```python
import torch

def _softmax(x, axis=-1):
    return torch.softmax(x, dim=axis)
def _gelu(x):
    return torch.nn.functional.gelu(x, approximate="tanh")
def _silu(x):
    return torch.nn.functional.silu(x)
def _sigmoid(x):
    return torch.sigmoid(x)
def _layernorm(x, axis=-1, eps=1e-5):
    m = x.mean(dim=axis, keepdim=True)
    v = x.var(dim=axis, keepdim=True, unbiased=False)
    return (x - m) / torch.sqrt(v + eps)
def _scatter_add(tgt, idx, src, axis=0):
    return tgt.clone().index_add_(axis, idx, src)
def _segment_sum(src, seg, n):
    out = torch.zeros((n,) + src.shape[1:], dtype=src.dtype)
    return out.index_add_(0, seg, src)
def _pad(x, pw):
    flat = tuple(v for pair in reversed(pw) for v in pair)
    return torch.nn.functional.pad(x, flat)

kernel_name = 'gated_mix__linear_attn_block__dense_activation_mish__prompt'

def setup_inputs():

    _w = (lambda a: (lambda t: t.to(torch.bfloat16) if t.is_floating_point() else t)(torch.as_tensor(a)))
    def _A_setup():
        B, S, D = 1, 2048, 640
        return {
            "x": _w((lambda *s: torch.randn(*s, dtype=torch.bfloat16) * 0.05)(B, S, D)),
            "wqkv": _w((lambda *s: torch.randn(*s, dtype=torch.bfloat16) * 0.8)(D, 3 * D)),
            "wo": _w((lambda *s: torch.randn(*s, dtype=torch.bfloat16) * 0.1)(D, D)),
        }
    _A_in = _A_setup()

    def _B_setup():
        B, S, D, F = 1, 2048, 640, 1536
        return {
            "x": _w((lambda *s: torch.randn(*s, dtype=torch.bfloat16) * 0.05)(B, S, D)),
            "w1": _w((lambda *s: torch.randn(*s, dtype=torch.bfloat16) * 12.8)(D, F) * (D ** -0.5)),
            "b1": _w((lambda *s: torch.randn(*s, dtype=torch.bfloat16) * 0.2)(F)),
            "w2": _w((lambda *s: torch.randn(*s, dtype=torch.bfloat16) * 0.1)(F, D) * (F ** -0.5)),
        }
    _B_in = _B_setup()

    return {
        "A_x": _A_in["x"],
        "A_wqkv": _A_in["wqkv"],
        "A_wo": _A_in["wo"],
        "B_x": _B_in["x"],
        "B_w1": _B_in["w1"],
        "B_b1": _B_in["b1"],
        "B_w2": _B_in["w2"],
        "gate_w": _w((lambda *s: torch.randn(*s, dtype=torch.bfloat16) * 0.05)(640) * 16.0),
    }

def reference(A_x, A_wqkv, A_wo, B_x, B_w1, B_b1, B_w2, gate_w):
    def _A_ref(x, wqkv, wo):
        B, S, D = x.shape
        H = 32; Dh = D // H
        qkv = (lambda x, *d: x.permute(*d))((x @ wqkv).reshape(B, S, 3, H, Dh), 2, 0, 3, 1, 4)
        q, k, v = qkv[0], qkv[1], qkv[2]
        phi = lambda t: torch.where(t > 0, t + 1, torch.exp(t)) + 1e-6
        pq, pk = phi(q), phi(k)
        kv = torch.einsum("bhsd,bhse->bhde", pk, v)
        z = torch.einsum("bhsd->bhd", pk)
        num = torch.einsum("bhqd,bhde->bhqe", pq, kv)
        den = torch.einsum("bhqd,bhd->bhq", pq, z)[..., None] + 1e-6
        o = num / den
        return (lambda x, *d: x.permute(*d))(o, 0, 2, 1, 3).reshape(B, S, D) @ wo

    def _B_ref(x, w1, b1, w2):
        h = torch.einsum("bsd,df->bsf", x, w1) + b1
        sp = torch.log1p(torch.exp(-torch.abs(h))) + torch.where(h > 0, h, torch.zeros_like(h))
        act = h * torch.tanh(sp)
        return torch.einsum("bsf,fd->bsd", act, w2)

    x = A_x
    g = _sigmoid((x * gate_w).sum(-1, keepdims=True))
    a = _A_ref(x, A_wqkv, A_wo)
    b = _B_ref(x, B_w1, B_b1, B_w2)
    return g * a + (1 - g) * b
```

```asm
; @launch grid=(256,1,1) block=(512,1,1) lds=163840
.amdgcn_target "amdgcn-amd-amdhsa--gfx950"
.text
.globl gated_mix__linear_attn_block__dense_activation_mish__prompt_kernel
.p2align 8
.type gated_mix__linear_attn_block__dense_activation_mish__prompt_kernel,@function
gated_mix__linear_attn_block__dense_activation_mish__prompt_kernel:
  s_cmp_ge_u32 s2, 256
  s_cbranch_scc1 L_end
  s_load_dwordx16 s[4:19], s[0:1], 0
  s_load_dwordx4 s[20:23], s[0:1], 64
  s_load_dwordx2 s[24:25], s[0:1], 80
  s_getpc_b64 s[60:61]
L_pc0:
  s_lshr_b32 s62, s2, 3
  s_lshl_b32 s62, s62, 11
  v_lshlrev_b32 v2, 4, v0
  v_add_u32 v2, s62, v2
  v_cmp_gt_u32 vcc, 128, v0
  v_min_u32 v2, L_code_end-L_pc0-16, v2
  s_and_saveexec_b64 s[64:65], vcc
  s_cbranch_execz L_cpf_1
  global_load_dwordx4 v[248:251], v2, s[60:61]
L_cpf_1:
  s_mov_b64 exec, s[64:65]
  v_lshrrev_b32 v1, 6, v0
  v_and_b32 v0, 63, v0
  v_readfirstlane_b32 s26, v1
  s_bfe_u32 s62, s2, 0x10002
  s_bfe_u32 s63, s2, 0x30003
  s_lshl3_add_u32 s27, s62, s63
  s_bfe_u32 s28, s2, 0x10001
  s_lshr_b32 s34, s2, 7
  s_bfe_u32 s60, s2, 0x10006
  s_and_b32 s61, s2, 1
  s_lshl1_add_u32 s64, s61, s60
  s_lshl1_add_u32 s65, s60, s61
  s_cmp_eq_u32 s34, 0
  s_cselect_b32 s60, s64, s65
  s_lshl2_add_u32 s29, s34, s60
  s_lshl2_add_u32 s30, s28, s60
  s_lshr_b32 s64, s2, 6
  s_mul_i32 s64, s64, 1
  s_add_u32 s64, s64, s63
  s_and_b32 s64, s64, 7
  s_lshl_b32 s64, s64, 2
  s_lshr_b32 s64, 0x30730730, s64
  s_and_b32 s64, s64, 15
  s_and_b32 s65, s2, 7
  s_lshl_b32 s65, s65, 2
  s_lshr_b32 s65, 0x21210210, s65
  s_and_b32 s65, s65, 15
  s_add_u32 s32, s64, s65
  s_cmp_lt_u32 s26, 4
  s_cbranch_scc1 L_comp
  s_setprio 2
  s_sub_u32 s35, s26, 4
  v_lshrrev_b32 v10, 3, v0
  v_and_b32 v11, 7, v0
  v_lshrrev_b32 v12, 4, v0
  v_mul_u32_u24 v13, 1280, v10
  v_xor_b32 v14, v11, v12
  s_and_b32 s60, s35, 1
  s_lshl_b32 s60, s60, 6
  v_lshl_add_u32 v13, v14, 4, v13
  v_xor_b32 v2, s60, v13
  v_xor_b32 v3, 64, v2
  v_mov_b32 v16, v13
  v_xor_b32 v17, 64, v13
  s_lshl_b32 s50, s32, 1
  s_mov_b32 s51, s32
  s_mul_i32 s68, s35, 3072
  s_mul_i32 s69, s35, 30720
  v_mov_b32 v6, 536870912
  v_mov_b32 v7, 536870912
  v_mov_b32 v8, 536870912
  v_mov_b32 v9, 536870912
  s_mov_b32 s67, 0
  s_cmp_eq_u32 s34, 0
  s_cbranch_scc1 L_wkv_2
  s_cmp_eq_u32 s35, 3
  s_cbranch_scc1 L_wqh_3
  s_mov_b32 s70, 1
  s_mov_b32 s48, 3072
  s_mul_i32 s49, s30, 3
  s_add_u32 s49, s49, s35
  s_lshl_b32 s49, s49, 7
  s_lshl_b32 s66, s35, 12
L_wln_4:
  v_and_b32 v13, 4, v10
  v_add_u32 v13, v13, v10
  v_mul_u32_u24 v13, s48, v13
  v_lshlrev_b32 v12, 1, v12
  v_xor_b32 v12, v11, v12
  v_lshl_add_u32 v4, v12, 4, v13
  s_lshl_b32 s60, s48, 4
  s_lshl_b32 s61, s48, 2
  v_add_u32 v5, s60, v4
  v_add_u32 v6, s61, v4
  v_add_u32 v7, s60, v6
  s_branch L_wj_5
L_wqh_3:
  s_mov_b32 s70, 0
  s_mov_b32 s48, 3840
  s_lshl_b32 s49, s28, 1
  s_add_u32 s49, s49, s29
  s_add_u32 s49, s49, 12
  s_lshl_b32 s49, s49, 6
  s_cmp_lt_u32 s29, 6
  s_cselect_b32 s49, s49, 536870912
  s_mov_b32 s66, 12288
  s_mov_b32 s67, 13312
  v_lshrrev_b32 v10, 2, v0
  v_and_b32 v13, 12, v10
  v_add_u32 v13, v13, v10
  v_mul_u32_u24 v13, 3840, v13
  v_and_b32 v11, 3, v0
  v_and_b32 v12, 1, v12
  v_lshlrev_b32 v12, 1, v12
  v_xor_b32 v12, v11, v12
  v_lshl_add_u32 v4, v12, 4, v13
  v_add_u32 v5, 15360, v4
  s_lshl_b32 s60, s32, 3
  v_mov_b32 v14, 536870912
  v_add_u32 v10, 0, v0
  v_add_u32 v11, s60, v10
  v_cmp_gt_u32 vcc, 80, v10
  v_subrev_u32 v12, 80, v11
  v_min_u32 v11, v11, v12
  v_lshlrev_b32 v11, 4, v11
  v_cndmask_b32 v8, v14, v11, vcc
  v_add_u32 v10, 64, v0
  v_add_u32 v11, s60, v10
  v_cmp_gt_u32 vcc, 80, v10
  v_subrev_u32 v12, 80, v11
  v_min_u32 v11, v11, v12
  v_lshlrev_b32 v11, 4, v11
  v_cndmask_b32 v9, v14, v11, vcc
  s_branch L_wj_5
L_wkv_2:
  s_mov_b32 s70, 0
  s_mov_b32 s48, 3840
  s_mul_i32 s66, s35, 5120
  s_lshl_b32 s49, s30, 7
  s_cmp_eq_u32 s35, 2
  s_cbranch_scc1 L_wln_4
  s_mul_i32 s49, s30, 160
  s_cmp_eq_u32 s35, 1
  s_mov_b32 s60, 1280
  s_cselect_b32 s60, 2560, s60
  s_add_u32 s49, s49, s60
  s_cmp_eq_u32 s35, 3
  s_cselect_b32 s60, 256, 0
  s_cselect_b32 s66, 4096, s66
  s_mov_b32 s67, 9216
  v_add_u32 v14, s60, v0
  v_add_u32 v10, 0, v14
  v_mul_u32_u24 v11, 6554, v10
  v_lshrrev_b32 v11, 16, v11
  v_mad_i32_i24 v10, v11, -10, v10
  v_and_b32 v12, 12, v11
  v_and_b32 v13, 3, v11
  v_lshl_or_b32 v12, v12, 1, v13
  v_bfe_u32 v13, v11, 4, 1
  v_lshl_or_b32 v12, v13, 2, v12
  v_mul_u32_u24 v12, 3840, v12
  v_lshl_add_u32 v4, v10, 4, v12
  v_add_u32 v5, 1280, v4
  s_cmp_eq_u32 s35, 3
  s_cbranch_scc1 L_wj_5
  v_add_u32 v10, 64, v14
  v_mul_u32_u24 v11, 6554, v10
  v_lshrrev_b32 v11, 16, v11
  v_mad_i32_i24 v10, v11, -10, v10
  v_and_b32 v12, 12, v11
  v_and_b32 v13, 3, v11
  v_lshl_or_b32 v12, v12, 1, v13
  v_bfe_u32 v13, v11, 4, 1
  v_lshl_or_b32 v12, v13, 2, v12
  v_mul_u32_u24 v12, 3840, v12
  v_lshl_add_u32 v5, v10, 4, v12
  v_add_u32 v10, 128, v14
  v_mul_u32_u24 v11, 6554, v10
  v_lshrrev_b32 v11, 16, v11
  v_mad_i32_i24 v10, v11, -10, v10
  v_and_b32 v12, 12, v11
  v_and_b32 v13, 3, v11
  v_lshl_or_b32 v12, v12, 1, v13
  v_bfe_u32 v13, v11, 4, 1
  v_lshl_or_b32 v12, v13, 2, v12
  v_mul_u32_u24 v12, 3840, v12
  v_lshl_add_u32 v6, v10, 4, v12
  v_add_u32 v10, 192, v14
  v_mul_u32_u24 v11, 6554, v10
  v_lshrrev_b32 v11, 16, v11
  v_mad_i32_i24 v10, v11, -10, v10
  v_and_b32 v12, 12, v11
  v_and_b32 v13, 3, v11
  v_lshl_or_b32 v12, v12, 1, v13
  v_bfe_u32 v13, v11, 4, 1
  v_lshl_or_b32 v12, v13, 2, v12
  v_mul_u32_u24 v12, 3840, v12
  v_lshl_add_u32 v7, v10, 4, v12
L_wj_5:
  s_lshl_b32 s48, s48, 5
  s_mul_i32 s60, s27, 163840
  s_waitcnt lgkmcnt(0)
  s_add_u32 s40, s4, s60
  s_addc_u32 s41, s5, 0
  s_mov_b32 s42, 163840
  s_mov_b32 s43, 0x20000
  s_mul_i32 s65, s35, 40960
  s_lshl_b32 s60, s51, 7
  s_add_u32 s65, s65, s60
  s_lshl_b32 s60, s35, 12
  s_add_u32 m0, s60, 0
  s_nop 0
  buffer_load_dwordx4 v16, s[40:43], s65 offen lds
  s_add_u32 m0, s60, 1024
  s_add_u32 s65, s65, 10240
  buffer_load_dwordx4 v17, s[40:43], s65 offen lds
  s_add_u32 m0, s60, 2048
  s_add_u32 s65, s65, 10240
  buffer_load_dwordx4 v16, s[40:43], s65 offen lds
  s_add_u32 m0, s60, 3072
  s_add_u32 s65, s65, 10240
  buffer_load_dwordx4 v17, s[40:43], s65 offen lds
  s_cmp_eq_u32 s70, 0
  s_cselect_b32 s44, s6, s12
  s_cselect_b32 s45, s7, s13
  s_mov_b32 s46, 1966080
  s_cselect_b32 s46, 2457600, s46
  s_mov_b32 s47, 0x20000
  s_add_u32 s51, s51, 1
  s_cmp_eq_u32 s51, 10
  s_cselect_b32 s51, 0, s51
  s_add_u32 s61, s66, 1024
  s_cmp_eq_u32 s35, 3
  s_cselect_b32 s61, s67, s61
  s_cselect_b32 s62, s29, 0
  s_cmp_ge_u32 s62, 6
  s_cbranch_scc1 L_f4_6
  s_mul_i32 s64, s50, s48
  s_add_u32 m0, s66, 49152
  s_add_u32 s64, s64, s49
  buffer_load_dwordx4 v4, s[44:47], s64 offen lds
  s_add_u32 m0, s61, 49152
  s_cmp_eq_u32 s35, 3
  buffer_load_dwordx4 v5, s[44:47], s64 offen lds
  s_cbranch_scc1 L_f2_8
  s_add_u32 m0, s66, 51200
  s_nop 0
  buffer_load_dwordx4 v6, s[44:47], s64 offen lds
  s_add_u32 m0, s66, 52224
  s_nop 0
  buffer_load_dwordx4 v7, s[44:47], s64 offen lds
L_f2_8:
  s_add_u32 s50, s50, 1
  s_cmp_eq_u32 s50, 20
  s_cselect_b32 s50, 0, s50
  s_mul_i32 s64, s50, s48
  s_add_u32 m0, s66, 63488
  s_add_u32 s64, s64, s49
  buffer_load_dwordx4 v4, s[44:47], s64 offen lds
  s_add_u32 m0, s61, 63488
  s_cmp_eq_u32 s35, 3
  buffer_load_dwordx4 v5, s[44:47], s64 offen lds
  s_cbranch_scc1 L_f2_9
  s_add_u32 m0, s66, 65536
  s_nop 0
  buffer_load_dwordx4 v6, s[44:47], s64 offen lds
  s_add_u32 m0, s66, 66560
  s_nop 0
  buffer_load_dwordx4 v7, s[44:47], s64 offen lds
L_f2_9:
  s_add_u32 s50, s50, 1
  s_cmp_eq_u32 s50, 20
  s_cselect_b32 s50, 0, s50
  s_branch L_fj_7
L_f4_6:
  s_mov_b32 s52, s18
  s_mov_b32 s53, s19
  s_mov_b32 s54, 1280
  s_mov_b32 s55, 0x20000
  s_mov_b32 m0, 135168
  s_nop 0
  buffer_load_dwordx4 v8, s[52:55], 0 offen lds
  s_mov_b32 m0, 136192
  s_nop 0
  buffer_load_dwordx4 v9, s[52:55], 0 offen lds
L_fj_7:
  s_cmp_eq_u32 s35, 3
  s_cbranch_scc1 L_ld3_10
  s_waitcnt vmcnt(4)
  s_barrier
  s_lshl_b32 s65, s51, 7
  s_add_u32 m0, s68, 16384
  s_add_u32 s65, s65, s69
  buffer_load_dwordx4 v2, s[40:43], s65 offen lds
  s_add_u32 m0, s68, 17408
  s_add_u32 s65, s65, 10240
  buffer_load_dwordx4 v3, s[40:43], s65 offen lds
  s_add_u32 m0, s68, 18432
  s_add_u32 s65, s65, 10240
  buffer_load_dwordx4 v2, s[40:43], s65 offen lds
  s_add_u32 s51, s51, 1
  s_cmp_eq_u32 s51, 10
  s_cselect_b32 s51, 0, s51
  s_waitcnt vmcnt(3)
  s_barrier
  s_mul_i32 s64, s50, s48
  s_add_u32 m0, s66, 77824
  s_add_u32 s64, s64, s49
  buffer_load_dwordx4 v4, s[44:47], s64 offen lds
  s_add_u32 m0, s66, 78848
  s_nop 0
  buffer_load_dwordx4 v5, s[44:47], s64 offen lds
  s_add_u32 m0, s66, 79872
  s_nop 0
  buffer_load_dwordx4 v6, s[44:47], s64 offen lds
  s_add_u32 m0, s66, 80896
  s_nop 0
  buffer_load_dwordx4 v7, s[44:47], s64 offen lds
  s_add_u32 s50, s50, 1
  s_cmp_eq_u32 s50, 20
  s_cselect_b32 s50, 0, s50
  s_mul_i32 s64, s50, s48
  s_add_u32 m0, s66, 92160
  s_add_u32 s64, s64, s49
  buffer_load_dwordx4 v4, s[44:47], s64 offen lds
  s_add_u32 m0, s66, 93184
  s_nop 0
  buffer_load_dwordx4 v5, s[44:47], s64 offen lds
  s_add_u32 m0, s66, 94208
  s_nop 0
  buffer_load_dwordx4 v6, s[44:47], s64 offen lds
  s_add_u32 m0, s66, 95232
  s_nop 0
  buffer_load_dwordx4 v7, s[44:47], s64 offen lds
  s_add_u32 s50, s50, 1
  s_cmp_eq_u32 s50, 20
  s_cselect_b32 s50, 0, s50
  s_lshl_b32 s65, s51, 7
  s_add_u32 m0, s68, 32768
  s_add_u32 s65, s65, s69
  buffer_load_dwordx4 v2, s[40:43], s65 offen lds
  s_add_u32 m0, s68, 33792
  s_add_u32 s65, s65, 10240
  buffer_load_dwordx4 v3, s[40:43], s65 offen lds
  s_add_u32 m0, s68, 34816
  s_add_u32 s65, s65, 10240
  buffer_load_dwordx4 v2, s[40:43], s65 offen lds
  s_add_u32 s51, s51, 1
  s_cmp_eq_u32 s51, 10
  s_cselect_b32 s51, 0, s51
  s_mul_i32 s64, s50, s48
  s_add_u32 m0, s66, 106496
  s_add_u32 s64, s64, s49
  buffer_load_dwordx4 v4, s[44:47], s64 offen lds
  s_add_u32 m0, s66, 107520
  s_nop 0
  buffer_load_dwordx4 v5, s[44:47], s64 offen lds
  s_add_u32 m0, s66, 108544
  s_nop 0
  buffer_load_dwordx4 v6, s[44:47], s64 offen lds
  s_add_u32 m0, s66, 109568
  s_nop 0
  buffer_load_dwordx4 v7, s[44:47], s64 offen lds
  s_add_u32 s50, s50, 1
  s_cmp_eq_u32 s50, 20
  s_cselect_b32 s50, 0, s50
  s_waitcnt vmcnt(7)
  s_barrier
  s_mul_i32 s64, s50, s48
  s_add_u32 m0, s66, 120832
  s_add_u32 s64, s64, s49
  buffer_load_dwordx4 v4, s[44:47], s64 offen lds
  s_add_u32 m0, s66, 121856
  s_nop 0
  buffer_load_dwordx4 v5, s[44:47], s64 offen lds
  s_add_u32 m0, s66, 122880
  s_nop 0
  buffer_load_dwordx4 v6, s[44:47], s64 offen lds
  s_add_u32 m0, s66, 123904
  s_nop 0
  buffer_load_dwordx4 v7, s[44:47], s64 offen lds
  s_add_u32 s50, s50, 1
  s_cmp_eq_u32 s50, 20
  s_cselect_b32 s50, 0, s50
  s_lshl_b32 s65, s51, 7
  s_add_u32 m0, s68, 0
  s_add_u32 s65, s65, s69
  buffer_load_dwordx4 v2, s[40:43], s65 offen lds
  s_add_u32 m0, s68, 1024
  s_add_u32 s65, s65, 10240
  buffer_load_dwordx4 v3, s[40:43], s65 offen lds
  s_add_u32 m0, s68, 2048
  s_add_u32 s65, s65, 10240
  buffer_load_dwordx4 v2, s[40:43], s65 offen lds
  s_add_u32 s51, s51, 1
  s_cmp_eq_u32 s51, 10
  s_cselect_b32 s51, 0, s51
  s_mul_i32 s64, s50, s48
  s_add_u32 m0, s66, 49152
  s_add_u32 s64, s64, s49
  buffer_load_dwordx4 v4, s[44:47], s64 offen lds
  s_add_u32 m0, s66, 50176
  s_nop 0
  buffer_load_dwordx4 v5, s[44:47], s64 offen lds
  s_add_u32 m0, s66, 51200
  s_nop 0
  buffer_load_dwordx4 v6, s[44:47], s64 offen lds
  s_add_u32 m0, s66, 52224
  s_nop 0
  buffer_load_dwordx4 v7, s[44:47], s64 offen lds
  s_add_u32 s50, s50, 1
  s_cmp_eq_u32 s50, 20
  s_cselect_b32 s50, 0, s50
  s_waitcnt vmcnt(7)
  s_barrier
  s_mul_i32 s64, s50, s48
  s_add_u32 m0, s66, 63488
  s_add_u32 s64, s64, s49
  buffer_load_dwordx4 v4, s[44:47], s64 offen lds
  s_add_u32 m0, s66, 64512
  s_nop 0
  buffer_load_dwordx4 v5, s[44:47], s64 offen lds
  s_add_u32 m0, s66, 65536
  s_nop 0
  buffer_load_dwordx4 v6, s[44:47], s64 offen lds
  s_add_u32 m0, s66, 66560
  s_nop 0
  buffer_load_dwordx4 v7, s[44:47], s64 offen lds
  s_add_u32 s50, s50, 1
  s_cmp_eq_u32 s50, 20
  s_cselect_b32 s50, 0, s50
  s_lshl_b32 s65, s51, 7
  s_add_u32 m0, s68, 16384
  s_add_u32 s65, s65, s69
  buffer_load_dwordx4 v2, s[40:43], s65 offen lds
  s_add_u32 m0, s68, 17408
  s_add_u32 s65, s65, 10240
  buffer_load_dwordx4 v3, s[40:43], s65 offen lds
  s_add_u32 m0, s68, 18432
  s_add_u32 s65, s65, 10240
  buffer_load_dwordx4 v2, s[40:43], s65 offen lds
  s_add_u32 s51, s51, 1
  s_cmp_eq_u32 s51, 10
  s_cselect_b32 s51, 0, s51
  s_mul_i32 s64, s50, s48
  s_add_u32 m0, s66, 77824
  s_add_u32 s64, s64, s49
  buffer_load_dwordx4 v4, s[44:47], s64 offen lds
  s_add_u32 m0, s66, 78848
  s_nop 0
  buffer_load_dwordx4 v5, s[44:47], s64 offen lds
  s_add_u32 m0, s66, 79872
  s_nop 0
  buffer_load_dwordx4 v6, s[44:47], s64 offen lds
  s_add_u32 m0, s66, 80896
  s_nop 0
  buffer_load_dwordx4 v7, s[44:47], s64 offen lds
  s_add_u32 s50, s50, 1
  s_cmp_eq_u32 s50, 20
  s_cselect_b32 s50, 0, s50
  s_waitcnt vmcnt(7)
  s_barrier
  s_mul_i32 s64, s50, s48
  s_add_u32 m0, s66, 92160
  s_add_u32 s64, s64, s49
  buffer_load_dwordx4 v4, s[44:47], s64 offen lds
  s_add_u32 m0, s66, 93184
  s_nop 0
  buffer_load_dwordx4 v5, s[44:47], s64 offen lds
  s_add_u32 m0, s66, 94208
  s_nop 0
  buffer_load_dwordx4 v6, s[44:47], s64 offen lds
  s_add_u32 m0, s66, 95232
  s_nop 0
  buffer_load_dwordx4 v7, s[44:47], s64 offen lds
  s_add_u32 s50, s50, 1
  s_cmp_eq_u32 s50, 20
  s_cselect_b32 s50, 0, s50
  s_lshl_b32 s65, s51, 7
  s_add_u32 m0, s68, 32768
  s_add_u32 s65, s65, s69
  buffer_load_dwordx4 v2, s[40:43], s65 offen lds
  s_add_u32 m0, s68, 33792
  s_add_u32 s65, s65, 10240
  buffer_load_dwordx4 v3, s[40:43], s65 offen lds
  s_add_u32 m0, s68, 34816
  s_add_u32 s65, s65, 10240
  buffer_load_dwordx4 v2, s[40:43], s65 offen lds
  s_add_u32 s51, s51, 1
  s_cmp_eq_u32 s51, 10
  s_cselect_b32 s51, 0, s51
  s_mul_i32 s64, s50, s48
  s_add_u32 m0, s66, 106496
  s_add_u32 s64, s64, s49
  buffer_load_dwordx4 v4, s[44:47], s64 offen lds
  s_add_u32 m0, s66, 107520
  s_nop 0
  buffer_load_dwordx4 v5, s[44:47], s64 offen lds
  s_add_u32 m0, s66, 108544
  s_nop 0
  buffer_load_dwordx4 v6, s[44:47], s64 offen lds
  s_add_u32 m0, s66, 109568
  s_nop 0
  buffer_load_dwordx4 v7, s[44:47], s64 offen lds
  s_add_u32 s50, s50, 1
  s_cmp_eq_u32 s50, 20
  s_cselect_b32 s50, 0, s50
  s_waitcnt vmcnt(7)
  s_barrier
  s_mul_i32 s64, s50, s48
  s_add_u32 m0, s66, 120832
  s_add_u32 s64, s64, s49
  buffer_load_dwordx4 v4, s[44:47], s64 offen lds
  s_add_u32 m0, s66, 121856
  s_nop 0
  buffer_load_dwordx4 v5, s[44:47], s64 offen lds
  s_add_u32 m0, s66, 122880
  s_nop 0
  buffer_load_dwordx4 v6, s[44:47], s64 offen lds
  s_add_u32 m0, s66, 123904
  s_nop 0
  buffer_load_dwordx4 v7, s[44:47], s64 offen lds
  s_add_u32 s50, s50, 1
  s_cmp_eq_u32 s50, 20
  s_cselect_b32 s50, 0, s50
  s_lshl_b32 s65, s51, 7
  s_add_u32 m0, s68, 0
  s_add_u32 s65, s65, s69
  buffer_load_dwordx4 v2, s[40:43], s65 offen lds
  s_add_u32 m0, s68, 1024
  s_add_u32 s65, s65, 10240
  buffer_load_dwordx4 v3, s[40:43], s65 offen lds
  s_add_u32 m0, s68, 2048
  s_add_u32 s65, s65, 10240
  buffer_load_dwordx4 v2, s[40:43], s65 offen lds
  s_add_u32 s51, s51, 1
  s_cmp_eq_u32 s51, 10
  s_cselect_b32 s51, 0, s51
  s_mul_i32 s64, s50, s48
  s_add_u32 m0, s66, 49152
  s_add_u32 s64, s64, s49
  buffer_load_dwordx4 v4, s[44:47], s64 offen lds
  s_add_u32 m0, s66, 50176
  s_nop 0
  buffer_load_dwordx4 v5, s[44:47], s64 offen lds
  s_add_u32 m0, s66, 51200
  s_nop 0
  buffer_load_dwordx4 v6, s[44:47], s64 offen lds
  s_add_u32 m0, s66, 52224
  s_nop 0
  buffer_load_dwordx4 v7, s[44:47], s64 offen lds
  s_add_u32 s50, s50, 1
  s_cmp_eq_u32 s50, 20
  s_cselect_b32 s50, 0, s50
  s_cmp_lg_u32 s35, 0
  s_cbranch_scc1 L_s1a_15
  s_cmp_eq_u32 s34, 0
  s_cbranch_scc1 L_s1a_15
  s_mov_b32 s56, s22
  s_mov_b32 s57, s23
  s_mov_b32 s58, 256
  s_mov_b32 s59, 0x20000
  v_mov_b32 v70, 1
  v_mov_b32 v69, 0
  s_mov_b64 exec, 1
  buffer_atomic_add v70, v69, s[56:59], 0 offen sc0 sc1
  s_mov_b64 exec, -1
L_s1a_15:
  v_lshlrev_b32 v254, 4, v0
  v_mov_b32 v255, v0
  s_xor_b32 s30, s26, 4
  s_mul_i32 s30, s30, 20480
  s_mov_b32 s33, -208
  v_and_b32 v44, 15, v255
  v_lshrrev_b32 v45, 4, v255
  s_add_u32 s72, s30, 13312
  v_mul_u32_u24 v47, 336, v45
  v_add_u32 v47, s72, v47
  v_add_u32 v62, s30, v254
  s_add_u32 s72, s72, 7056
  v_mov_b32 v57, s72
  v_subrev_u32 v58, 1344, v57
  v_subrev_u32 v59, 2688, v57
  v_subrev_u32 v60, 4032, v57
  v_subrev_u32 v61, 5376, v57
  v_add_u32 v50, 0, v44
  v_mul_u32_u24 v48, 3277, v50
  v_lshrrev_b32 v48, 16, v48
  v_lshl_add_u32 v50, v50, 4, v47
  v_mad_i32_i24 v49, v48, s33, v50
  v_mad_i32_i24 v48, v48, -5, v45
  v_add_u32 v52, 0, v48
  v_add_u32 v53, 4, v48
  v_cmp_gt_u32 s[96:97], 5, v52
  v_cmp_gt_u32 s[98:99], 5, v53
  s_nop 0
  v_cndmask_b32 v20, v57, v49, s[96:97]
  v_cndmask_b32 v21, v58, v49, s[98:99]
  s_waitcnt vmcnt(7)
  s_barrier
  s_mul_i32 s64, s50, s48
  s_add_u32 m0, s66, 63488
  s_add_u32 s64, s64, s49
  buffer_load_dwordx4 v4, s[44:47], s64 offen lds
  s_add_u32 m0, s66, 64512
  s_nop 0
  buffer_load_dwordx4 v5, s[44:47], s64 offen lds
  s_add_u32 m0, s66, 65536
  s_nop 0
  buffer_load_dwordx4 v6, s[44:47], s64 offen lds
  s_add_u32 m0, s66, 66560
  s_nop 0
  buffer_load_dwordx4 v7, s[44:47], s64 offen lds
  s_add_u32 s50, s50, 1
  s_cmp_eq_u32 s50, 20
  s_cselect_b32 s50, 0, s50
  s_lshl_b32 s65, s51, 7
  s_add_u32 m0, s68, 16384
  s_add_u32 s65, s65, s69
  buffer_load_dwordx4 v2, s[40:43], s65 offen lds
  s_add_u32 m0, s68, 17408
  s_add_u32 s65, s65, 10240
  buffer_load_dwordx4 v3, s[40:43], s65 offen lds
  s_add_u32 m0, s68, 18432
  s_add_u32 s65, s65, 10240
  buffer_load_dwordx4 v2, s[40:43], s65 offen lds
  s_add_u32 s51, s51, 1
  s_cmp_eq_u32 s51, 10
  s_cselect_b32 s51, 0, s51
  s_mul_i32 s64, s50, s48
  s_add_u32 m0, s66, 77824
  s_add_u32 s64, s64, s49
  buffer_load_dwordx4 v4, s[44:47], s64 offen lds
  s_add_u32 m0, s66, 78848
  s_nop 0
  buffer_load_dwordx4 v5, s[44:47], s64 offen lds
  s_add_u32 m0, s66, 79872
  s_nop 0
  buffer_load_dwordx4 v6, s[44:47], s64 offen lds
  s_add_u32 m0, s66, 80896
  s_nop 0
  buffer_load_dwordx4 v7, s[44:47], s64 offen lds
  s_add_u32 s50, s50, 1
  s_cmp_eq_u32 s50, 20
  s_cselect_b32 s50, 0, s50
  v_add_u32 v50, 16, v44
  v_mul_u32_u24 v48, 3277, v50
  v_lshrrev_b32 v48, 16, v48
  v_lshl_add_u32 v50, v50, 4, v47
  v_mad_i32_i24 v49, v48, s33, v50
  v_mad_i32_i24 v48, v48, -5, v45
  v_add_u32 v52, 0, v48
  v_add_u32 v53, 4, v48
  v_add_u32 v54, 8, v48
  v_cmp_gt_u32 s[96:97], 5, v52
  v_cmp_gt_u32 s[98:99], 5, v53
  v_cmp_gt_u32 s[100:101], 5, v54
  s_nop 0
  v_cndmask_b32 v22, v57, v49, s[96:97]
  v_cndmask_b32 v23, v58, v49, s[98:99]
  v_cndmask_b32 v24, v59, v49, s[100:101]
  v_add_u32 v50, 32, v44
  v_mul_u32_u24 v48, 3277, v50
  v_lshrrev_b32 v48, 16, v48
  v_lshl_add_u32 v50, v50, 4, v47
  v_mad_i32_i24 v49, v48, s33, v50
  v_mad_i32_i24 v48, v48, -5, v45
  v_add_u32 v52, 4, v48
  v_add_u32 v53, 8, v48
  v_add_u32 v54, 12, v48
  v_cmp_gt_u32 s[96:97], 5, v52
  v_cmp_gt_u32 s[98:99], 5, v53
  v_cmp_gt_u32 s[100:101], 5, v54
  s_nop 0
  v_cndmask_b32 v25, v58, v49, s[96:97]
  v_cndmask_b32 v26, v59, v49, s[98:99]
  v_cndmask_b32 v27, v60, v49, s[100:101]
  s_waitcnt vmcnt(7)
  s_cmp_lg_u32 s35, 0
  s_cbranch_scc1 L_s1b_16
  s_cmp_eq_u32 s34, 0
  s_cbranch_scc1 L_s1b_16
  v_readfirstlane_b32 s60, v70
  v_mov_b32 v71, 1
  s_cmp_lg_u32 s60, 127
  s_cbranch_scc1 L_s1b_16
  s_mov_b32 s56, s22
  s_mov_b32 s57, s23
  s_mov_b32 s58, 256
  s_mov_b32 s59, 0x20000
  v_mov_b32 v69, 0
  s_mov_b64 exec, 1
  buffer_store_dword v71, v69, s[56:59], 0 offen offset:128 sc1
  s_mov_b64 exec, -1
L_s1b_16:
  s_barrier
  s_mul_i32 s64, s50, s48
  s_add_u32 m0, s66, 92160
  s_add_u32 s64, s64, s49
  buffer_load_dwordx4 v4, s[44:47], s64 offen lds
  s_add_u32 m0, s66, 93184
  s_nop 0
  buffer_load_dwordx4 v5, s[44:47], s64 offen lds
  s_add_u32 m0, s66, 94208
  s_nop 0
  buffer_load_dwordx4 v6, s[44:47], s64 offen lds
  s_add_u32 m0, s66, 95232
  s_nop 0
  buffer_load_dwordx4 v7, s[44:47], s64 offen lds
  s_add_u32 s50, s50, 1
  s_cmp_eq_u32 s50, 20
  s_cselect_b32 s50, 0, s50
  s_lshl_b32 s65, s51, 7
  s_add_u32 m0, s68, 32768
  s_add_u32 s65, s65, s69
  buffer_load_dwordx4 v2, s[40:43], s65 offen lds
  s_add_u32 m0, s68, 33792
  s_add_u32 s65, s65, 10240
  buffer_load_dwordx4 v3, s[40:43], s65 offen lds
  s_add_u32 m0, s68, 34816
  s_add_u32 s65, s65, 10240
  buffer_load_dwordx4 v2, s[40:43], s65 offen lds
  s_add_u32 s51, s51, 1
  s_cmp_eq_u32 s51, 10
  s_cselect_b32 s51, 0, s51
  s_mul_i32 s64, s50, s48
  s_add_u32 m0, s66, 106496
  s_add_u32 s64, s64, s49
  buffer_load_dwordx4 v4, s[44:47], s64 offen lds
  s_add_u32 m0, s66, 107520
  s_nop 0
  buffer_load_dwordx4 v5, s[44:47], s64 offen lds
  s_add_u32 m0, s66, 108544
  s_nop 0
  buffer_load_dwordx4 v6, s[44:47], s64 offen lds
  s_add_u32 m0, s66, 109568
  s_nop 0
  buffer_load_dwordx4 v7, s[44:47], s64 offen lds
  s_add_u32 s50, s50, 1
  s_cmp_eq_u32 s50, 20
  s_cselect_b32 s50, 0, s50
  v_add_u32 v50, 48, v44
  v_mul_u32_u24 v48, 3277, v50
  v_lshrrev_b32 v48, 16, v48
  v_lshl_add_u32 v50, v50, 4, v47
  v_mad_i32_i24 v49, v48, s33, v50
  v_mad_i32_i24 v48, v48, -5, v45
  v_add_u32 v52, 8, v48
  v_add_u32 v53, 12, v48
  v_add_u32 v54, 16, v48
  v_cmp_gt_u32 s[96:97], 5, v52
  v_cmp_gt_u32 s[98:99], 5, v53
  v_cmp_gt_u32 s[100:101], 5, v54
  s_nop 0
  v_cndmask_b32 v28, v59, v49, s[96:97]
  v_cndmask_b32 v29, v60, v49, s[98:99]
  v_cndmask_b32 v31, v61, v49, s[100:101]
  v_add_u32 v50, 64, v44
  v_mul_u32_u24 v48, 3277, v50
  v_lshrrev_b32 v48, 16, v48
  v_lshl_add_u32 v50, v50, 4, v47
  v_mad_i32_i24 v49, v48, s33, v50
  v_mad_i32_i24 v48, v48, -5, v45
  v_add_u32 v52, 12, v48
  v_add_u32 v53, 16, v48
  v_cmp_gt_u32 s[96:97], 5, v52
  v_cmp_gt_u32 s[98:99], 5, v53
  s_nop 0
  v_cndmask_b32 v30, v60, v49, s[96:97]
  v_cndmask_b32 v32, v61, v49, s[98:99]
  s_waitcnt vmcnt(7)
  s_barrier
  s_mul_i32 s64, s50, s48
  s_add_u32 m0, s66, 120832
  s_add_u32 s64, s64, s49
  buffer_load_dwordx4 v4, s[44:47], s64 offen lds
  s_add_u32 m0, s66, 121856
  s_nop 0
  buffer_load_dwordx4 v5, s[44:47], s64 offen lds
  s_add_u32 m0, s66, 122880
  s_nop 0
  buffer_load_dwordx4 v6, s[44:47], s64 offen lds
  s_add_u32 m0, s66, 123904
  s_nop 0
  buffer_load_dwordx4 v7, s[44:47], s64 offen lds
  s_add_u32 s50, s50, 1
  s_cmp_eq_u32 s50, 20
  s_cselect_b32 s50, 0, s50
  s_lshl_b32 s65, s51, 7
  s_add_u32 m0, s68, 0
  s_add_u32 s65, s65, s69
  buffer_load_dwordx4 v2, s[40:43], s65 offen lds
  s_add_u32 m0, s68, 1024
  s_add_u32 s65, s65, 10240
  buffer_load_dwordx4 v3, s[40:43], s65 offen lds
  s_add_u32 m0, s68, 2048
  s_add_u32 s65, s65, 10240
  buffer_load_dwordx4 v2, s[40:43], s65 offen lds
  s_add_u32 s51, s51, 1
  s_cmp_eq_u32 s51, 10
  s_cselect_b32 s51, 0, s51
  s_mul_i32 s64, s50, s48
  s_add_u32 m0, s66, 49152
  s_add_u32 s64, s64, s49
  buffer_load_dwordx4 v4, s[44:47], s64 offen lds
  s_add_u32 m0, s66, 50176
  s_nop 0
  buffer_load_dwordx4 v5, s[44:47], s64 offen lds
  s_add_u32 m0, s66, 51200
  s_nop 0
  buffer_load_dwordx4 v6, s[44:47], s64 offen lds
  s_add_u32 m0, s66, 52224
  s_nop 0
  buffer_load_dwordx4 v7, s[44:47], s64 offen lds
  s_add_u32 s50, s50, 1
  s_cmp_eq_u32 s50, 20
  s_cselect_b32 s50, 0, s50
  v_and_b32 v48, 3, v255
  v_mul_u32_u24 v49, 112, v48
  v_add_u32 v50, 320, v47
  v_add_u32 v49, v49, v50
  v_mad_i32_i24 v48, v48, -5, v45
  v_add_u32 v52, 0, v48
  v_add_u32 v53, 4, v48
  v_add_u32 v54, 8, v48
  v_add_u32 v55, 12, v48
  v_add_u32 v56, 16, v48
  v_cmp_gt_u32 s[96:97], 5, v52
  v_cmp_gt_u32 s[98:99], 5, v53
  v_cmp_gt_u32 s[100:101], 5, v54
  v_cmp_gt_u32 s[52:53], 5, v55
  v_cmp_gt_u32 s[54:55], 5, v56
  s_nop 0
  v_cndmask_b32 v33, v57, v49, s[96:97]
  v_cndmask_b32 v34, v58, v49, s[98:99]
  v_cndmask_b32 v35, v59, v49, s[100:101]
  v_cndmask_b32 v36, v60, v49, s[52:53]
  v_cndmask_b32 v37, v61, v49, s[54:55]
  s_waitcnt vmcnt(7)
  s_barrier
  s_mul_i32 s64, s50, s48
  s_add_u32 m0, s66, 63488
  s_add_u32 s64, s64, s49
  buffer_load_dwordx4 v4, s[44:47], s64 offen lds
  s_add_u32 m0, s66, 64512
  s_nop 0
  buffer_load_dwordx4 v5, s[44:47], s64 offen lds
  s_add_u32 m0, s66, 65536
  s_nop 0
  buffer_load_dwordx4 v6, s[44:47], s64 offen lds
  s_add_u32 m0, s66, 66560
  s_nop 0
  buffer_load_dwordx4 v7, s[44:47], s64 offen lds
  s_add_u32 s50, s50, 1
  s_cmp_eq_u32 s50, 20
  s_cselect_b32 s50, 0, s50
  s_cmp_lg_u32 s26, 4
  s_cbranch_scc1 L_s1skip_17
  s_mov_b32 s56, s22
  s_mov_b32 s57, s23
  s_mov_b32 s58, 256
  s_mov_b32 s59, 0x20000
  v_mov_b32 v74, 128
  s_mov_b32 s75, 0
L_poll_18:
  buffer_load_dword v75, v74, s[56:59], 0 offen sc1
  s_waitcnt vmcnt(0)
  v_cmp_le_u32 vcc, 1, v75
  s_add_u32 s75, s75, 1
  s_nop 0
  s_cmp_eq_u64 vcc, -1
  s_cbranch_scc1 L_polld_19
  s_sleep 2
  s_cmp_lt_u32 s75, 1048576
  s_cbranch_scc1 L_poll_18
L_polld_19:
L_s1skip_17:
  s_waitcnt vmcnt(0)
  s_barrier
  s_branch L_ldj_12
L_ld3_10:
  s_cmp_ge_u32 s29, 6
  s_cbranch_scc1 L_ld4_11
  s_waitcnt vmcnt(2)
  s_barrier
  s_lshl_b32 s65, s51, 7
  s_add_u32 m0, s68, 16384
  s_add_u32 s65, s65, s69
  buffer_load_dwordx4 v2, s[40:43], s65 offen lds
  s_add_u32 m0, s68, 17408
  s_add_u32 s65, s65, 10240
  buffer_load_dwordx4 v3, s[40:43], s65 offen lds
  s_add_u32 m0, s68, 18432
  s_add_u32 s65, s65, 10240
  buffer_load_dwordx4 v2, s[40:43], s65 offen lds
  s_add_u32 m0, s68, 19456
  s_add_u32 s65, s65, 10240
  buffer_load_dwordx4 v3, s[40:43], s65 offen lds
  s_add_u32 m0, s68, 20480
  s_add_u32 s65, s65, 10240
  buffer_load_dwordx4 v2, s[40:43], s65 offen lds
  s_add_u32 m0, s68, 21504
  s_add_u32 s65, s65, 10240
  buffer_load_dwordx4 v3, s[40:43], s65 offen lds
  s_add_u32 m0, s68, 22528
  s_add_u32 s65, s65, 10240
  buffer_load_dwordx4 v2, s[40:43], s65 offen lds
  s_add_u32 s51, s51, 1
  s_cmp_eq_u32 s51, 10
  s_cselect_b32 s51, 0, s51
  s_waitcnt vmcnt(7)
  s_barrier
  s_mul_i32 s64, s50, s48
  s_add_u32 m0, s66, 77824
  s_add_u32 s64, s64, s49
  buffer_load_dwordx4 v4, s[44:47], s64 offen lds
  s_add_u32 m0, s67, 77824
  s_nop 0
  buffer_load_dwordx4 v5, s[44:47], s64 offen lds
  s_add_u32 s50, s50, 1
  s_cmp_eq_u32 s50, 20
  s_cselect_b32 s50, 0, s50
  s_mul_i32 s64, s50, s48
  s_add_u32 m0, s66, 92160
  s_add_u32 s64, s64, s49
  buffer_load_dwordx4 v4, s[44:47], s64 offen lds
  s_add_u32 m0, s67, 92160
  s_nop 0
  buffer_load_dwordx4 v5, s[44:47], s64 offen lds
  s_add_u32 s50, s50, 1
  s_cmp_eq_u32 s50, 20
  s_cselect_b32 s50, 0, s50
  s_lshl_b32 s65, s51, 7
  s_add_u32 m0, s68, 32768
  s_add_u32 s65, s65, s69
  buffer_load_dwordx4 v2, s[40:43], s65 offen lds
  s_add_u32 m0, s68, 33792
  s_add_u32 s65, s65, 10240
  buffer_load_dwordx4 v3, s[40:43], s65 offen lds
  s_add_u32 m0, s68, 34816
  s_add_u32 s65, s65, 10240
  buffer_load_dwordx4 v2, s[40:43], s65 offen lds
  s_add_u32 m0, s68, 35840
  s_add_u32 s65, s65, 10240
  buffer_load_dwordx4 v3, s[40:43], s65 offen lds
  s_add_u32 m0, s68, 36864
  s_add_u32 s65, s65, 10240
  buffer_load_dwordx4 v2, s[40:43], s65 offen lds
  s_add_u32 m0, s68, 37888
  s_add_u32 s65, s65, 10240
  buffer_load_dwordx4 v3, s[40:43], s65 offen lds
  s_add_u32 m0, s68, 38912
  s_add_u32 s65, s65, 10240
  buffer_load_dwordx4 v2, s[40:43], s65 offen lds
  s_add_u32 s51, s51, 1
  s_cmp_eq_u32 s51, 10
  s_cselect_b32 s51, 0, s51
  s_mul_i32 s64, s50, s48
  s_add_u32 m0, s66, 106496
  s_add_u32 s64, s64, s49
  buffer_load_dwordx4 v4, s[44:47], s64 offen lds
  s_add_u32 m0, s67, 106496
  s_nop 0
  buffer_load_dwordx4 v5, s[44:47], s64 offen lds
  s_add_u32 s50, s50, 1
  s_cmp_eq_u32 s50, 20
  s_cselect_b32 s50, 0, s50
  s_waitcnt vmcnt(9)
  s_barrier
  s_mul_i32 s64, s50, s48
  s_add_u32 m0, s66, 120832
  s_add_u32 s64, s64, s49
  buffer_load_dwordx4 v4, s[44:47], s64 offen lds
  s_add_u32 m0, s67, 120832
  s_nop 0
  buffer_load_dwordx4 v5, s[44:47], s64 offen lds
  s_add_u32 s50, s50, 1
  s_cmp_eq_u32 s50, 20
  s_cselect_b32 s50, 0, s50
  s_lshl_b32 s65, s51, 7
  s_add_u32 m0, s68, 0
  s_add_u32 s65, s65, s69
  buffer_load_dwordx4 v2, s[40:43], s65 offen lds
  s_add_u32 m0, s68, 1024
  s_add_u32 s65, s65, 10240
  buffer_load_dwordx4 v3, s[40:43], s65 offen lds
  s_add_u32 m0, s68, 2048
  s_add_u32 s65, s65, 10240
  buffer_load_dwordx4 v2, s[40:43], s65 offen lds
  s_add_u32 m0, s68, 3072
  s_add_u32 s65, s65, 10240
  buffer_load_dwordx4 v3, s[40:43], s65 offen lds
  s_add_u32 m0, s68, 4096
  s_add_u32 s65, s65, 10240
  buffer_load_dwordx4 v2, s[40:43], s65 offen lds
  s_add_u32 m0, s68, 5120
  s_add_u32 s65, s65, 10240
  buffer_load_dwordx4 v3, s[40:43], s65 offen lds
  s_add_u32 m0, s68, 6144
  s_add_u32 s65, s65, 10240
  buffer_load_dwordx4 v2, s[40:43], s65 offen lds
  s_add_u32 s51, s51, 1
  s_cmp_eq_u32 s51, 10
  s_cselect_b32 s51, 0, s51
  s_mul_i32 s64, s50, s48
  s_add_u32 m0, s66, 49152
  s_add_u32 s64, s64, s49
  buffer_load_dwordx4 v4, s[44:47], s64 offen lds
  s_add_u32 m0, s67, 49152
  s_nop 0
  buffer_load_dwordx4 v5, s[44:47], s64 offen lds
  s_add_u32 s50, s50, 1
  s_cmp_eq_u32 s50, 20
  s_cselect_b32 s50, 0, s50
  s_waitcnt vmcnt(9)
  s_barrier
  s_mul_i32 s64, s50, s48
  s_add_u32 m0, s66, 63488
  s_add_u32 s64, s64, s49
  buffer_load_dwordx4 v4, s[44:47], s64 offen lds
  s_add_u32 m0, s67, 63488
  s_nop 0
  buffer_load_dwordx4 v5, s[44:47], s64 offen lds
  s_add_u32 s50, s50, 1
  s_cmp_eq_u32 s50, 20
  s_cselect_b32 s50, 0, s50
  s_lshl_b32 s65, s51, 7
  s_add_u32 m0, s68, 16384
  s_add_u32 s65, s65, s69
  buffer_load_dwordx4 v2, s[40:43], s65 offen lds
  s_add_u32 m0, s68, 17408
  s_add_u32 s65, s65, 10240
  buffer_load_dwordx4 v3, s[40:43], s65 offen lds
  s_add_u32 m0, s68, 18432
  s_add_u32 s65, s65, 10240
  buffer_load_dwordx4 v2, s[40:43], s65 offen lds
  s_add_u32 m0, s68, 19456
  s_add_u32 s65, s65, 10240
  buffer_load_dwordx4 v3, s[40:43], s65 offen lds
  s_add_u32 m0, s68, 20480
  s_add_u32 s65, s65, 10240
  buffer_load_dwordx4 v2, s[40:43], s65 offen lds
  s_add_u32 m0, s68, 21504
  s_add_u32 s65, s65, 10240
  buffer_load_dwordx4 v3, s[40:43], s65 offen lds
  s_add_u32 m0, s68, 22528
  s_add_u32 s65, s65, 10240
  buffer_load_dwordx4 v2, s[40:43], s65 offen lds
  s_add_u32 s51, s51, 1
  s_cmp_eq_u32 s51, 10
  s_cselect_b32 s51, 0, s51
  s_mul_i32 s64, s50, s48
  s_add_u32 m0, s66, 77824
  s_add_u32 s64, s64, s49
  buffer_load_dwordx4 v4, s[44:47], s64 offen lds
  s_add_u32 m0, s67, 77824
  s_nop 0
  buffer_load_dwordx4 v5, s[44:47], s64 offen lds
  s_add_u32 s50, s50, 1
  s_cmp_eq_u32 s50, 20
  s_cselect_b32 s50, 0, s50
  s_waitcnt vmcnt(9)
  s_barrier
  s_mul_i32 s64, s50, s48
  s_add_u32 m0, s66, 92160
  s_add_u32 s64, s64, s49
  buffer_load_dwordx4 v4, s[44:47], s64 offen lds
  s_add_u32 m0, s67, 92160
  s_nop 0
  buffer_load_dwordx4 v5, s[44:47], s64 offen lds
  s_add_u32 s50, s50, 1
  s_cmp_eq_u32 s50, 20
  s_cselect_b32 s50, 0, s50
  s_lshl_b32 s65, s51, 7
  s_add_u32 m0, s68, 32768
  s_add_u32 s65, s65, s69
  buffer_load_dwordx4 v2, s[40:43], s65 offen lds
  s_add_u32 m0, s68, 33792
  s_add_u32 s65, s65, 10240
  buffer_load_dwordx4 v3, s[40:43], s65 offen lds
  s_add_u32 m0, s68, 34816
  s_add_u32 s65, s65, 10240
  buffer_load_dwordx4 v2, s[40:43], s65 offen lds
  s_add_u32 m0, s68, 35840
  s_add_u32 s65, s65, 10240
  buffer_load_dwordx4 v3, s[40:43], s65 offen lds
  s_add_u32 m0, s68, 36864
  s_add_u32 s65, s65, 10240
  buffer_load_dwordx4 v2, s[40:43], s65 offen lds
  s_add_u32 m0, s68, 37888
  s_add_u32 s65, s65, 10240
  buffer_load_dwordx4 v3, s[40:43], s65 offen lds
  s_add_u32 m0, s68, 38912
  s_add_u32 s65, s65, 10240
  buffer_load_dwordx4 v2, s[40:43], s65 offen lds
  s_add_u32 s51, s51, 1
  s_cmp_eq_u32 s51, 10
  s_cselect_b32 s51, 0, s51
  s_mul_i32 s64, s50, s48
  s_add_u32 m0, s66, 106496
  s_add_u32 s64, s64, s49
  buffer_load_dwordx4 v4, s[44:47], s64 offen lds
  s_add_u32 m0, s67, 106496
  s_nop 0
  buffer_load_dwordx4 v5, s[44:47], s64 offen lds
  s_add_u32 s50, s50, 1
  s_cmp_eq_u32 s50, 20
  s_cselect_b32 s50, 0, s50
  s_waitcnt vmcnt(9)
  s_barrier
  s_mul_i32 s64, s50, s48
  s_add_u32 m0, s66, 120832
  s_add_u32 s64, s64, s49
  buffer_load_dwordx4 v4, s[44:47], s64 offen lds
  s_add_u32 m0, s67, 120832
  s_nop 0
  buffer_load_dwordx4 v5, s[44:47], s64 offen lds
  s_add_u32 s50, s50, 1
  s_cmp_eq_u32 s50, 20
  s_cselect_b32 s50, 0, s50
  s_lshl_b32 s65, s51, 7
  s_add_u32 m0, s68, 0
  s_add_u32 s65, s65, s69
  buffer_load_dwordx4 v2, s[40:43], s65 offen lds
  s_add_u32 m0, s68, 1024
  s_add_u32 s65, s65, 10240
  buffer_load_dwordx4 v3, s[40:43], s65 offen lds
  s_add_u32 m0, s68, 2048
  s_add_u32 s65, s65, 10240
  buffer_load_dwordx4 v2, s[40:43], s65 offen lds
  s_add_u32 m0, s68, 3072
  s_add_u32 s65, s65, 10240
  buffer_load_dwordx4 v3, s[40:43], s65 offen lds
  s_add_u32 m0, s68, 4096
  s_add_u32 s65, s65, 10240
  buffer_load_dwordx4 v2, s[40:43], s65 offen lds
  s_add_u32 m0, s68, 5120
  s_add_u32 s65, s65, 10240
  buffer_load_dwordx4 v3, s[40:43], s65 offen lds
  s_add_u32 m0, s68, 6144
  s_add_u32 s65, s65, 10240
  buffer_load_dwordx4 v2, s[40:43], s65 offen lds
  s_add_u32 s51, s51, 1
  s_cmp_eq_u32 s51, 10
  s_cselect_b32 s51, 0, s51
  s_mul_i32 s64, s50, s48
  s_add_u32 m0, s66, 49152
  s_add_u32 s64, s64, s49
  buffer_load_dwordx4 v4, s[44:47], s64 offen lds
  s_add_u32 m0, s67, 49152
  s_nop 0
  buffer_load_dwordx4 v5, s[44:47], s64 offen lds
  s_add_u32 s50, s50, 1
  s_cmp_eq_u32 s50, 20
  s_cselect_b32 s50, 0, s50
  v_lshlrev_b32 v254, 4, v0
  v_mov_b32 v255, v0
  s_xor_b32 s30, s26, 4
  s_mul_i32 s30, s30, 20480
  s_mov_b32 s33, -208
  v_and_b32 v44, 15, v255
  v_lshrrev_b32 v45, 4, v255
  s_add_u32 s72, s30, 13312
  v_mul_u32_u24 v47, 336, v45
  v_add_u32 v47, s72, v47
  v_add_u32 v62, s30, v254
  s_add_u32 s72, s72, 7056
  v_mov_b32 v57, s72
  v_subrev_u32 v58, 1344, v57
  v_subrev_u32 v59, 2688, v57
  v_subrev_u32 v60, 4032, v57
  v_subrev_u32 v61, 5376, v57
  v_add_u32 v50, 0, v44
  v_mul_u32_u24 v48, 3277, v50
  v_lshrrev_b32 v48, 16, v48
  v_lshl_add_u32 v50, v50, 4, v47
  v_mad_i32_i24 v49, v48, s33, v50
  v_mad_i32_i24 v48, v48, -5, v45
  v_add_u32 v52, 0, v48
  v_add_u32 v53, 4, v48
  v_cmp_gt_u32 s[96:97], 5, v52
  v_cmp_gt_u32 s[98:99], 5, v53
  s_nop 0
  v_cndmask_b32 v20, v57, v49, s[96:97]
  v_cndmask_b32 v21, v58, v49, s[98:99]
  s_waitcnt vmcnt(9)
  s_barrier
  s_mul_i32 s64, s50, s48
  s_add_u32 m0, s66, 63488
  s_add_u32 s64, s64, s49
  buffer_load_dwordx4 v4, s[44:47], s64 offen lds
  s_add_u32 m0, s67, 63488
  s_nop 0
  buffer_load_dwordx4 v5, s[44:47], s64 offen lds
  s_add_u32 s50, s50, 1
  s_cmp_eq_u32 s50, 20
  s_cselect_b32 s50, 0, s50
  s_lshl_b32 s65, s51, 7
  s_add_u32 m0, s68, 16384
  s_add_u32 s65, s65, s69
  buffer_load_dwordx4 v2, s[40:43], s65 offen lds
  s_add_u32 m0, s68, 17408
  s_add_u32 s65, s65, 10240
  buffer_load_dwordx4 v3, s[40:43], s65 offen lds
  s_add_u32 m0, s68, 18432
  s_add_u32 s65, s65, 10240
  buffer_load_dwordx4 v2, s[40:43], s65 offen lds
  s_add_u32 m0, s68, 19456
  s_add_u32 s65, s65, 10240
  buffer_load_dwordx4 v3, s[40:43], s65 offen lds
  s_add_u32 m0, s68, 20480
  s_add_u32 s65, s65, 10240
  buffer_load_dwordx4 v2, s[40:43], s65 offen lds
  s_add_u32 m0, s68, 21504
  s_add_u32 s65, s65, 10240
  buffer_load_dwordx4 v3, s[40:43], s65 offen lds
  s_add_u32 m0, s68, 22528
  s_add_u32 s65, s65, 10240
  buffer_load_dwordx4 v2, s[40:43], s65 offen lds
  s_add_u32 s51, s51, 1
  s_cmp_eq_u32 s51, 10
  s_cselect_b32 s51, 0, s51
  s_mul_i32 s64, s50, s48
  s_add_u32 m0, s66, 77824
  s_add_u32 s64, s64, s49
  buffer_load_dwordx4 v4, s[44:47], s64 offen lds
  s_add_u32 m0, s67, 77824
  s_nop 0
  buffer_load_dwordx4 v5, s[44:47], s64 offen lds
  s_add_u32 s50, s50, 1
  s_cmp_eq_u32 s50, 20
  s_cselect_b32 s50, 0, s50
  v_add_u32 v50, 16, v44
  v_mul_u32_u24 v48, 3277, v50
  v_lshrrev_b32 v48, 16, v48
  v_lshl_add_u32 v50, v50, 4, v47
  v_mad_i32_i24 v49, v48, s33, v50
  v_mad_i32_i24 v48, v48, -5, v45
  v_add_u32 v52, 0, v48
  v_add_u32 v53, 4, v48
  v_add_u32 v54, 8, v48
  v_cmp_gt_u32 s[96:97], 5, v52
  v_cmp_gt_u32 s[98:99], 5, v53
  v_cmp_gt_u32 s[100:101], 5, v54
  s_nop 0
  v_cndmask_b32 v22, v57, v49, s[96:97]
  v_cndmask_b32 v23, v58, v49, s[98:99]
  v_cndmask_b32 v24, v59, v49, s[100:101]
  v_add_u32 v50, 32, v44
  v_mul_u32_u24 v48, 3277, v50
  v_lshrrev_b32 v48, 16, v48
  v_lshl_add_u32 v50, v50, 4, v47
  v_mad_i32_i24 v49, v48, s33, v50
  v_mad_i32_i24 v48, v48, -5, v45
  v_add_u32 v52, 4, v48
  v_add_u32 v53, 8, v48
  v_add_u32 v54, 12, v48
  v_cmp_gt_u32 s[96:97], 5, v52
  v_cmp_gt_u32 s[98:99], 5, v53
  v_cmp_gt_u32 s[100:101], 5, v54
  s_nop 0
  v_cndmask_b32 v25, v58, v49, s[96:97]
  v_cndmask_b32 v26, v59, v49, s[98:99]
  v_cndmask_b32 v27, v60, v49, s[100:101]
  s_waitcnt vmcnt(9)
  s_barrier
  s_mul_i32 s64, s50, s48
  s_add_u32 m0, s66, 92160
  s_add_u32 s64, s64, s49
  buffer_load_dwordx4 v4, s[44:47], s64 offen lds
  s_add_u32 m0, s67, 92160
  s_nop 0
  buffer_load_dwordx4 v5, s[44:47], s64 offen lds
  s_add_u32 s50, s50, 1
  s_cmp_eq_u32 s50, 20
  s_cselect_b32 s50, 0, s50
  s_lshl_b32 s65, s51, 7
  s_add_u32 m0, s68, 32768
  s_add_u32 s65, s65, s69
  buffer_load_dwordx4 v2, s[40:43], s65 offen lds
  s_add_u32 m0, s68, 33792
  s_add_u32 s65, s65, 10240
  buffer_load_dwordx4 v3, s[40:43], s65 offen lds
  s_add_u32 m0, s68, 34816
  s_add_u32 s65, s65, 10240
  buffer_load_dwordx4 v2, s[40:43], s65 offen lds
  s_add_u32 m0, s68, 35840
  s_add_u32 s65, s65, 10240
  buffer_load_dwordx4 v3, s[40:43], s65 offen lds
  s_add_u32 m0, s68, 36864
  s_add_u32 s65, s65, 10240
  buffer_load_dwordx4 v2, s[40:43], s65 offen lds
  s_add_u32 m0, s68, 37888
  s_add_u32 s65, s65, 10240
  buffer_load_dwordx4 v3, s[40:43], s65 offen lds
  s_add_u32 m0, s68, 38912
  s_add_u32 s65, s65, 10240
  buffer_load_dwordx4 v2, s[40:43], s65 offen lds
  s_add_u32 s51, s51, 1
  s_cmp_eq_u32 s51, 10
  s_cselect_b32 s51, 0, s51
  s_mul_i32 s64, s50, s48
  s_add_u32 m0, s66, 106496
  s_add_u32 s64, s64, s49
  buffer_load_dwordx4 v4, s[44:47], s64 offen lds
  s_add_u32 m0, s67, 106496
  s_nop 0
  buffer_load_dwordx4 v5, s[44:47], s64 offen lds
  s_add_u32 s50, s50, 1
  s_cmp_eq_u32 s50, 20
  s_cselect_b32 s50, 0, s50
  v_add_u32 v50, 48, v44
  v_mul_u32_u24 v48, 3277, v50
  v_lshrrev_b32 v48, 16, v48
  v_lshl_add_u32 v50, v50, 4, v47
  v_mad_i32_i24 v49, v48, s33, v50
  v_mad_i32_i24 v48, v48, -5, v45
  v_add_u32 v52, 8, v48
  v_add_u32 v53, 12, v48
  v_add_u32 v54, 16, v48
  v_cmp_gt_u32 s[96:97], 5, v52
  v_cmp_gt_u32 s[98:99], 5, v53
  v_cmp_gt_u32 s[100:101], 5, v54
  s_nop 0
  v_cndmask_b32 v28, v59, v49, s[96:97]
  v_cndmask_b32 v29, v60, v49, s[98:99]
  v_cndmask_b32 v31, v61, v49, s[100:101]
  v_add_u32 v50, 64, v44
  v_mul_u32_u24 v48, 3277, v50
  v_lshrrev_b32 v48, 16, v48
  v_lshl_add_u32 v50, v50, 4, v47
  v_mad_i32_i24 v49, v48, s33, v50
  v_mad_i32_i24 v48, v48, -5, v45
  v_add_u32 v52, 12, v48
  v_add_u32 v53, 16, v48
  v_cmp_gt_u32 s[96:97], 5, v52
  v_cmp_gt_u32 s[98:99], 5, v53
  s_nop 0
  v_cndmask_b32 v30, v60, v49, s[96:97]
  v_cndmask_b32 v32, v61, v49, s[98:99]
  s_waitcnt vmcnt(9)
  s_barrier
  s_mul_i32 s64, s50, s48
  s_add_u32 m0, s66, 120832
  s_add_u32 s64, s64, s49
  buffer_load_dwordx4 v4, s[44:47], s64 offen lds
  s_add_u32 m0, s67, 120832
  s_nop 0
  buffer_load_dwordx4 v5, s[44:47], s64 offen lds
  s_add_u32 s50, s50, 1
  s_cmp_eq_u32 s50, 20
  s_cselect_b32 s50, 0, s50
  s_lshl_b32 s65, s51, 7
  s_add_u32 m0, s68, 0
  s_add_u32 s65, s65, s69
  buffer_load_dwordx4 v2, s[40:43], s65 offen lds
  s_add_u32 m0, s68, 1024
  s_add_u32 s65, s65, 10240
  buffer_load_dwordx4 v3, s[40:43], s65 offen lds
  s_add_u32 m0, s68, 2048
  s_add_u32 s65, s65, 10240
  buffer_load_dwordx4 v2, s[40:43], s65 offen lds
  s_add_u32 m0, s68, 3072
  s_add_u32 s65, s65, 10240
  buffer_load_dwordx4 v3, s[40:43], s65 offen lds
  s_add_u32 m0, s68, 4096
  s_add_u32 s65, s65, 10240
  buffer_load_dwordx4 v2, s[40:43], s65 offen lds
  s_add_u32 m0, s68, 5120
  s_add_u32 s65, s65, 10240
  buffer_load_dwordx4 v3, s[40:43], s65 offen lds
  s_add_u32 m0, s68, 6144
  s_add_u32 s65, s65, 10240
  buffer_load_dwordx4 v2, s[40:43], s65 offen lds
  s_add_u32 s51, s51, 1
  s_cmp_eq_u32 s51, 10
  s_cselect_b32 s51, 0, s51
  s_mul_i32 s64, s50, s48
  s_add_u32 m0, s66, 49152
  s_add_u32 s64, s64, s49
  buffer_load_dwordx4 v4, s[44:47], s64 offen lds
  s_add_u32 m0, s67, 49152
  s_nop 0
  buffer_load_dwordx4 v5, s[44:47], s64 offen lds
  s_add_u32 s50, s50, 1
  s_cmp_eq_u32 s50, 20
  s_cselect_b32 s50, 0, s50
  v_and_b32 v48, 3, v255
  v_mul_u32_u24 v49, 112, v48
  v_add_u32 v50, 320, v47
  v_add_u32 v49, v49, v50
  v_mad_i32_i24 v48, v48, -5, v45
  v_add_u32 v52, 0, v48
  v_add_u32 v53, 4, v48
  v_add_u32 v54, 8, v48
  v_add_u32 v55, 12, v48
  v_add_u32 v56, 16, v48
  v_cmp_gt_u32 s[96:97], 5, v52
  v_cmp_gt_u32 s[98:99], 5, v53
  v_cmp_gt_u32 s[100:101], 5, v54
  v_cmp_gt_u32 s[52:53], 5, v55
  v_cmp_gt_u32 s[54:55], 5, v56
  s_nop 0
  v_cndmask_b32 v33, v57, v49, s[96:97]
  v_cndmask_b32 v34, v58, v49, s[98:99]
  v_cndmask_b32 v35, v59, v49, s[100:101]
  v_cndmask_b32 v36, v60, v49, s[52:53]
  v_cndmask_b32 v37, v61, v49, s[54:55]
  s_waitcnt vmcnt(9)
  s_barrier
  s_mul_i32 s64, s50, s48
  s_add_u32 m0, s66, 63488
  s_add_u32 s64, s64, s49
  buffer_load_dwordx4 v4, s[44:47], s64 offen lds
  s_add_u32 m0, s67, 63488
  s_nop 0
  buffer_load_dwordx4 v5, s[44:47], s64 offen lds
  s_add_u32 s50, s50, 1
  s_cmp_eq_u32 s50, 20
  s_cselect_b32 s50, 0, s50
  s_waitcnt vmcnt(0)
  s_barrier
  s_branch L_ldj_12
L_ld4_11:
  s_waitcnt vmcnt(0)
  s_barrier
  s_lshl_b32 s65, s51, 7
  s_add_u32 m0, s68, 16384
  s_add_u32 s65, s65, s69
  buffer_load_dwordx4 v2, s[40:43], s65 offen lds
  s_add_u32 m0, s68, 17408
  s_add_u32 s65, s65, 10240
  buffer_load_dwordx4 v3, s[40:43], s65 offen lds
  s_add_u32 m0, s68, 18432
  s_add_u32 s65, s65, 10240
  buffer_load_dwordx4 v2, s[40:43], s65 offen lds
  s_add_u32 m0, s68, 19456
  s_add_u32 s65, s65, 10240
  buffer_load_dwordx4 v3, s[40:43], s65 offen lds
  s_add_u32 m0, s68, 20480
  s_add_u32 s65, s65, 10240
  buffer_load_dwordx4 v2, s[40:43], s65 offen lds
  s_add_u32 m0, s68, 21504
  s_add_u32 s65, s65, 10240
  buffer_load_dwordx4 v3, s[40:43], s65 offen lds
  s_add_u32 m0, s68, 22528
  s_add_u32 s65, s65, 10240
  buffer_load_dwordx4 v2, s[40:43], s65 offen lds
  s_add_u32 s51, s51, 1
  s_cmp_eq_u32 s51, 10
  s_cselect_b32 s51, 0, s51
  s_barrier
  s_lshl_b32 s65, s51, 7
  s_add_u32 m0, s68, 32768
  s_add_u32 s65, s65, s69
  buffer_load_dwordx4 v2, s[40:43], s65 offen lds
  s_add_u32 m0, s68, 33792
  s_add_u32 s65, s65, 10240
  buffer_load_dwordx4 v3, s[40:43], s65 offen lds
  s_add_u32 m0, s68, 34816
  s_add_u32 s65, s65, 10240
  buffer_load_dwordx4 v2, s[40:43], s65 offen lds
  s_add_u32 m0, s68, 35840
  s_add_u32 s65, s65, 10240
  buffer_load_dwordx4 v3, s[40:43], s65 offen lds
  s_add_u32 m0, s68, 36864
  s_add_u32 s65, s65, 10240
  buffer_load_dwordx4 v2, s[40:43], s65 offen lds
  s_add_u32 m0, s68, 37888
  s_add_u32 s65, s65, 10240
  buffer_load_dwordx4 v3, s[40:43], s65 offen lds
  s_add_u32 m0, s68, 38912
  s_add_u32 s65, s65, 10240
  buffer_load_dwordx4 v2, s[40:43], s65 offen lds
  s_add_u32 s51, s51, 1
  s_cmp_eq_u32 s51, 10
  s_cselect_b32 s51, 0, s51
  s_waitcnt vmcnt(7)
  s_barrier
  s_lshl_b32 s65, s51, 7
  s_add_u32 m0, s68, 0
  s_add_u32 s65, s65, s69
  buffer_load_dwordx4 v2, s[40:43], s65 offen lds
  s_add_u32 m0, s68, 1024
  s_add_u32 s65, s65, 10240
  buffer_load_dwordx4 v3, s[40:43], s65 offen lds
  s_add_u32 m0, s68, 2048
  s_add_u32 s65, s65, 10240
  buffer_load_dwordx4 v2, s[40:43], s65 offen lds
  s_add_u32 m0, s68, 3072
  s_add_u32 s65, s65, 10240
  buffer_load_dwordx4 v3, s[40:43], s65 offen lds
  s_add_u32 m0, s68, 4096
  s_add_u32 s65, s65, 10240
  buffer_load_dwordx4 v2, s[40:43], s65 offen lds
  s_add_u32 m0, s68, 5120
  s_add_u32 s65, s65, 10240
  buffer_load_dwordx4 v3, s[40:43], s65 offen lds
  s_add_u32 m0, s68, 6144
  s_add_u32 s65, s65, 10240
  buffer_load_dwordx4 v2, s[40:43], s65 offen lds
  s_add_u32 s51, s51, 1
  s_cmp_eq_u32 s51, 10
  s_cselect_b32 s51, 0, s51
  s_waitcnt vmcnt(7)
  s_barrier
  s_lshl_b32 s65, s51, 7
  s_add_u32 m0, s68, 16384
  s_add_u32 s65, s65, s69
  buffer_load_dwordx4 v2, s[40:43], s65 offen lds
  s_add_u32 m0, s68, 17408
  s_add_u32 s65, s65, 10240
  buffer_load_dwordx4 v3, s[40:43], s65 offen lds
  s_add_u32 m0, s68, 18432
  s_add_u32 s65, s65, 10240
  buffer_load_dwordx4 v2, s[40:43], s65 offen lds
  s_add_u32 m0, s68, 19456
  s_add_u32 s65, s65, 10240
  buffer_load_dwordx4 v3, s[40:43], s65 offen lds
  s_add_u32 m0, s68, 20480
  s_add_u32 s65, s65, 10240
  buffer_load_dwordx4 v2, s[40:43], s65 offen lds
  s_add_u32 m0, s68, 21504
  s_add_u32 s65, s65, 10240
  buffer_load_dwordx4 v3, s[40:43], s65 offen lds
  s_add_u32 m0, s68, 22528
  s_add_u32 s65, s65, 10240
  buffer_load_dwordx4 v2, s[40:43], s65 offen lds
  s_add_u32 s51, s51, 1
  s_cmp_eq_u32 s51, 10
  s_cselect_b32 s51, 0, s51
  s_waitcnt vmcnt(7)
  s_barrier
  s_lshl_b32 s65, s51, 7
  s_add_u32 m0, s68, 32768
  s_add_u32 s65, s65, s69
  buffer_load_dwordx4 v2, s[40:43], s65 offen lds
  s_add_u32 m0, s68, 33792
  s_add_u32 s65, s65, 10240
  buffer_load_dwordx4 v3, s[40:43], s65 offen lds
  s_add_u32 m0, s68, 34816
  s_add_u32 s65, s65, 10240
  buffer_load_dwordx4 v2, s[40:43], s65 offen lds
  s_add_u32 m0, s68, 35840
  s_add_u32 s65, s65, 10240
  buffer_load_dwordx4 v3, s[40:43], s65 offen lds
  s_add_u32 m0, s68, 36864
  s_add_u32 s65, s65, 10240
  buffer_load_dwordx4 v2, s[40:43], s65 offen lds
  s_add_u32 m0, s68, 37888
  s_add_u32 s65, s65, 10240
  buffer_load_dwordx4 v3, s[40:43], s65 offen lds
  s_add_u32 m0, s68, 38912
  s_add_u32 s65, s65, 10240
  buffer_load_dwordx4 v2, s[40:43], s65 offen lds
  s_add_u32 s51, s51, 1
  s_cmp_eq_u32 s51, 10
  s_cselect_b32 s51, 0, s51
  s_waitcnt vmcnt(7)
  s_barrier
  s_lshl_b32 s65, s51, 7
  s_add_u32 m0, s68, 0
  s_add_u32 s65, s65, s69
  buffer_load_dwordx4 v2, s[40:43], s65 offen lds
  s_add_u32 m0, s68, 1024
  s_add_u32 s65, s65, 10240
  buffer_load_dwordx4 v3, s[40:43], s65 offen lds
  s_add_u32 m0, s68, 2048
  s_add_u32 s65, s65, 10240
  buffer_load_dwordx4 v2, s[40:43], s65 offen lds
  s_add_u32 m0, s68, 3072
  s_add_u32 s65, s65, 10240
  buffer_load_dwordx4 v3, s[40:43], s65 offen lds
  s_add_u32 m0, s68, 4096
  s_add_u32 s65, s65, 10240
  buffer_load_dwordx4 v2, s[40:43], s65 offen lds
  s_add_u32 m0, s68, 5120
  s_add_u32 s65, s65, 10240
  buffer_load_dwordx4 v3, s[40:43], s65 offen lds
  s_add_u32 m0, s68, 6144
  s_add_u32 s65, s65, 10240
  buffer_load_dwordx4 v2, s[40:43], s65 offen lds
  s_add_u32 s51, s51, 1
  s_cmp_eq_u32 s51, 10
  s_cselect_b32 s51, 0, s51
  v_lshlrev_b32 v254, 4, v0
  v_mov_b32 v255, v0
  s_xor_b32 s30, s26, 4
  s_mul_i32 s30, s30, 20480
  s_mov_b32 s33, -208
  v_and_b32 v44, 15, v255
  v_lshrrev_b32 v45, 4, v255
  s_add_u32 s72, s30, 13312
  v_mul_u32_u24 v47, 336, v45
  v_add_u32 v47, s72, v47
  v_add_u32 v62, s30, v254
  s_add_u32 s72, s72, 7056
  v_mov_b32 v57, s72
  v_subrev_u32 v58, 1344, v57
  v_subrev_u32 v59, 2688, v57
  v_subrev_u32 v60, 4032, v57
  v_subrev_u32 v61, 5376, v57
  v_add_u32 v50, 0, v44
  v_mul_u32_u24 v48, 3277, v50
  v_lshrrev_b32 v48, 16, v48
  v_lshl_add_u32 v50, v50, 4, v47
  v_mad_i32_i24 v49, v48, s33, v50
  v_mad_i32_i24 v48, v48, -5, v45
  v_add_u32 v52, 0, v48
  v_add_u32 v53, 4, v48
  v_cmp_gt_u32 s[96:97], 5, v52
  v_cmp_gt_u32 s[98:99], 5, v53
  s_nop 0
  v_cndmask_b32 v20, v57, v49, s[96:97]
  v_cndmask_b32 v21, v58, v49, s[98:99]
  s_waitcnt vmcnt(7)
  s_barrier
  s_lshl_b32 s65, s51, 7
  s_add_u32 m0, s68, 16384
  s_add_u32 s65, s65, s69
  buffer_load_dwordx4 v2, s[40:43], s65 offen lds
  s_add_u32 m0, s68, 17408
  s_add_u32 s65, s65, 10240
  buffer_load_dwordx4 v3, s[40:43], s65 offen lds
  s_add_u32 m0, s68, 18432
  s_add_u32 s65, s65, 10240
  buffer_load_dwordx4 v2, s[40:43], s65 offen lds
  s_add_u32 m0, s68, 19456
  s_add_u32 s65, s65, 10240
  buffer_load_dwordx4 v3, s[40:43], s65 offen lds
  s_add_u32 m0, s68, 20480
  s_add_u32 s65, s65, 10240
  buffer_load_dwordx4 v2, s[40:43], s65 offen lds
  s_add_u32 m0, s68, 21504
  s_add_u32 s65, s65, 10240
  buffer_load_dwordx4 v3, s[40:43], s65 offen lds
  s_add_u32 m0, s68, 22528
  s_add_u32 s65, s65, 10240
  buffer_load_dwordx4 v2, s[40:43], s65 offen lds
  s_add_u32 s51, s51, 1
  s_cmp_eq_u32 s51, 10
  s_cselect_b32 s51, 0, s51
  v_add_u32 v50, 16, v44
  v_mul_u32_u24 v48, 3277, v50
  v_lshrrev_b32 v48, 16, v48
  v_lshl_add_u32 v50, v50, 4, v47
  v_mad_i32_i24 v49, v48, s33, v50
  v_mad_i32_i24 v48, v48, -5, v45
  v_add_u32 v52, 0, v48
  v_add_u32 v53, 4, v48
  v_add_u32 v54, 8, v48
  v_cmp_gt_u32 s[96:97], 5, v52
  v_cmp_gt_u32 s[98:99], 5, v53
  v_cmp_gt_u32 s[100:101], 5, v54
  s_nop 0
  v_cndmask_b32 v22, v57, v49, s[96:97]
  v_cndmask_b32 v23, v58, v49, s[98:99]
  v_cndmask_b32 v24, v59, v49, s[100:101]
  v_add_u32 v50, 32, v44
  v_mul_u32_u24 v48, 3277, v50
  v_lshrrev_b32 v48, 16, v48
  v_lshl_add_u32 v50, v50, 4, v47
  v_mad_i32_i24 v49, v48, s33, v50
  v_mad_i32_i24 v48, v48, -5, v45
  v_add_u32 v52, 4, v48
  v_add_u32 v53, 8, v48
  v_add_u32 v54, 12, v48
  v_cmp_gt_u32 s[96:97], 5, v52
  v_cmp_gt_u32 s[98:99], 5, v53
  v_cmp_gt_u32 s[100:101], 5, v54
  s_nop 0
  v_cndmask_b32 v25, v58, v49, s[96:97]
  v_cndmask_b32 v26, v59, v49, s[98:99]
  v_cndmask_b32 v27, v60, v49, s[100:101]
  s_waitcnt vmcnt(7)
  s_barrier
  s_lshl_b32 s65, s51, 7
  s_add_u32 m0, s68, 32768
  s_add_u32 s65, s65, s69
  buffer_load_dwordx4 v2, s[40:43], s65 offen lds
  s_add_u32 m0, s68, 33792
  s_add_u32 s65, s65, 10240
  buffer_load_dwordx4 v3, s[40:43], s65 offen lds
  s_add_u32 m0, s68, 34816
  s_add_u32 s65, s65, 10240
  buffer_load_dwordx4 v2, s[40:43], s65 offen lds
  s_add_u32 m0, s68, 35840
  s_add_u32 s65, s65, 10240
  buffer_load_dwordx4 v3, s[40:43], s65 offen lds
  s_add_u32 m0, s68, 36864
  s_add_u32 s65, s65, 10240
  buffer_load_dwordx4 v2, s[40:43], s65 offen lds
  s_add_u32 m0, s68, 37888
  s_add_u32 s65, s65, 10240
  buffer_load_dwordx4 v3, s[40:43], s65 offen lds
  s_add_u32 m0, s68, 38912
  s_add_u32 s65, s65, 10240
  buffer_load_dwordx4 v2, s[40:43], s65 offen lds
  s_add_u32 s51, s51, 1
  s_cmp_eq_u32 s51, 10
  s_cselect_b32 s51, 0, s51
  v_add_u32 v50, 48, v44
  v_mul_u32_u24 v48, 3277, v50
  v_lshrrev_b32 v48, 16, v48
  v_lshl_add_u32 v50, v50, 4, v47
  v_mad_i32_i24 v49, v48, s33, v50
  v_mad_i32_i24 v48, v48, -5, v45
  v_add_u32 v52, 8, v48
  v_add_u32 v53, 12, v48
  v_add_u32 v54, 16, v48
  v_cmp_gt_u32 s[96:97], 5, v52
  v_cmp_gt_u32 s[98:99], 5, v53
  v_cmp_gt_u32 s[100:101], 5, v54
  s_nop 0
  v_cndmask_b32 v28, v59, v49, s[96:97]
  v_cndmask_b32 v29, v60, v49, s[98:99]
  v_cndmask_b32 v31, v61, v49, s[100:101]
  v_add_u32 v50, 64, v44
  v_mul_u32_u24 v48, 3277, v50
  v_lshrrev_b32 v48, 16, v48
  v_lshl_add_u32 v50, v50, 4, v47
  v_mad_i32_i24 v49, v48, s33, v50
  v_mad_i32_i24 v48, v48, -5, v45
  v_add_u32 v52, 12, v48
  v_add_u32 v53, 16, v48
  v_cmp_gt_u32 s[96:97], 5, v52
  v_cmp_gt_u32 s[98:99], 5, v53
  s_nop 0
  v_cndmask_b32 v30, v60, v49, s[96:97]
  v_cndmask_b32 v32, v61, v49, s[98:99]
  s_waitcnt vmcnt(7)
  s_barrier
  s_lshl_b32 s65, s51, 7
  s_add_u32 m0, s68, 0
  s_add_u32 s65, s65, s69
  buffer_load_dwordx4 v2, s[40:43], s65 offen lds
  s_add_u32 m0, s68, 1024
  s_add_u32 s65, s65, 10240
  buffer_load_dwordx4 v3, s[40:43], s65 offen lds
  s_add_u32 m0, s68, 2048
  s_add_u32 s65, s65, 10240
  buffer_load_dwordx4 v2, s[40:43], s65 offen lds
  s_add_u32 m0, s68, 3072
  s_add_u32 s65, s65, 10240
  buffer_load_dwordx4 v3, s[40:43], s65 offen lds
  s_add_u32 m0, s68, 4096
  s_add_u32 s65, s65, 10240
  buffer_load_dwordx4 v2, s[40:43], s65 offen lds
  s_add_u32 m0, s68, 5120
  s_add_u32 s65, s65, 10240
  buffer_load_dwordx4 v3, s[40:43], s65 offen lds
  s_add_u32 m0, s68, 6144
  s_add_u32 s65, s65, 10240
  buffer_load_dwordx4 v2, s[40:43], s65 offen lds
  s_add_u32 s51, s51, 1
  s_cmp_eq_u32 s51, 10
  s_cselect_b32 s51, 0, s51
  v_and_b32 v48, 3, v255
  v_mul_u32_u24 v49, 112, v48
  v_add_u32 v50, 320, v47
  v_add_u32 v49, v49, v50
  v_mad_i32_i24 v48, v48, -5, v45
  v_add_u32 v52, 0, v48
  v_add_u32 v53, 4, v48
  v_add_u32 v54, 8, v48
  v_add_u32 v55, 12, v48
  v_add_u32 v56, 16, v48
  v_cmp_gt_u32 s[96:97], 5, v52
  v_cmp_gt_u32 s[98:99], 5, v53
  v_cmp_gt_u32 s[100:101], 5, v54
  v_cmp_gt_u32 s[52:53], 5, v55
  v_cmp_gt_u32 s[54:55], 5, v56
  s_nop 0
  v_cndmask_b32 v33, v57, v49, s[96:97]
  v_cndmask_b32 v34, v58, v49, s[98:99]
  v_cndmask_b32 v35, v59, v49, s[100:101]
  v_cndmask_b32 v36, v60, v49, s[52:53]
  v_cndmask_b32 v37, v61, v49, s[54:55]
  s_waitcnt vmcnt(7)
  s_barrier
  s_waitcnt vmcnt(0)
  s_barrier
L_ldj_12:
  s_setprio 0
  s_bfe_u32 s62, s2, 0x20001
  s_bfe_u32 s63, s2, 0x30003
  s_lshl3_add_u32 s27, s62, s63
  s_and_b32 s62, s2, 1
  s_lshr_b32 s63, s2, 6
  s_lshl2_add_u32 s28, s62, s63
  s_mov_b32 s60, 0
  s_mul_i32 s61, s26, 6
  s_mul_i32 s62, s28, 245760
  s_add_u32 s62, s62, 3145728
  s_mul_i32 s63, s27, 196608
  s_add_u32 s63, s63, 8388608
  s_add_u32 s64, s61, s60
  s_mul_i32 s40, s64, 5120
  s_add_u32 s40, s40, s62
  s_lshl_b32 s46, s64, 12
  s_add_u32 s46, s46, s63
  s_add_u32 s60, s60, 1
  s_cmp_eq_u32 s60, 6
  s_cselect_b32 s60, 0, s60
  s_add_u32 s64, s61, s60
  s_mul_i32 s41, s64, 5120
  s_add_u32 s41, s41, s62
  s_lshl_b32 s47, s64, 12
  s_add_u32 s47, s47, s63
  s_add_u32 s60, s60, 1
  s_cmp_eq_u32 s60, 6
  s_cselect_b32 s60, 0, s60
  s_add_u32 s64, s61, s60
  s_mul_i32 s42, s64, 5120
  s_add_u32 s42, s42, s62
  s_lshl_b32 s48, s64, 12
  s_add_u32 s48, s48, s63
  s_add_u32 s60, s60, 1
  s_cmp_eq_u32 s60, 6
  s_cselect_b32 s60, 0, s60
  s_add_u32 s64, s61, s60
  s_mul_i32 s43, s64, 5120
  s_add_u32 s43, s43, s62
  s_lshl_b32 s49, s64, 12
  s_add_u32 s49, s49, s63
  s_add_u32 s60, s60, 1
  s_cmp_eq_u32 s60, 6
  s_cselect_b32 s60, 0, s60
  s_add_u32 s64, s61, s60
  s_mul_i32 s44, s64, 5120
  s_add_u32 s44, s44, s62
  s_lshl_b32 s50, s64, 12
  s_add_u32 s50, s50, s63
  s_add_u32 s60, s60, 1
  s_cmp_eq_u32 s60, 6
  s_cselect_b32 s60, 0, s60
  s_add_u32 s64, s61, s60
  s_mul_i32 s45, s64, 5120
  s_add_u32 s45, s45, s62
  s_lshl_b32 s51, s64, 12
  s_add_u32 s51, s51, s63
  s_lshl3_add_u32 s10, s27, s26
  s_lshl_b32 s10, s10, 7
  s_lshl_b32 s11, s27, 7
  s_add_u32 s11, s11, 32768
  s_mul_i32 s0, s27, 40
  s_mul_i32 s60, s26, 5
  s_add_u32 s0, s0, s60
  s_lshl_b32 s0, s0, 11
  s_add_u32 s0, s0, 5242880
  s_lshl3_add_u32 s1, s28, s26
  s_mul_i32 s1, s1, 12800
  s_add_u32 s1, s1, 2097152
  s_mul_i32 s3, s26, 7168
  s_add_u32 s3, s3, 1048576
  s_lshl_b32 s29, s26, 9
  s_add_u32 s29, s29, 36864
  s_mov_b32 s36, s24
  s_mov_b32 s37, s25
  s_mov_b32 s38, 16777216
  s_mov_b32 s39, 0x20000
  v_add_u32 v72, 4096, v254
  buffer_load_dwordx4 v[80:83], v254, s[36:39], s40 offen offset:0 sc1
  buffer_load_dwordx4 v[84:87], v254, s[36:39], s40 offen offset:1024 sc1
  buffer_load_dwordx4 v[88:91], v254, s[36:39], s40 offen offset:2048 sc1
  buffer_load_dwordx4 v[92:95], v254, s[36:39], s40 offen offset:3072 sc1
  buffer_load_dwordx4 v[96:99], v72, s[36:39], s40 offen offset:0 sc1
  buffer_load_dwordx4 v[100:103], v254, s[36:39], s41 offen offset:0 sc1
  buffer_load_dwordx4 v[104:107], v254, s[36:39], s41 offen offset:1024 sc1
  buffer_load_dwordx4 v[108:111], v254, s[36:39], s41 offen offset:2048 sc1
  buffer_load_dwordx4 v[112:115], v254, s[36:39], s41 offen offset:3072 sc1
  buffer_load_dwordx4 v[116:119], v72, s[36:39], s41 offen offset:0 sc1
  buffer_load_dwordx4 v[120:123], v254, s[36:39], s42 offen offset:0 sc1
  buffer_load_dwordx4 v[124:127], v254, s[36:39], s42 offen offset:1024 sc1
  buffer_load_dwordx4 v[128:131], v254, s[36:39], s42 offen offset:2048 sc1
  buffer_load_dwordx4 v[132:135], v254, s[36:39], s42 offen offset:3072 sc1
  buffer_load_dwordx4 v[136:139], v72, s[36:39], s42 offen offset:0 sc1
  v_mov_b32 v76, 42992
  v_mov_b32 v77, 0
  ds_write_b32 v76, v77
  s_waitcnt lgkmcnt(0)
  s_barrier
  v_add_u32 v72, 4096, v254
  s_waitcnt vmcnt(3)
  buffer_load_dwordx4 v[140:143], v254, s[36:39], s43 offen offset:0 sc1
  s_waitcnt vmcnt(3)
  buffer_load_dwordx4 v[144:147], v254, s[36:39], s43 offen offset:1024 sc1
  s_waitcnt vmcnt(3)
  buffer_load_dwordx4 v[148:151], v254, s[36:39], s43 offen offset:2048 sc1
L_l2:
  v_add_u32 v72, 4096, v254
  s_waitcnt vmcnt(3)
  buffer_load_dwordx4 v[152:155], v254, s[36:39], s43 offen offset:3072 sc1
  s_waitcnt vmcnt(3)
  buffer_load_dwordx4 v[156:159], v72, s[36:39], s43 offen offset:0 sc1
  s_waitcnt vmcnt(3)
  buffer_load_dwordx4 v[160:163], v254, s[36:39], s44 offen offset:0 sc1
  s_waitcnt vmcnt(3)
  buffer_load_dwordx4 v[164:167], v254, s[36:39], s44 offen offset:1024 sc1
  s_waitcnt vmcnt(3)
  buffer_load_dwordx4 v[168:171], v254, s[36:39], s44 offen offset:2048 sc1
  s_waitcnt vmcnt(3)
  buffer_load_dwordx4 v[172:175], v254, s[36:39], s44 offen offset:3072 sc1
  s_waitcnt vmcnt(3)
  buffer_load_dwordx4 v[176:179], v72, s[36:39], s44 offen offset:0 sc1
  s_mul_i32 s60, s35, 20480
  s_add_u32 s60, s60, 81920
  s_sub_u32 s61, s42, 122880
  s_add_u32 m0, s60, 0
  s_nop 0
  s_waitcnt vmcnt(3)
  buffer_load_dwordx4 v254, s[36:39], s61 offen offset:0 sc1 lds
  s_waitcnt vmcnt(3)
  buffer_load_dwordx4 v254, s[36:39], s61 offen offset:1024 sc1 lds
  s_waitcnt vmcnt(3)
  buffer_load_dwordx4 v254, s[36:39], s61 offen offset:2048 sc1 lds
  s_waitcnt vmcnt(3)
  buffer_load_dwordx4 v254, s[36:39], s61 offen offset:3072 sc1 lds
  s_add_u32 m0, s60, 4096
  s_add_u32 s61, s61, 4096
  s_waitcnt vmcnt(3)
  buffer_load_dwordx4 v254, s[36:39], s61 offen offset:0 sc1 lds
  s_sub_u32 s61, s43, 122880
  s_add_u32 m0, s60, 5120
  s_nop 0
  s_waitcnt vmcnt(3)
  buffer_load_dwordx4 v254, s[36:39], s61 offen offset:0 sc1 lds
  s_waitcnt vmcnt(3)
  buffer_load_dwordx4 v254, s[36:39], s61 offen offset:1024 sc1 lds
  s_waitcnt vmcnt(3)
  buffer_load_dwordx4 v254, s[36:39], s61 offen offset:2048 sc1 lds
  s_waitcnt vmcnt(3)
  buffer_load_dwordx4 v254, s[36:39], s61 offen offset:3072 sc1 lds
  s_add_u32 m0, s60, 9216
  s_add_u32 s61, s61, 4096
  s_waitcnt vmcnt(3)
  buffer_load_dwordx4 v254, s[36:39], s61 offen offset:0 sc1 lds
  s_sub_u32 s61, s44, 122880
  s_add_u32 m0, s60, 10240
  s_nop 0
  s_waitcnt vmcnt(3)
  buffer_load_dwordx4 v254, s[36:39], s61 offen offset:0 sc1 lds
  buffer_load_dwordx4 v254, s[36:39], s61 offen offset:1024 sc1 lds
  buffer_load_dwordx4 v254, s[36:39], s61 offen offset:2048 sc1 lds
  buffer_load_dwordx4 v254, s[36:39], s61 offen offset:3072 sc1 lds
  s_add_u32 m0, s60, 14336
  s_add_u32 s61, s61, 4096
  buffer_load_dwordx4 v254, s[36:39], s61 offen offset:0 sc1 lds
  s_waitcnt vmcnt(0)
L_g2:
  s_setprio 0
  s_lshl_b32 s63, s27, 8
  s_add_u32 s63, s63, 65536
  s_add_u32 s60, s0, 4096
  s_add_u32 s61, s0, 8192
  v_mov_b32 v252, 0
  s_barrier
  v_mov_b32 v253, 0
  s_mov_b64 exec, 1
  buffer_atomic_add v253, v252, s[36:39], s10 offen sc0 sc1
  s_mov_b64 exec, -1
  s_cmp_ge_u32 s26, 4
  s_cbranch_scc1 L_np_21
  v_add_u32 v72, 4096, v254
  buffer_load_dwordx4 v[80:83], v254, s[36:39], s40 offen offset:0 sc1
  buffer_load_dwordx4 v[84:87], v254, s[36:39], s40 offen offset:1024 sc1
  buffer_load_dwordx4 v[88:91], v254, s[36:39], s40 offen offset:2048 sc1
  buffer_load_dwordx4 v[92:95], v254, s[36:39], s40 offen offset:3072 sc1
  buffer_load_dwordx4 v[96:99], v72, s[36:39], s40 offen offset:0 sc1
  buffer_load_dwordx4 v[100:103], v254, s[36:39], s41 offen offset:0 sc1
  buffer_load_dwordx4 v[104:107], v254, s[36:39], s41 offen offset:1024 sc1
  buffer_load_dwordx4 v[108:111], v254, s[36:39], s41 offen offset:2048 sc1
  buffer_load_dwordx4 v[112:115], v254, s[36:39], s41 offen offset:3072 sc1
  buffer_load_dwordx4 v[116:119], v72, s[36:39], s41 offen offset:0 sc1
L_np_21:
  s_cmp_ge_u32 s26, 4
  s_cbranch_scc1 L_pk_22
  s_mul_i32 s74, s26, 20480
  s_add_u32 s74, s74, 81920
  v_add_u32 v197, s74, v254
  ds_read_b128 v[120:123], v197 offset:0
  ds_read_b128 v[124:127], v197 offset:1024
  ds_read_b128 v[128:131], v197 offset:2048
  ds_read_b128 v[132:135], v197 offset:3072
  ds_read_b128 v[136:139], v197 offset:4096
  ds_read_b128 v[140:143], v197 offset:5120
  ds_read_b128 v[144:147], v197 offset:6144
  ds_read_b128 v[148:151], v197 offset:7168
  ds_read_b128 v[152:155], v197 offset:8192
  ds_read_b128 v[156:159], v197 offset:9216
  ds_read_b128 v[160:163], v197 offset:10240
  ds_read_b128 v[164:167], v197 offset:11264
  ds_read_b128 v[168:171], v197 offset:12288
  ds_read_b128 v[172:175], v197 offset:13312
  ds_read_b128 v[176:179], v197 offset:14336
L_pk_22:
  s_waitcnt lgkmcnt(0)
  ds_write_b128 v62, v[20:23] offset:13312
  ds_write_b128 v62, v[24:27] offset:14336
  ds_write_b128 v62, v[28:31] offset:15360
  ds_write_b128 v62, v[32:35] offset:16384
  ds_write_b128 v62, v[36:39] offset:17408
  s_mov_b32 s75, 0
  s_cmp_ge_u32 s26, 4
  s_cbranch_scc1 L_ap_23
  s_waitcnt vmcnt(10)
  v_readfirstlane_b32 s74, v253
  s_nop 0
  s_cmp_ge_u32 s74, 2
  s_cbranch_scc1 L_apd_24
  v_mov_b32 v253, 0
  s_mov_b64 exec, 1
  buffer_atomic_add v253, v252, s[36:39], s10 offen sc0 sc1
  s_mov_b64 exec, -1
L_ap_23:
  s_waitcnt vmcnt(0)
  v_readfirstlane_b32 s74, v253
  s_nop 0
  s_cmp_ge_u32 s74, 2
  s_cbranch_scc1 L_apd_24
  s_add_u32 s75, s75, 1
  s_cmp_ge_u32 s75, 1048576
  s_cbranch_scc1 L_apd_24
  s_sleep 2
  v_mov_b32 v253, 0
  s_mov_b64 exec, 1
  buffer_atomic_add v253, v252, s[36:39], s10 offen sc0 sc1
  s_mov_b64 exec, -1
  s_branch L_ap_23
L_apd_24:
  s_setprio 1
  buffer_load_dwordx4 v[200:203], v254, s[36:39], s46 offen offset:0 sc1
  buffer_load_dwordx4 v[204:207], v254, s[36:39], s46 offen offset:1024 sc1
  buffer_load_dwordx4 v[208:211], v254, s[36:39], s46 offen offset:2048 sc1
  buffer_load_dwordx4 v[212:215], v254, s[36:39], s46 offen offset:3072 sc1
  v_lshlrev_b32 v252, 7, v255
  v_add_u32 v252, s29, v252
  v_cmp_le_u32 vcc, 4, v255
  v_mov_b32 v249, s11
  v_mov_b32 v248, 16
  v_cndmask_b32 v252, v252, v249, vcc
  v_cndmask_b32 v248, v248, 25, vcc
  buffer_load_dwordx4 v[216:219], v254, s[36:39], s47 offen offset:0 sc1
  buffer_load_dwordx4 v[220:223], v254, s[36:39], s47 offen offset:1024 sc1
  buffer_load_dwordx4 v[224:227], v254, s[36:39], s47 offen offset:2048 sc1
  buffer_load_dwordx4 v[228:231], v254, s[36:39], s47 offen offset:3072 sc1
  buffer_load_dwordx4 v[232:235], v254, s[36:39], s48 offen offset:0 sc1
  buffer_load_dwordx4 v[236:239], v254, s[36:39], s48 offen offset:1024 sc1
  buffer_load_dwordx4 v[240:243], v254, s[36:39], s48 offen offset:2048 sc1
  buffer_load_dwordx4 v[244:247], v254, s[36:39], s48 offen offset:3072 sc1
  s_waitcnt vmcnt(8)
  v_mfma_f32_16x16x32_bf16 v[0:3], v[80:83], v[200:203], 0
  v_mfma_f32_16x16x32_bf16 v[20:23], v[80:83], v[204:207], 0
  v_mfma_f32_16x16x32_bf16 v[40:43], v[80:83], v[208:211], 0
  v_mfma_f32_16x16x32_bf16 v[60:63], v[80:83], v[212:215], 0
  v_mfma_f32_16x16x32_bf16 v[4:7], v[84:87], v[200:203], 0
  v_mfma_f32_16x16x32_bf16 v[24:27], v[84:87], v[204:207], 0
  v_mfma_f32_16x16x32_bf16 v[44:47], v[84:87], v[208:211], 0
  v_mfma_f32_16x16x32_bf16 v[64:67], v[84:87], v[212:215], 0
  v_mfma_f32_16x16x32_bf16 v[8:11], v[88:91], v[200:203], 0
  v_mfma_f32_16x16x32_bf16 v[28:31], v[88:91], v[204:207], 0
  v_mfma_f32_16x16x32_bf16 v[48:51], v[88:91], v[208:211], 0
  v_mfma_f32_16x16x32_bf16 v[68:71], v[88:91], v[212:215], 0
  v_mfma_f32_16x16x32_bf16 v[12:15], v[92:95], v[200:203], 0
  v_mfma_f32_16x16x32_bf16 v[32:35], v[92:95], v[204:207], 0
  v_mfma_f32_16x16x32_bf16 v[52:55], v[92:95], v[208:211], 0
  v_mfma_f32_16x16x32_bf16 v[72:75], v[92:95], v[212:215], 0
  v_mfma_f32_16x16x32_bf16 v[16:19], v[96:99], v[200:203], 0
  v_mfma_f32_16x16x32_bf16 v[36:39], v[96:99], v[204:207], 0
  v_mfma_f32_16x16x32_bf16 v[56:59], v[96:99], v[208:211], 0
  v_mfma_f32_16x16x32_bf16 v[76:79], v[96:99], v[212:215], 0
  buffer_load_dword v253, v252, s[36:39], 0 offen sc1
  buffer_load_dwordx4 v[200:203], v254, s[36:39], s49 offen offset:0 sc1
  buffer_load_dwordx4 v[204:207], v254, s[36:39], s49 offen offset:1024 sc1
  buffer_load_dwordx4 v[208:211], v254, s[36:39], s49 offen offset:2048 sc1
  buffer_load_dwordx4 v[212:215], v254, s[36:39], s49 offen offset:3072 sc1
  s_waitcnt vmcnt(9)
  v_mfma_f32_16x16x32_bf16 v[0:3], v[100:103], v[216:219], v[0:3]
  v_mfma_f32_16x16x32_bf16 v[20:23], v[100:103], v[220:223], v[20:23]
  v_mfma_f32_16x16x32_bf16 v[40:43], v[100:103], v[224:227], v[40:43]
  v_mfma_f32_16x16x32_bf16 v[60:63], v[100:103], v[228:231], v[60:63]
  v_mfma_f32_16x16x32_bf16 v[4:7], v[104:107], v[216:219], v[4:7]
  v_mfma_f32_16x16x32_bf16 v[24:27], v[104:107], v[220:223], v[24:27]
  v_mfma_f32_16x16x32_bf16 v[44:47], v[104:107], v[224:227], v[44:47]
  v_mfma_f32_16x16x32_bf16 v[64:67], v[104:107], v[228:231], v[64:67]
  v_mfma_f32_16x16x32_bf16 v[8:11], v[108:111], v[216:219], v[8:11]
  v_mfma_f32_16x16x32_bf16 v[28:31], v[108:111], v[220:223], v[28:31]
  v_mfma_f32_16x16x32_bf16 v[48:51], v[108:111], v[224:227], v[48:51]
  v_mfma_f32_16x16x32_bf16 v[68:71], v[108:111], v[228:231], v[68:71]
  v_mfma_f32_16x16x32_bf16 v[12:15], v[112:115], v[216:219], v[12:15]
  v_mfma_f32_16x16x32_bf16 v[32:35], v[112:115], v[220:223], v[32:35]
  v_mfma_f32_16x16x32_bf16 v[52:55], v[112:115], v[224:227], v[52:55]
  v_mfma_f32_16x16x32_bf16 v[72:75], v[112:115], v[228:231], v[72:75]
  v_mfma_f32_16x16x32_bf16 v[16:19], v[116:119], v[216:219], v[16:19]
  v_mfma_f32_16x16x32_bf16 v[36:39], v[116:119], v[220:223], v[36:39]
  v_mfma_f32_16x16x32_bf16 v[56:59], v[116:119], v[224:227], v[56:59]
  v_mfma_f32_16x16x32_bf16 v[76:79], v[116:119], v[228:231], v[76:79]
  buffer_load_dwordx4 v[216:219], v254, s[36:39], s50 offen offset:0 sc1
  buffer_load_dwordx4 v[220:223], v254, s[36:39], s50 offen offset:1024 sc1
  buffer_load_dwordx4 v[224:227], v254, s[36:39], s50 offen offset:2048 sc1
  buffer_load_dwordx4 v[228:231], v254, s[36:39], s50 offen offset:3072 sc1
  s_waitcnt vmcnt(8)
  v_cmp_le_u32 vcc, v248, v253
  s_nop 1
  s_cmp_eq_u64 vcc, -1
  s_cbranch_scc1 L_ok_26
  s_mov_b32 s75, 0
L_poll_27:
  buffer_load_dword v253, v252, s[36:39], 0 offen sc1
  s_waitcnt vmcnt(0)
  v_cmp_le_u32 vcc, v248, v253
  s_add_u32 s75, s75, 1
  s_nop 0
  s_cmp_eq_u64 vcc, -1
  s_cbranch_scc1 L_polld_28
  s_sleep 8
  s_cmp_lt_u32 s75, 1048576
  s_cbranch_scc1 L_poll_27
L_polld_28:
L_ok_26:
  v_and_b32 v253, 15, v255
  v_lshlrev_b32 v253, 2, v253
  s_waitcnt vmcnt(9)
  v_mfma_f32_16x16x32_bf16 v[0:3], v[120:123], v[232:235], v[0:3]
  buffer_load_dwordx4 v[80:83], v254, s[36:39], s0 offen offset:0 sc1
  v_mfma_f32_16x16x32_bf16 v[20:23], v[120:123], v[236:239], v[20:23]
  buffer_load_dwordx4 v[84:87], v254, s[36:39], s0 offen offset:2048 sc1
  v_mfma_f32_16x16x32_bf16 v[40:43], v[120:123], v[240:243], v[40:43]
  buffer_load_dwordx4 v[88:91], v254, s[36:39], s60 offen offset:0 sc1
  v_mfma_f32_16x16x32_bf16 v[60:63], v[120:123], v[244:247], v[60:63]
  v_mfma_f32_16x16x32_bf16 v[4:7], v[124:127], v[232:235], v[4:7]
  buffer_load_dwordx4 v[92:95], v254, s[36:39], s60 offen offset:2048 sc1
  v_mfma_f32_16x16x32_bf16 v[24:27], v[124:127], v[236:239], v[24:27]
  buffer_load_dwordx4 v[96:99], v254, s[36:39], s61 offen offset:0 sc1
  v_mfma_f32_16x16x32_bf16 v[44:47], v[124:127], v[240:243], v[44:47]
  v_mfma_f32_16x16x32_bf16 v[64:67], v[124:127], v[244:247], v[64:67]
  buffer_load_dwordx4 v[100:103], v254, s[36:39], s0 offen offset:1024 sc1
  v_mfma_f32_16x16x32_bf16 v[8:11], v[128:131], v[232:235], v[8:11]
  buffer_load_dwordx4 v[104:107], v254, s[36:39], s0 offen offset:3072 sc1
  v_mfma_f32_16x16x32_bf16 v[28:31], v[128:131], v[236:239], v[28:31]
  v_mfma_f32_16x16x32_bf16 v[48:51], v[128:131], v[240:243], v[48:51]
  buffer_load_dwordx4 v[108:111], v254, s[36:39], s60 offen offset:1024 sc1
  v_mfma_f32_16x16x32_bf16 v[68:71], v[128:131], v[244:247], v[68:71]
  buffer_load_dwordx4 v[112:115], v254, s[36:39], s60 offen offset:3072 sc1
  v_mfma_f32_16x16x32_bf16 v[12:15], v[132:135], v[232:235], v[12:15]
  buffer_load_dwordx4 v[116:119], v254, s[36:39], s61 offen offset:1024 sc1
  v_mfma_f32_16x16x32_bf16 v[32:35], v[132:135], v[236:239], v[32:35]
  v_mfma_f32_16x16x32_bf16 v[52:55], v[132:135], v[240:243], v[52:55]
  buffer_load_dword v248, v253, s[36:39], s63 offen offset:0 sc1
  v_mfma_f32_16x16x32_bf16 v[72:75], v[132:135], v[244:247], v[72:75]
  buffer_load_dword v249, v253, s[36:39], s63 offen offset:64 sc1
  v_mfma_f32_16x16x32_bf16 v[16:19], v[136:139], v[232:235], v[16:19]
  v_mfma_f32_16x16x32_bf16 v[36:39], v[136:139], v[236:239], v[36:39]
  buffer_load_dword v250, v253, s[36:39], s63 offen offset:128 sc1
  v_mfma_f32_16x16x32_bf16 v[56:59], v[136:139], v[240:243], v[56:59]
  buffer_load_dword v251, v253, s[36:39], s63 offen offset:192 sc1
  v_mfma_f32_16x16x32_bf16 v[76:79], v[136:139], v[244:247], v[76:79]
  v_add_u32 v139, s30, v254
  ds_read_b128 v[120:123], v139 offset:13312
  ds_read_b128 v[124:127], v139 offset:14336
  ds_read_b128 v[128:131], v139 offset:15360
  ds_read_b128 v[132:135], v139 offset:16384
  ds_read_b128 v[136:139], v139 offset:17408
  s_waitcnt lgkmcnt(0)
  s_waitcnt vmcnt(18)
  v_mfma_f32_16x16x32_bf16 v[0:3], v[140:143], v[200:203], v[0:3]
  s_add_u32 m0, s30, 13312
  s_nop 0
  buffer_load_dwordx4 v254, s[36:39], s3 offen offset:0 sc1 lds
  v_mfma_f32_16x16x32_bf16 v[20:23], v[140:143], v[204:207], v[20:23]
  v_mfma_f32_16x16x32_bf16 v[40:43], v[140:143], v[208:211], v[40:43]
  buffer_load_dwordx4 v254, s[36:39], s3 offen offset:1024 sc1 lds
  v_mfma_f32_16x16x32_bf16 v[60:63], v[140:143], v[212:215], v[60:63]
  v_mfma_f32_16x16x32_bf16 v[4:7], v[144:147], v[200:203], v[4:7]
  v_mfma_f32_16x16x32_bf16 v[24:27], v[144:147], v[204:207], v[24:27]
  buffer_load_dwordx4 v254, s[36:39], s3 offen offset:2048 sc1 lds
  v_mfma_f32_16x16x32_bf16 v[44:47], v[144:147], v[208:211], v[44:47]
  v_mfma_f32_16x16x32_bf16 v[64:67], v[144:147], v[212:215], v[64:67]
  v_mfma_f32_16x16x32_bf16 v[8:11], v[148:151], v[200:203], v[8:11]
  buffer_load_dwordx4 v254, s[36:39], s3 offen offset:3072 sc1 lds
  v_mfma_f32_16x16x32_bf16 v[28:31], v[148:151], v[204:207], v[28:31]
  v_mfma_f32_16x16x32_bf16 v[48:51], v[148:151], v[208:211], v[48:51]
  v_mfma_f32_16x16x32_bf16 v[68:71], v[148:151], v[212:215], v[68:71]
  s_add_u32 m0, s30, 17408
  s_add_u32 s3, s3, 4096
  buffer_load_dwordx4 v254, s[36:39], s3 offen offset:0 sc1 lds
  v_mfma_f32_16x16x32_bf16 v[12:15], v[152:155], v[200:203], v[12:15]
  v_mfma_f32_16x16x32_bf16 v[32:35], v[152:155], v[204:207], v[32:35]
  v_mfma_f32_16x16x32_bf16 v[52:55], v[152:155], v[208:211], v[52:55]
  buffer_load_dwordx4 v254, s[36:39], s3 offen offset:1024 sc1 lds
  v_mfma_f32_16x16x32_bf16 v[72:75], v[152:155], v[212:215], v[72:75]
  v_mfma_f32_16x16x32_bf16 v[16:19], v[156:159], v[200:203], v[16:19]
  v_mfma_f32_16x16x32_bf16 v[36:39], v[156:159], v[204:207], v[36:39]
  buffer_load_dwordx4 v254, s[36:39], s3 offen offset:2048 sc1 lds
  v_mfma_f32_16x16x32_bf16 v[56:59], v[156:159], v[208:211], v[56:59]
  v_mfma_f32_16x16x32_bf16 v[76:79], v[156:159], v[212:215], v[76:79]
  s_waitcnt vmcnt(21)
  v_mfma_f32_16x16x32_bf16 v[0:3], v[160:163], v[216:219], v[0:3]
  v_mfma_f32_16x16x32_bf16 v[20:23], v[160:163], v[220:223], v[20:23]
  v_mfma_f32_16x16x32_bf16 v[40:43], v[160:163], v[224:227], v[40:43]
  v_mfma_f32_16x16x32_bf16 v[60:63], v[160:163], v[228:231], v[60:63]
  v_mfma_f32_16x16x32_bf16 v[4:7], v[164:167], v[216:219], v[4:7]
  v_mfma_f32_16x16x32_bf16 v[24:27], v[164:167], v[220:223], v[24:27]
  v_mfma_f32_16x16x32_bf16 v[44:47], v[164:167], v[224:227], v[44:47]
  v_mfma_f32_16x16x32_bf16 v[64:67], v[164:167], v[228:231], v[64:67]
  v_mfma_f32_16x16x32_bf16 v[8:11], v[168:171], v[216:219], v[8:11]
  v_mfma_f32_16x16x32_bf16 v[28:31], v[168:171], v[220:223], v[28:31]
  v_mfma_f32_16x16x32_bf16 v[48:51], v[168:171], v[224:227], v[48:51]
  v_mfma_f32_16x16x32_bf16 v[68:71], v[168:171], v[228:231], v[68:71]
  v_mfma_f32_16x16x32_bf16 v[12:15], v[172:175], v[216:219], v[12:15]
  v_mfma_f32_16x16x32_bf16 v[32:35], v[172:175], v[220:223], v[32:35]
  v_mfma_f32_16x16x32_bf16 v[52:55], v[172:175], v[224:227], v[52:55]
  v_mfma_f32_16x16x32_bf16 v[72:75], v[172:175], v[228:231], v[72:75]
  v_mfma_f32_16x16x32_bf16 v[16:19], v[176:179], v[216:219], v[16:19]
  v_mfma_f32_16x16x32_bf16 v[36:39], v[176:179], v[220:223], v[36:39]
  v_mfma_f32_16x16x32_bf16 v[56:59], v[176:179], v[224:227], v[56:59]
  v_mfma_f32_16x16x32_bf16 v[76:79], v[176:179], v[228:231], v[76:79]
  s_setprio 0
  s_mov_b32 s100, 0x358637bd
  s_mov_b32 s64, 0xffff
  s_mov_b32 s65, 0
  s_mov_b32 s66, -1
  s_mov_b32 s67, 0
  s_mov_b32 s68, -1
  s_mov_b32 s69, 0xffff
  s_waitcnt vmcnt(0)
  ds_read_b128 v[200:203], v120 offset:0
  ds_read_b128 v[204:207], v121 offset:1344
  ds_read_b128 v[208:211], v122 offset:0
  ds_read_b128 v[212:215], v123 offset:1344
  ds_read_b128 v[216:219], v124 offset:2688
  ds_read_b128 v[220:223], v125 offset:1344
  ds_read_b128 v[224:227], v126 offset:2688
  ds_read_b128 v[228:231], v127 offset:4032
  ds_read_b128 v[140:143], v128 offset:2688
  ds_read_b128 v[144:147], v129 offset:4032
  ds_read_b128 v[148:151], v130 offset:4032
  ds_read_b128 v[152:155], v131 offset:5376
  ds_read_b128 v[156:159], v132 offset:5376
  ds_read_b128 v[160:163], v133 offset:0
  ds_read_b128 v[164:167], v134 offset:1344
  ds_read_b128 v[168:171], v135 offset:2688
  ds_read_b128 v[172:175], v136 offset:4032
  ds_read_b128 v[176:179], v137 offset:5376
  v_swap_b32 v82, v84
  v_swap_b32 v83, v85
  v_swap_b32 v90, v92
  v_swap_b32 v91, v93
  v_swap_b32 v102, v104
  v_swap_b32 v103, v105
  v_swap_b32 v110, v112
  v_swap_b32 v111, v113
  s_waitcnt lgkmcnt(10)
  v_cvt_pk_bf16_f32 v120, v200, v201
  v_cvt_pk_bf16_f32 v121, v202, v203
  v_cvt_pk_bf16_f32 v122, v204, v205
  v_cvt_pk_bf16_f32 v123, v206, v207
  v_cvt_pk_bf16_f32 v124, v208, v209
  v_cvt_pk_bf16_f32 v125, v210, v211
  v_cvt_pk_bf16_f32 v126, v212, v213
  v_cvt_pk_bf16_f32 v127, v214, v215
  v_cvt_pk_bf16_f32 v128, v216, v217
  v_cvt_pk_bf16_f32 v129, v218, v219
  v_cvt_pk_bf16_f32 v134, v220, v221
  v_cvt_pk_bf16_f32 v135, v222, v223
  v_cvt_pk_bf16_f32 v136, v224, v225
  v_cvt_pk_bf16_f32 v137, v226, v227
  v_cvt_pk_bf16_f32 v138, v228, v229
  v_cvt_pk_bf16_f32 v139, v230, v231
  s_waitcnt lgkmcnt(0)
  v_cvt_pk_bf16_f32 v140, v140, v141
  v_cvt_pk_bf16_f32 v141, v142, v143
  v_cvt_pk_bf16_f32 v142, v144, v145
  v_cvt_pk_bf16_f32 v143, v146, v147
  v_cvt_pk_bf16_f32 v146, v148, v149
  v_cvt_pk_bf16_f32 v147, v150, v151
  v_cvt_pk_bf16_f32 v148, v152, v153
  v_cvt_pk_bf16_f32 v149, v154, v155
  v_cvt_pk_bf16_f32 v150, v156, v157
  v_cvt_pk_bf16_f32 v151, v158, v159
  v_cvt_pk_bf16_f32 v152, v160, v161
  v_cvt_pk_bf16_f32 v153, v162, v163
  v_cvt_pk_bf16_f32 v154, v164, v165
  v_cvt_pk_bf16_f32 v155, v166, v167
  v_cvt_pk_bf16_f32 v156, v168, v169
  v_cvt_pk_bf16_f32 v157, v170, v171
  v_cvt_pk_bf16_f32 v158, v172, v173
  v_cvt_pk_bf16_f32 v159, v174, v175
  v_cvt_pk_bf16_f32 v160, v176, v177
  v_cvt_pk_bf16_f32 v161, v178, v179
  v_mov_b32 v130, 0
  v_mov_b32 v131, 0
  v_mov_b32 v132, 0
  v_mov_b32 v133, 0
  v_mov_b32 v144, 0
  v_mov_b32 v145, 0
  s_nop 1
  v_mfma_f32_16x16x32_bf16 v[228:231], v[152:155], v[80:83], 0
  buffer_load_dwordx4 v[232:235], v254, s[36:39], s51 offen offset:0 sc1
  v_mfma_f32_16x16x32_bf16 v[174:177], v[140:143], v[88:91], 0
  v_mfma_f32_16x16x32_bf16 v[224:227], v[144:147], v[88:91], 0
  buffer_load_dwordx4 v[236:239], v254, s[36:39], s51 offen offset:1024 sc1
  v_mfma_f32_16x16x32_bf16 v[228:231], v[156:159], v[88:91], v[228:231]
  v_mfma_f32_16x16x32_bf16 v[162:165], v[120:123], v[80:83], 0
  buffer_load_dwordx4 v[240:243], v254, s[36:39], s51 offen offset:2048 sc1
  v_mfma_f32_16x16x32_bf16 v[166:169], v[124:127], v[80:83], 0
  v_mfma_f32_16x16x32_bf16 v[170:173], v[132:135], v[80:83], 0
  buffer_load_dwordx4 v[244:247], v254, s[36:39], s51 offen offset:3072 sc1
  v_mfma_f32_16x16x32_bf16 v[166:169], v[128:131], v[88:91], v[166:169]
  v_mfma_f32_16x16x32_bf16 v[170:173], v[136:139], v[88:91], v[170:173]
  buffer_load_dwordx4 v[180:183], v254, s[36:39], s45 offen offset:0 sc1
  s_nop 0
  v_mfma_f32_16x16x16_bf16 v[228:231], v[160:161], v[96:97], v[228:231]
  buffer_load_dwordx4 v[184:187], v254, s[36:39], s45 offen offset:1024 sc1
  v_mfma_f32_16x16x16_bf16 v[174:177], v[148:149], v[96:97], v[174:177]
  v_mfma_f32_16x16x16_bf16 v[224:227], v[150:151], v[96:97], v[224:227]
  v_mfma_f32_16x16x32_bf16 v[220:223], v[152:155], v[84:87], 0
  buffer_load_dwordx4 v[188:191], v254, s[36:39], s45 offen offset:2048 sc1
  v_mfma_f32_16x16x32_bf16 v[212:215], v[140:143], v[92:95], 0
  buffer_load_dwordx4 v[192:195], v254, s[36:39], s45 offen offset:3072 sc1
  v_mfma_f32_16x16x32_bf16 v[216:219], v[144:147], v[92:95], 0
  s_add_u32 s45, s45, 4096
  v_mfma_f32_16x16x32_bf16 v[220:223], v[156:159], v[92:95], v[220:223]
  buffer_load_dwordx4 v[196:199], v254, s[36:39], s45 offen offset:0 sc1
  v_mfma_f32_16x16x32_bf16 v[200:203], v[120:123], v[84:87], 0
  s_add_u32 m0, s30, 0
  s_nop 0
  buffer_load_dwordx4 v254, s[36:39], s1 offen offset:0 sc1 lds
  v_mfma_f32_16x16x32_bf16 v[204:207], v[124:127], v[84:87], 0
  buffer_load_dwordx4 v254, s[36:39], s1 offen offset:1024 sc1 lds
  v_mfma_f32_16x16x32_bf16 v[208:211], v[132:135], v[84:87], 0
  v_add_f32 v228, s100, v228
  v_add_f32 v229, s100, v229
  v_add_f32 v230, s100, v230
  v_add_f32 v231, s100, v231
  v_rcp_f32 v228, v228
  v_rcp_f32 v229, v229
  v_rcp_f32 v230, v230
  v_mfma_f32_16x16x32_bf16 v[204:207], v[128:131], v[92:95], v[204:207]
  v_rcp_f32 v231, v231
  v_mul_f32 v228, v248, v228
  v_mul_f32 v229, v248, v229
  v_mul_f32 v230, v248, v230
  v_mul_f32 v231, v248, v231
  v_cndmask_b32 v178, v229, v228, s[64:65]
  v_mfma_f32_16x16x32_bf16 v[208:211], v[136:139], v[92:95], v[208:211]
  v_cndmask_b32 v179, v230, v229, s[66:67]
  v_cndmask_b32 v253, v231, v230, s[68:69]
  v_mul_f32 v162, v228, v162
  v_mul_f32 v163, v228, v163
  v_mul_f32 v164, v228, v164
  v_mul_f32 v165, v228, v165
  v_cvt_pk_bf16_f32 v80, v162, v163
  s_nop 0
  v_cvt_pk_bf16_f32 v81, v164, v165
  v_mul_f32 v166, v178, v166
  v_mul_f32 v167, v178, v167
  v_mul_f32 v168, v178, v168
  v_mul_f32 v169, v178, v169
  v_cvt_pk_bf16_f32 v82, v166, v167
  v_mfma_f32_16x16x16_bf16 v[220:223], v[160:161], v[98:99], v[220:223]
  v_cvt_pk_bf16_f32 v83, v168, v169
  v_mul_f32 v170, v179, v170
  v_mul_f32 v171, v179, v171
  v_mul_f32 v172, v179, v172
  v_mul_f32 v173, v179, v173
  v_cvt_pk_bf16_f32 v88, v170, v171
  v_cvt_pk_bf16_f32 v89, v172, v173
  v_mfma_f32_16x16x16_bf16 v[212:215], v[148:149], v[98:99], v[212:215]
  v_mul_f32 v174, v253, v174
  v_mul_f32 v175, v253, v175
  v_mul_f32 v176, v253, v176
  v_mul_f32 v177, v253, v177
  v_cvt_pk_bf16_f32 v90, v174, v175
  v_cvt_pk_bf16_f32 v91, v176, v177
  v_mfma_f32_16x16x16_bf16 v[216:219], v[150:151], v[98:99], v[216:219]
  v_mul_f32 v224, v231, v224
  v_mul_f32 v225, v231, v225
  v_mul_f32 v226, v231, v226
  v_mul_f32 v227, v231, v227
  v_cvt_pk_bf16_f32 v96, v224, v225
  v_cvt_pk_bf16_f32 v97, v226, v227
  v_mfma_f32_16x16x32_bf16 v[228:231], v[152:155], v[100:103], 0
  buffer_load_dwordx4 v254, s[36:39], s1 offen offset:2048 sc1 lds
  v_mfma_f32_16x16x32_bf16 v[174:177], v[140:143], v[108:111], 0
  buffer_load_dwordx4 v254, s[36:39], s1 offen offset:3072 sc1 lds
  v_mfma_f32_16x16x32_bf16 v[224:227], v[144:147], v[108:111], 0
  s_add_u32 m0, s30, 4096
  s_add_u32 s1, s1, 4096
  buffer_load_dwordx4 v254, s[36:39], s1 offen offset:0 sc1 lds
  v_mfma_f32_16x16x32_bf16 v[228:231], v[156:159], v[108:111], v[228:231]
  buffer_load_dwordx4 v254, s[36:39], s1 offen offset:1024 sc1 lds
  v_mfma_f32_16x16x32_bf16 v[162:165], v[120:123], v[100:103], 0
  buffer_load_dwordx4 v254, s[36:39], s1 offen offset:2048 sc1 lds
  v_mfma_f32_16x16x32_bf16 v[166:169], v[124:127], v[100:103], 0
  buffer_load_dwordx4 v254, s[36:39], s1 offen offset:3072 sc1 lds
  v_mfma_f32_16x16x32_bf16 v[170:173], v[132:135], v[100:103], 0
  v_add_f32 v220, s100, v220
  v_add_f32 v221, s100, v221
  v_add_f32 v222, s100, v222
  v_add_f32 v223, s100, v223
  v_rcp_f32 v220, v220
  v_rcp_f32 v221, v221
  v_rcp_f32 v222, v222
  v_mfma_f32_16x16x32_bf16 v[166:169], v[128:131], v[108:111], v[166:169]
  v_rcp_f32 v223, v223
  v_mul_f32 v220, v249, v220
  v_mul_f32 v221, v249, v221
  v_mul_f32 v222, v249, v222
  v_mul_f32 v223, v249, v223
  v_cndmask_b32 v178, v221, v220, s[64:65]
  v_mfma_f32_16x16x32_bf16 v[170:173], v[136:139], v[108:111], v[170:173]
  v_cndmask_b32 v179, v222, v221, s[66:67]
  v_cndmask_b32 v253, v223, v222, s[68:69]
  v_mul_f32 v200, v220, v200
  v_mul_f32 v201, v220, v201
  v_mul_f32 v202, v220, v202
  v_mul_f32 v203, v220, v203
  v_cvt_pk_bf16_f32 v84, v200, v201
  s_nop 0
  v_cvt_pk_bf16_f32 v85, v202, v203
  v_mul_f32 v204, v178, v204
  v_mul_f32 v205, v178, v205
  v_mul_f32 v206, v178, v206
  v_mul_f32 v207, v178, v207
  v_cvt_pk_bf16_f32 v86, v204, v205
  v_mfma_f32_16x16x16_bf16 v[228:231], v[160:161], v[116:117], v[228:231]
  v_cvt_pk_bf16_f32 v87, v206, v207
  v_mul_f32 v208, v179, v208
  v_mul_f32 v209, v179, v209
  v_mul_f32 v210, v179, v210
  v_mul_f32 v211, v179, v211
  v_cvt_pk_bf16_f32 v92, v208, v209
  v_cvt_pk_bf16_f32 v93, v210, v211
  v_mfma_f32_16x16x16_bf16 v[174:177], v[148:149], v[116:117], v[174:177]
  v_mul_f32 v212, v253, v212
  v_mul_f32 v213, v253, v213
  v_mul_f32 v214, v253, v214
  v_mul_f32 v215, v253, v215
  v_cvt_pk_bf16_f32 v94, v212, v213
  v_cvt_pk_bf16_f32 v95, v214, v215
  v_mfma_f32_16x16x16_bf16 v[224:227], v[150:151], v[116:117], v[224:227]
  v_mul_f32 v216, v223, v216
  v_mul_f32 v217, v223, v217
  v_mul_f32 v218, v223, v218
  v_mul_f32 v219, v223, v219
  v_cvt_pk_bf16_f32 v98, v216, v217
  v_cvt_pk_bf16_f32 v99, v218, v219
  v_mfma_f32_16x16x32_bf16 v[220:223], v[152:155], v[104:107], 0
  s_add_u32 m0, s30, 8192
  s_add_u32 s1, s1, 4096
  buffer_load_dwordx4 v254, s[36:39], s1 offen offset:0 sc1 lds
  v_mfma_f32_16x16x32_bf16 v[212:215], v[140:143], v[112:115], 0
  buffer_load_dwordx4 v254, s[36:39], s1 offen offset:1024 sc1 lds
  v_mfma_f32_16x16x32_bf16 v[216:219], v[144:147], v[112:115], 0
  buffer_load_dwordx4 v254, s[36:39], s1 offen offset:2048 sc1 lds
  v_mfma_f32_16x16x32_bf16 v[220:223], v[156:159], v[112:115], v[220:223]
  buffer_load_dwordx4 v254, s[36:39], s1 offen offset:3072 sc1 lds
  v_mfma_f32_16x16x32_bf16 v[200:203], v[120:123], v[104:107], 0
  s_add_u32 m0, s30, 12288
  s_add_u32 s1, s1, 4096
  buffer_load_dwordx4 v254, s[36:39], s1 offen offset:0 sc1 lds
  v_mfma_f32_16x16x32_bf16 v[204:207], v[124:127], v[104:107], 0
  v_mfma_f32_16x16x32_bf16 v[208:211], v[132:135], v[104:107], 0
  v_add_f32 v228, s100, v228
  v_add_f32 v229, s100, v229
  v_add_f32 v230, s100, v230
  v_add_f32 v231, s100, v231
  v_rcp_f32 v228, v228
  v_rcp_f32 v229, v229
  v_rcp_f32 v230, v230
  v_mfma_f32_16x16x32_bf16 v[204:207], v[128:131], v[112:115], v[204:207]
  v_rcp_f32 v231, v231
  v_mul_f32 v228, v250, v228
  v_mul_f32 v229, v250, v229
  v_mul_f32 v230, v250, v230
  v_mul_f32 v231, v250, v231
  v_cndmask_b32 v178, v229, v228, s[64:65]
  v_mfma_f32_16x16x32_bf16 v[208:211], v[136:139], v[112:115], v[208:211]
  v_cndmask_b32 v179, v230, v229, s[66:67]
  v_cndmask_b32 v253, v231, v230, s[68:69]
  v_mul_f32 v162, v228, v162
  v_mul_f32 v163, v228, v163
  v_mul_f32 v164, v228, v164
  v_mul_f32 v165, v228, v165
  v_cvt_pk_bf16_f32 v100, v162, v163
  s_nop 0
  v_cvt_pk_bf16_f32 v101, v164, v165
  v_mul_f32 v166, v178, v166
  v_mul_f32 v167, v178, v167
  v_mul_f32 v168, v178, v168
  v_mul_f32 v169, v178, v169
  v_cvt_pk_bf16_f32 v102, v166, v167
  v_mfma_f32_16x16x16_bf16 v[220:223], v[160:161], v[118:119], v[220:223]
  v_cvt_pk_bf16_f32 v103, v168, v169
  v_mul_f32 v170, v179, v170
  v_mul_f32 v171, v179, v171
  v_mul_f32 v172, v179, v172
  v_mul_f32 v173, v179, v173
  v_cvt_pk_bf16_f32 v108, v170, v171
  v_cvt_pk_bf16_f32 v109, v172, v173
  v_mfma_f32_16x16x16_bf16 v[212:215], v[148:149], v[118:119], v[212:215]
  v_mul_f32 v174, v253, v174
  v_mul_f32 v175, v253, v175
  v_mul_f32 v176, v253, v176
  v_mul_f32 v177, v253, v177
  v_cvt_pk_bf16_f32 v110, v174, v175
  v_cvt_pk_bf16_f32 v111, v176, v177
  v_mfma_f32_16x16x16_bf16 v[216:219], v[150:151], v[118:119], v[216:219]
  v_mul_f32 v224, v231, v224
  v_mul_f32 v225, v231, v225
  v_mul_f32 v226, v231, v226
  v_mul_f32 v227, v231, v227
  v_cvt_pk_bf16_f32 v116, v224, v225
  v_cvt_pk_bf16_f32 v117, v226, v227
  v_add_u32 v224, s30, v254
  v_lshlrev_b32 v225, 3, v255
  v_add_u32 v225, s30, v225
  s_waitcnt vmcnt(13)
  v_mfma_f32_16x16x32_bf16 v[0:3], v[180:183], v[232:235], v[0:3]
  v_add_f32 v220, s100, v220
  v_add_f32 v221, s100, v221
  v_add_f32 v222, s100, v222
  v_mfma_f32_16x16x32_bf16 v[20:23], v[180:183], v[236:239], v[20:23]
  v_add_f32 v223, s100, v223
  v_rcp_f32 v220, v220
  v_mfma_f32_16x16x32_bf16 v[40:43], v[180:183], v[240:243], v[40:43]
  v_rcp_f32 v221, v221
  v_rcp_f32 v222, v222
  v_mfma_f32_16x16x32_bf16 v[60:63], v[180:183], v[244:247], v[60:63]
  v_rcp_f32 v223, v223
  v_mul_f32 v220, v251, v220
  v_mfma_f32_16x16x32_bf16 v[4:7], v[184:187], v[232:235], v[4:7]
  v_mul_f32 v221, v251, v221
  v_mul_f32 v222, v251, v222
  v_mul_f32 v223, v251, v223
  v_mfma_f32_16x16x32_bf16 v[24:27], v[184:187], v[236:239], v[24:27]
  v_cndmask_b32 v178, v221, v220, s[64:65]
  v_cndmask_b32 v179, v222, v221, s[66:67]
  v_mfma_f32_16x16x32_bf16 v[44:47], v[184:187], v[240:243], v[44:47]
  v_cndmask_b32 v253, v223, v222, s[68:69]
  v_mul_f32 v200, v220, v200
  v_mfma_f32_16x16x32_bf16 v[64:67], v[184:187], v[244:247], v[64:67]
  v_mul_f32 v201, v220, v201
  v_mul_f32 v202, v220, v202
  v_mfma_f32_16x16x32_bf16 v[8:11], v[188:191], v[232:235], v[8:11]
  v_mul_f32 v203, v220, v203
  v_cvt_pk_bf16_f32 v104, v200, v201
  v_cvt_pk_bf16_f32 v105, v202, v203
  v_mfma_f32_16x16x32_bf16 v[28:31], v[188:191], v[236:239], v[28:31]
  v_mul_f32 v204, v178, v204
  v_mul_f32 v205, v178, v205
  v_mfma_f32_16x16x32_bf16 v[48:51], v[188:191], v[240:243], v[48:51]
  v_mul_f32 v206, v178, v206
  v_mul_f32 v207, v178, v207
  v_mfma_f32_16x16x32_bf16 v[68:71], v[188:191], v[244:247], v[68:71]
  v_cvt_pk_bf16_f32 v106, v204, v205
  v_cvt_pk_bf16_f32 v107, v206, v207
  v_mfma_f32_16x16x32_bf16 v[12:15], v[192:195], v[232:235], v[12:15]
  v_mul_f32 v208, v179, v208
  v_mul_f32 v209, v179, v209
  v_mul_f32 v210, v179, v210
  v_mfma_f32_16x16x32_bf16 v[32:35], v[192:195], v[236:239], v[32:35]
  v_mul_f32 v211, v179, v211
  v_cvt_pk_bf16_f32 v112, v208, v209
  v_mfma_f32_16x16x32_bf16 v[52:55], v[192:195], v[240:243], v[52:55]
  v_cvt_pk_bf16_f32 v113, v210, v211
  v_mul_f32 v212, v253, v212
  v_mfma_f32_16x16x32_bf16 v[72:75], v[192:195], v[244:247], v[72:75]
  v_mul_f32 v213, v253, v213
  v_mul_f32 v214, v253, v214
  v_mfma_f32_16x16x32_bf16 v[16:19], v[196:199], v[232:235], v[16:19]
  v_mul_f32 v215, v253, v215
  v_cvt_pk_bf16_f32 v114, v212, v213
  v_cvt_pk_bf16_f32 v115, v214, v215
  v_mfma_f32_16x16x32_bf16 v[36:39], v[196:199], v[236:239], v[36:39]
  v_mul_f32 v216, v223, v216
  v_mul_f32 v217, v223, v217
  v_mfma_f32_16x16x32_bf16 v[56:59], v[196:199], v[240:243], v[56:59]
  v_mul_f32 v218, v223, v218
  v_mul_f32 v219, v223, v219
  v_mfma_f32_16x16x32_bf16 v[76:79], v[196:199], v[244:247], v[76:79]
  v_cvt_pk_bf16_f32 v118, v216, v217
  v_cvt_pk_bf16_f32 v119, v218, v219
  s_waitcnt vmcnt(0)
  ds_read_b128 v[120:123], v224 offset:0
  ds_read_b128 v[124:127], v224 offset:1024
  ds_read_b128 v[128:131], v224 offset:2048
  ds_read_b128 v[132:135], v224 offset:3072
  ds_read_b128 v[136:139], v224 offset:4096
  ds_read_b128 v[140:143], v224 offset:5120
  ds_read_b128 v[144:147], v224 offset:6144
  ds_read_b128 v[148:151], v224 offset:7168
  ds_read_b128 v[152:155], v224 offset:8192
  ds_read_b128 v[156:159], v224 offset:9216
  ds_read_b64 v[160:161], v225 offset:10240
  ds_read_b64 v[162:163], v225 offset:10752
  ds_read_b64 v[164:165], v225 offset:11264
  ds_read_b64 v[166:167], v225 offset:11776
  ds_read_b64 v[168:169], v225 offset:12288
  v_and_b32 v224, 15, v255
  v_mul_u32_u24 v224, 160, v224
  v_bfe_u32 v225, v255, 5, 1
  v_bfe_u32 v252, v255, 2, 1
  v_xor_b32 v225, v225, v252
  v_lshl_add_u32 v224, v225, 4, v224
  v_bfe_u32 v225, v255, 4, 1
  v_mul_u32_u24 v225, 10240, v225
  v_add3_u32 v252, v224, v225, s30
  s_waitcnt lgkmcnt(0)
  v_mfma_f32_16x16x32_bf16 v[0:3], v[120:123], v[80:83], v[0:3]
  s_mul_i32 s63, s26, 40
  s_add_u32 s63, s63, 320
  v_mfma_f32_16x16x32_bf16 v[4:7], v[128:131], v[80:83], v[4:7]
  s_lshl_b32 s62, s27, 8
  v_mfma_f32_16x16x32_bf16 v[8:11], v[136:139], v[80:83], v[8:11]
  s_add_u32 s62, s62, 73728
  v_add_u32 v170, s63, v255
  v_mfma_f32_16x16x32_bf16 v[12:15], v[144:147], v[80:83], v[12:15]
  v_mul_u32_u24 v175, 6554, v170
  v_mfma_f32_16x16x32_bf16 v[16:19], v[152:155], v[80:83], v[16:19]
  v_lshrrev_b32 v175, 16, v175
  v_mad_i32_i24 v176, v175, -10, v170
  v_mfma_f32_16x16x32_bf16 v[0:3], v[124:127], v[88:91], v[0:3]
  v_lshlrev_b32 v174, 2, v175
  v_mfma_f32_16x16x32_bf16 v[4:7], v[132:135], v[88:91], v[4:7]
  buffer_load_dword v174, v174, s[36:39], s62 offen sc1
  v_bfe_u32 v171, v175, 2, 1
  v_mfma_f32_16x16x32_bf16 v[8:11], v[140:143], v[88:91], v[8:11]
  v_xor_b32 v170, v170, v171
  v_mfma_f32_16x16x32_bf16 v[12:15], v[148:151], v[88:91], v[12:15]
  v_mul_u32_u24 v175, 1280, v175
  v_lshl_add_u32 v173, v176, 4, v175
  v_mfma_f32_16x16x32_bf16 v[16:19], v[156:159], v[88:91], v[16:19]
  v_lshlrev_b32 v170, 4, v170
  s_nop 1
  v_add_u32 v171, 61440, v170
  v_add_u32 v172, 122880, v170
  v_mfma_f32_16x16x16_bf16 v[0:3], v[160:161], v[96:97], v[0:3]
  s_mov_b32 s52, s20
  v_mfma_f32_16x16x16_bf16 v[4:7], v[162:163], v[96:97], v[4:7]
  s_mov_b32 s53, s21
  s_mov_b32 s54, 2621440
  v_mfma_f32_16x16x16_bf16 v[8:11], v[164:165], v[96:97], v[8:11]
  s_mov_b32 s55, 0x20000
  v_mfma_f32_16x16x16_bf16 v[12:15], v[166:167], v[96:97], v[12:15]
  s_mul_i32 s60, s27, 81920
  s_mul_i32 s61, s28, 160
  v_mfma_f32_16x16x16_bf16 v[16:19], v[168:169], v[96:97], v[16:19]
  s_add_u32 s60, s60, s61
  v_mfma_f32_16x16x32_bf16 v[20:23], v[120:123], v[84:87], v[20:23]
  v_mfma_f32_16x16x32_bf16 v[24:27], v[128:131], v[84:87], v[24:27]
  v_mfma_f32_16x16x32_bf16 v[28:31], v[136:139], v[84:87], v[28:31]
  v_mfma_f32_16x16x32_bf16 v[32:35], v[144:147], v[84:87], v[32:35]
  v_mfma_f32_16x16x32_bf16 v[36:39], v[152:155], v[84:87], v[36:39]
  v_mfma_f32_16x16x32_bf16 v[20:23], v[124:127], v[92:95], v[20:23]
  v_mfma_f32_16x16x32_bf16 v[24:27], v[132:135], v[92:95], v[24:27]
  ds_write_b128 v252, v[0:3] offset:0
  v_mfma_f32_16x16x32_bf16 v[28:31], v[140:143], v[92:95], v[28:31]
  v_mfma_f32_16x16x32_bf16 v[32:35], v[148:151], v[92:95], v[32:35]
  ds_write_b128 v252, v[4:7] offset:32
  v_mfma_f32_16x16x32_bf16 v[36:39], v[156:159], v[92:95], v[36:39]
  s_nop 1
  ds_write_b128 v252, v[8:11] offset:64
  v_mfma_f32_16x16x16_bf16 v[20:23], v[160:161], v[98:99], v[20:23]
  v_mfma_f32_16x16x16_bf16 v[24:27], v[162:163], v[98:99], v[24:27]
  ds_write_b128 v252, v[12:15] offset:96
  v_mfma_f32_16x16x16_bf16 v[28:31], v[164:165], v[98:99], v[28:31]
  v_mfma_f32_16x16x16_bf16 v[32:35], v[166:167], v[98:99], v[32:35]
  ds_write_b128 v252, v[16:19] offset:128
  v_mfma_f32_16x16x16_bf16 v[36:39], v[168:169], v[98:99], v[36:39]
  v_mfma_f32_16x16x32_bf16 v[40:43], v[120:123], v[100:103], v[40:43]
  v_mfma_f32_16x16x32_bf16 v[44:47], v[128:131], v[100:103], v[44:47]
  v_mfma_f32_16x16x32_bf16 v[48:51], v[136:139], v[100:103], v[48:51]
  v_mfma_f32_16x16x32_bf16 v[52:55], v[144:147], v[100:103], v[52:55]
  v_mfma_f32_16x16x32_bf16 v[56:59], v[152:155], v[100:103], v[56:59]
  v_mfma_f32_16x16x32_bf16 v[40:43], v[124:127], v[108:111], v[40:43]
  v_mfma_f32_16x16x32_bf16 v[44:47], v[132:135], v[108:111], v[44:47]
  ds_write_b128 v252, v[20:23] offset:2560
  v_mfma_f32_16x16x32_bf16 v[48:51], v[140:143], v[108:111], v[48:51]
  v_mfma_f32_16x16x32_bf16 v[52:55], v[148:151], v[108:111], v[52:55]
  ds_write_b128 v252, v[24:27] offset:2592
  v_mfma_f32_16x16x32_bf16 v[56:59], v[156:159], v[108:111], v[56:59]
  s_nop 1
  ds_write_b128 v252, v[28:31] offset:2624
  v_mfma_f32_16x16x16_bf16 v[40:43], v[160:161], v[116:117], v[40:43]
  v_mfma_f32_16x16x16_bf16 v[44:47], v[162:163], v[116:117], v[44:47]
  ds_write_b128 v252, v[32:35] offset:2656
  v_mfma_f32_16x16x16_bf16 v[48:51], v[164:165], v[116:117], v[48:51]
  v_mfma_f32_16x16x16_bf16 v[52:55], v[166:167], v[116:117], v[52:55]
  ds_write_b128 v252, v[36:39] offset:2688
  v_mfma_f32_16x16x16_bf16 v[56:59], v[168:169], v[116:117], v[56:59]
  s_cmp_lt_u32 s26, 4
  s_cbranch_scc1 L_ro_29
  v_mfma_f32_16x16x32_bf16 v[60:63], v[120:123], v[104:107], v[60:63]
  v_mfma_f32_16x16x32_bf16 v[64:67], v[128:131], v[104:107], v[64:67]
  v_mfma_f32_16x16x32_bf16 v[68:71], v[136:139], v[104:107], v[68:71]
  v_mfma_f32_16x16x32_bf16 v[72:75], v[144:147], v[104:107], v[72:75]
  s_waitcnt lgkmcnt(0)
  s_barrier
  v_mfma_f32_16x16x32_bf16 v[76:79], v[152:155], v[104:107], v[76:79]
  v_mfma_f32_16x16x32_bf16 v[60:63], v[124:127], v[112:115], v[60:63]
  v_mfma_f32_16x16x32_bf16 v[64:67], v[132:135], v[112:115], v[64:67]
  ds_write_b128 v252, v[40:43] offset:5120
  v_mfma_f32_16x16x32_bf16 v[68:71], v[140:143], v[112:115], v[68:71]
  v_mfma_f32_16x16x32_bf16 v[72:75], v[148:151], v[112:115], v[72:75]
  ds_write_b128 v252, v[44:47] offset:5152
  v_mfma_f32_16x16x32_bf16 v[76:79], v[156:159], v[112:115], v[76:79]
  s_nop 1
  ds_write_b128 v252, v[48:51] offset:5184
  v_mfma_f32_16x16x16_bf16 v[60:63], v[160:161], v[118:119], v[60:63]
  v_mfma_f32_16x16x16_bf16 v[64:67], v[162:163], v[118:119], v[64:67]
  ds_write_b128 v252, v[52:55] offset:5216
  v_mfma_f32_16x16x16_bf16 v[68:71], v[164:165], v[118:119], v[68:71]
  v_mfma_f32_16x16x16_bf16 v[72:75], v[166:167], v[118:119], v[72:75]
  ds_write_b128 v252, v[56:59] offset:5248
  v_mfma_f32_16x16x16_bf16 v[76:79], v[168:169], v[118:119], v[76:79]
  s_nop 4
  ds_write_b128 v252, v[60:63] offset:7680
  ds_write_b128 v252, v[64:67] offset:7712
  ds_write_b128 v252, v[68:71] offset:7744
  ds_write_b128 v252, v[72:75] offset:7776
  ds_write_b128 v252, v[76:79] offset:7808
  s_waitcnt vmcnt(0)
  s_branch L_rj_30
L_ro_29:
  v_mfma_f32_16x16x32_bf16 v[60:63], v[120:123], v[104:107], v[60:63]
  s_mul_i32 s63, s26, 80
  v_add_u32 v200, s63, v255
  v_mfma_f32_16x16x32_bf16 v[64:67], v[128:131], v[104:107], v[64:67]
  v_mul_u32_u24 v210, 6554, v200
  v_mfma_f32_16x16x32_bf16 v[68:71], v[136:139], v[104:107], v[68:71]
  v_lshrrev_b32 v210, 16, v210
  v_mfma_f32_16x16x32_bf16 v[72:75], v[144:147], v[104:107], v[72:75]
  v_mad_i32_i24 v211, v210, -10, v200
  v_mfma_f32_16x16x32_bf16 v[76:79], v[152:155], v[104:107], v[76:79]
  v_lshlrev_b32 v204, 2, v210
  v_mfma_f32_16x16x32_bf16 v[60:63], v[124:127], v[112:115], v[60:63]
  ds_write_b128 v252, v[40:43] offset:5120
  ds_write_b128 v252, v[44:47] offset:5152
  v_mfma_f32_16x16x32_bf16 v[64:67], v[132:135], v[112:115], v[64:67]
  ds_write_b128 v252, v[48:51] offset:5184
  v_mfma_f32_16x16x32_bf16 v[68:71], v[140:143], v[112:115], v[68:71]
  ds_write_b128 v252, v[52:55] offset:5216
  v_mfma_f32_16x16x32_bf16 v[72:75], v[148:151], v[112:115], v[72:75]
  ds_write_b128 v252, v[56:59] offset:5248
  v_mfma_f32_16x16x32_bf16 v[76:79], v[156:159], v[112:115], v[76:79]
  buffer_load_dword v204, v204, s[36:39], s62 offen sc1
  s_nop 1
  v_bfe_u32 v201, v210, 2, 1
  v_xor_b32 v200, v200, v201
  v_mfma_f32_16x16x16_bf16 v[60:63], v[160:161], v[118:119], v[60:63]
  v_mul_u32_u24 v210, 1280, v210
  v_mfma_f32_16x16x16_bf16 v[64:67], v[162:163], v[118:119], v[64:67]
  v_lshl_add_u32 v203, v211, 4, v210
  v_mfma_f32_16x16x16_bf16 v[68:71], v[164:165], v[118:119], v[68:71]
  v_lshlrev_b32 v200, 4, v200
  v_mfma_f32_16x16x16_bf16 v[72:75], v[166:167], v[118:119], v[72:75]
  v_add_u32 v201, 61440, v200
  v_mfma_f32_16x16x16_bf16 v[76:79], v[168:169], v[118:119], v[76:79]
  v_add_u32 v202, 122880, v200
  s_add_u32 s63, s63, 64
  v_add_u32 v205, s63, v255
  v_mul_u32_u24 v210, 6554, v205
  v_lshrrev_b32 v210, 16, v210
  v_mad_i32_i24 v211, v210, -10, v205
  v_lshlrev_b32 v209, 2, v210
  buffer_load_dword v209, v209, s[36:39], s62 offen sc1
  v_bfe_u32 v206, v210, 2, 1
  v_xor_b32 v205, v205, v206
  ds_write_b128 v252, v[60:63] offset:7680
  ds_write_b128 v252, v[64:67] offset:7712
  ds_write_b128 v252, v[68:71] offset:7744
  ds_write_b128 v252, v[72:75] offset:7776
  ds_write_b128 v252, v[76:79] offset:7808
  v_mul_u32_u24 v210, 1280, v210
  v_lshl_add_u32 v208, v211, 4, v210
  v_lshlrev_b32 v205, 4, v205
  v_add_u32 v206, 61440, v205
  v_add_u32 v207, 122880, v205
  s_waitcnt lgkmcnt(0)
  s_barrier
  ds_read_b128 v[0:3], v200 offset:0
  ds_read_b128 v[4:7], v200 offset:10240
  ds_read_b128 v[8:11], v200 offset:20480
  ds_read_b128 v[12:15], v200 offset:30720
  ds_read_b128 v[16:19], v200 offset:40960
  ds_read_b128 v[20:23], v200 offset:51200
  ds_read_b128 v[24:27], v201 offset:0
  ds_read_b128 v[28:31], v201 offset:10240
  ds_read_b128 v[32:35], v201 offset:20480
  ds_read_b128 v[36:39], v201 offset:30720
  ds_read_b128 v[40:43], v201 offset:40960
  ds_read_b128 v[44:47], v201 offset:51200
  ds_read_b128 v[48:51], v202 offset:0
  ds_read_b128 v[52:55], v202 offset:10240
  ds_read_b128 v[56:59], v202 offset:20480
  ds_read_b128 v[60:63], v202 offset:30720
  s_waitcnt lgkmcnt(12)
  v_pk_add_f32 v[0:1], v[0:1], v[8:9]
  v_pk_add_f32 v[2:3], v[2:3], v[10:11]
  v_pk_add_f32 v[4:5], v[4:5], v[12:13]
  v_pk_add_f32 v[6:7], v[6:7], v[14:15]
  s_mov_b64 exec, 0xffff
  ds_read_b128 v[64:67], v205 offset:0
  ds_read_b128 v[68:71], v205 offset:10240
  s_mov_b64 exec, -1
  s_waitcnt lgkmcnt(12)
  v_pk_add_f32 v[0:1], v[0:1], v[16:17]
  v_pk_add_f32 v[2:3], v[2:3], v[18:19]
  v_pk_add_f32 v[4:5], v[4:5], v[20:21]
  v_pk_add_f32 v[6:7], v[6:7], v[22:23]
  s_mov_b64 exec, 0xffff
  ds_read_b128 v[72:75], v205 offset:20480
  ds_read_b128 v[76:79], v205 offset:30720
  s_mov_b64 exec, -1
  s_waitcnt lgkmcnt(12)
  v_pk_add_f32 v[0:1], v[0:1], v[24:25]
  v_pk_add_f32 v[2:3], v[2:3], v[26:27]
  v_pk_add_f32 v[4:5], v[4:5], v[28:29]
  v_pk_add_f32 v[6:7], v[6:7], v[30:31]
  s_mov_b64 exec, 0xffff
  ds_read_b128 v[80:83], v205 offset:40960
  ds_read_b128 v[84:87], v205 offset:51200
  s_mov_b64 exec, -1
  s_waitcnt lgkmcnt(12)
  v_pk_add_f32 v[0:1], v[0:1], v[32:33]
  v_pk_add_f32 v[2:3], v[2:3], v[34:35]
  v_pk_add_f32 v[4:5], v[4:5], v[36:37]
  v_pk_add_f32 v[6:7], v[6:7], v[38:39]
  s_mov_b64 exec, 0xffff
  ds_read_b128 v[88:91], v206 offset:0
  ds_read_b128 v[92:95], v206 offset:10240
  s_mov_b64 exec, -1
  s_waitcnt lgkmcnt(12)
  v_pk_add_f32 v[0:1], v[0:1], v[40:41]
  v_pk_add_f32 v[2:3], v[2:3], v[42:43]
  v_pk_add_f32 v[4:5], v[4:5], v[44:45]
  v_pk_add_f32 v[6:7], v[6:7], v[46:47]
  s_mov_b64 exec, 0xffff
  ds_read_b128 v[96:99], v206 offset:20480
  ds_read_b128 v[100:103], v206 offset:30720
  s_mov_b64 exec, -1
  s_waitcnt lgkmcnt(12)
  v_pk_add_f32 v[0:1], v[0:1], v[48:49]
  v_pk_add_f32 v[2:3], v[2:3], v[50:51]
  v_pk_add_f32 v[4:5], v[4:5], v[52:53]
  v_pk_add_f32 v[6:7], v[6:7], v[54:55]
  s_mov_b64 exec, 0xffff
  ds_read_b128 v[104:107], v206 offset:40960
  ds_read_b128 v[108:111], v206 offset:51200
  s_mov_b64 exec, -1
  s_waitcnt lgkmcnt(12)
  v_pk_add_f32 v[0:1], v[0:1], v[56:57]
  v_pk_add_f32 v[2:3], v[2:3], v[58:59]
  v_pk_add_f32 v[4:5], v[4:5], v[60:61]
  v_pk_add_f32 v[6:7], v[6:7], v[62:63]
  s_waitcnt vmcnt(0)
  v_mul_f32 v0, v204, v0
  v_mul_f32 v1, v204, v1
  v_mul_f32 v2, v204, v2
  v_mul_f32 v3, v204, v3
  v_mul_f32 v4, v204, v4
  v_mul_f32 v5, v204, v5
  v_mul_f32 v6, v204, v6
  v_mul_f32 v7, v204, v7
  v_cvt_pk_bf16_f32 v0, v0, v1
  v_cvt_pk_bf16_f32 v1, v2, v3
  v_cvt_pk_bf16_f32 v2, v4, v5
  v_cvt_pk_bf16_f32 v3, v6, v7
  buffer_store_dwordx4 v[0:3], v203, s[52:55], s60 offen
  s_mov_b64 exec, 0xffff
  ds_read_b128 v[112:115], v207 offset:0
  ds_read_b128 v[116:119], v207 offset:10240
  s_mov_b64 exec, -1
  s_mov_b64 exec, 0xffff
  ds_read_b128 v[120:123], v207 offset:20480
  ds_read_b128 v[124:127], v207 offset:30720
  s_mov_b64 exec, -1
  s_waitcnt lgkmcnt(12)
  v_pk_add_f32 v[64:65], v[64:65], v[72:73]
  v_pk_add_f32 v[66:67], v[66:67], v[74:75]
  v_pk_add_f32 v[68:69], v[68:69], v[76:77]
  v_pk_add_f32 v[70:71], v[70:71], v[78:79]
  s_waitcnt lgkmcnt(10)
  v_pk_add_f32 v[64:65], v[64:65], v[80:81]
  v_pk_add_f32 v[66:67], v[66:67], v[82:83]
  v_pk_add_f32 v[68:69], v[68:69], v[84:85]
  v_pk_add_f32 v[70:71], v[70:71], v[86:87]
  s_waitcnt lgkmcnt(8)
  v_pk_add_f32 v[64:65], v[64:65], v[88:89]
  v_pk_add_f32 v[66:67], v[66:67], v[90:91]
  v_pk_add_f32 v[68:69], v[68:69], v[92:93]
  v_pk_add_f32 v[70:71], v[70:71], v[94:95]
  s_waitcnt lgkmcnt(6)
  v_pk_add_f32 v[64:65], v[64:65], v[96:97]
  v_pk_add_f32 v[66:67], v[66:67], v[98:99]
  v_pk_add_f32 v[68:69], v[68:69], v[100:101]
  v_pk_add_f32 v[70:71], v[70:71], v[102:103]
  s_waitcnt lgkmcnt(4)
  v_pk_add_f32 v[64:65], v[64:65], v[104:105]
  v_pk_add_f32 v[66:67], v[66:67], v[106:107]
  v_pk_add_f32 v[68:69], v[68:69], v[108:109]
  v_pk_add_f32 v[70:71], v[70:71], v[110:111]
  s_waitcnt lgkmcnt(2)
  v_pk_add_f32 v[64:65], v[64:65], v[112:113]
  v_pk_add_f32 v[66:67], v[66:67], v[114:115]
  v_pk_add_f32 v[68:69], v[68:69], v[116:117]
  v_pk_add_f32 v[70:71], v[70:71], v[118:119]
  s_waitcnt lgkmcnt(0)
  v_pk_add_f32 v[64:65], v[64:65], v[120:121]
  v_pk_add_f32 v[66:67], v[66:67], v[122:123]
  v_pk_add_f32 v[68:69], v[68:69], v[124:125]
  v_pk_add_f32 v[70:71], v[70:71], v[126:127]
  v_mul_f32 v64, v209, v64
  v_mul_f32 v65, v209, v65
  v_mul_f32 v66, v209, v66
  v_mul_f32 v67, v209, v67
  v_mul_f32 v68, v209, v68
  v_mul_f32 v69, v209, v69
  v_mul_f32 v70, v209, v70
  v_mul_f32 v71, v209, v71
  v_cvt_pk_bf16_f32 v64, v64, v65
  v_cvt_pk_bf16_f32 v65, v66, v67
  v_cvt_pk_bf16_f32 v66, v68, v69
  v_cvt_pk_bf16_f32 v67, v70, v71
  s_mov_b64 exec, 0xffff
  buffer_store_dwordx4 v[64:67], v208, s[52:55], s60 offen
  s_mov_b64 exec, -1
L_rj_30:
  s_waitcnt lgkmcnt(0)
  s_barrier
  s_mov_b32 exec_hi, 0xff
  ds_read_b128 v[80:83], v170 offset:0
  ds_read_b128 v[84:87], v170 offset:10240
  s_mov_b64 exec, -1
  s_mov_b32 exec_hi, 0xff
  ds_read_b128 v[88:91], v170 offset:20480
  ds_read_b128 v[92:95], v170 offset:30720
  s_mov_b64 exec, -1
  s_mov_b32 exec_hi, 0xff
  ds_read_b128 v[96:99], v170 offset:40960
  ds_read_b128 v[100:103], v170 offset:51200
  s_mov_b64 exec, -1
  s_mov_b32 exec_hi, 0xff
  ds_read_b128 v[104:107], v171 offset:0
  ds_read_b128 v[108:111], v171 offset:10240
  s_mov_b64 exec, -1
  s_mov_b32 exec_hi, 0xff
  ds_read_b128 v[112:115], v171 offset:20480
  ds_read_b128 v[116:119], v171 offset:30720
  s_mov_b64 exec, -1
  s_mov_b32 exec_hi, 0xff
  ds_read_b128 v[120:123], v171 offset:40960
  ds_read_b128 v[124:127], v171 offset:51200
  s_mov_b64 exec, -1
  s_mov_b32 exec_hi, 0xff
  ds_read_b128 v[128:131], v172 offset:0
  ds_read_b128 v[132:135], v172 offset:10240
  s_mov_b64 exec, -1
  s_mov_b32 exec_hi, 0xff
  ds_read_b128 v[136:139], v172 offset:20480
  ds_read_b128 v[140:143], v172 offset:30720
  s_mov_b64 exec, -1
  s_waitcnt lgkmcnt(12)
  v_pk_add_f32 v[80:81], v[80:81], v[88:89]
  v_pk_add_f32 v[82:83], v[82:83], v[90:91]
  v_pk_add_f32 v[84:85], v[84:85], v[92:93]
  v_pk_add_f32 v[86:87], v[86:87], v[94:95]
  s_waitcnt lgkmcnt(10)
  v_pk_add_f32 v[80:81], v[80:81], v[96:97]
  v_pk_add_f32 v[82:83], v[82:83], v[98:99]
  v_pk_add_f32 v[84:85], v[84:85], v[100:101]
  v_pk_add_f32 v[86:87], v[86:87], v[102:103]
  s_waitcnt lgkmcnt(8)
  v_pk_add_f32 v[80:81], v[80:81], v[104:105]
  v_pk_add_f32 v[82:83], v[82:83], v[106:107]
  v_pk_add_f32 v[84:85], v[84:85], v[108:109]
  v_pk_add_f32 v[86:87], v[86:87], v[110:111]
  s_waitcnt lgkmcnt(6)
  v_pk_add_f32 v[80:81], v[80:81], v[112:113]
  v_pk_add_f32 v[82:83], v[82:83], v[114:115]
  v_pk_add_f32 v[84:85], v[84:85], v[116:117]
  v_pk_add_f32 v[86:87], v[86:87], v[118:119]
  s_waitcnt lgkmcnt(4)
  v_pk_add_f32 v[80:81], v[80:81], v[120:121]
  v_pk_add_f32 v[82:83], v[82:83], v[122:123]
  v_pk_add_f32 v[84:85], v[84:85], v[124:125]
  v_pk_add_f32 v[86:87], v[86:87], v[126:127]
  s_waitcnt lgkmcnt(2)
  v_pk_add_f32 v[80:81], v[80:81], v[128:129]
  v_pk_add_f32 v[82:83], v[82:83], v[130:131]
  v_pk_add_f32 v[84:85], v[84:85], v[132:133]
  v_pk_add_f32 v[86:87], v[86:87], v[134:135]
  s_waitcnt lgkmcnt(0)
  v_pk_add_f32 v[80:81], v[80:81], v[136:137]
  v_pk_add_f32 v[82:83], v[82:83], v[138:139]
  v_pk_add_f32 v[84:85], v[84:85], v[140:141]
  v_pk_add_f32 v[86:87], v[86:87], v[142:143]
  v_mul_f32 v80, v174, v80
  v_mul_f32 v81, v174, v81
  v_mul_f32 v82, v174, v82
  v_mul_f32 v83, v174, v83
  v_mul_f32 v84, v174, v84
  v_mul_f32 v85, v174, v85
  v_mul_f32 v86, v174, v86
  v_mul_f32 v87, v174, v87
  v_cvt_pk_bf16_f32 v80, v80, v81
  v_cvt_pk_bf16_f32 v81, v82, v83
  v_cvt_pk_bf16_f32 v82, v84, v85
  v_cvt_pk_bf16_f32 v83, v86, v87
  s_mov_b32 exec_hi, 0xff
  buffer_store_dwordx4 v[80:83], v173, s[52:55], s60 offen
  s_mov_b64 exec, -1
L_end:
  s_endpgm
L_comp:
  s_cmp_eq_u32 s34, 0
  s_cbranch_scc1 L_kv
  v_mov_b32 v253, v0
  s_lshr_b32 s35, s26, 1
  s_and_b32 s48, s26, 1
  v_and_b32 v1, 15, v0
  v_lshrrev_b32 v2, 4, v0
  v_lshrrev_b32 v3, 1, v1
  v_xor_b32 v3, v3, v2
  v_lshlrev_b32 v3, 4, v3
  v_lshl_add_u32 v3, v1, 7, v3
  s_lshl_b32 s60, s35, 13
  v_add_u32 v228, s60, v3
  v_xor_b32 v229, 64, v228
  v_lshrrev_b32 v3, 2, v0
  v_and_b32 v4, 3, v0
  v_lshlrev_b32 v4, 3, v4
  v_lshl_add_u32 v5, v3, 7, v4
  v_bfe_u32 v6, v0, 3, 2
  s_lshl_b32 s60, s48, 1
  v_xor_b32 v6, s60, v6
  v_lshl_add_u32 v6, v6, 5, v5
  v_add_u32 v230, 49152, v6
  v_xor_b32 v231, 32, v230
  v_lshl_add_u32 v6, v3, 6, v4
  v_and_b32 v7, 1, v2
  v_xor_b32 v7, s48, v7
  v_lshl_add_u32 v6, v7, 5, v6
  v_add_u32 v232, 61440, v6
  v_lshlrev_b32 v6, 4, v2
  v_add_u32 v233, 135168, v6
  v_lshlrev_b32 v234, 4, v0
  v_lshlrev_b32 v237, 3, v2
  v_lshrrev_b32 v6, 3, v0
  v_mul_u32_u24 v6, 1280, v6
  v_and_b32 v7, 7, v0
  v_lshl_add_u32 v235, v7, 4, v6
  s_lshl_b32 s60, s26, 12
  s_add_u32 s60, s60, 137216
  v_add_u32 v236, s60, v5
  s_lshl3_add_u32 s33, s27, s30
  s_mov_b32 s96, 0x3fb8aa3b
  s_mov_b32 s97, 0x3fb8aa3b
  s_lshl2_add_u32 s60, s33, s26
  s_min_u32 s60, s60, 479
  s_mul_i32 s61, s60, 6554
  s_lshr_b32 s61, s61, 16
  s_mul_i32 s62, s61, 10
  s_sub_u32 s62, s60, s62
  s_mul_i32 s66, s61, 40960
  s_lshl_b32 s63, s62, 7
  s_add_u32 s66, s66, s63
  s_mul_i32 s67, s30, 384
  s_lshl_b32 s63, s48, 6
  s_add_u32 s67, s67, s63
  s_waitcnt lgkmcnt(0)
  s_mov_b32 s52, s14
  s_mov_b32 s53, s15
  s_mov_b32 s54, 3072
  s_mov_b32 s55, 0x20000
  s_mov_b32 s44, s16
  s_mov_b32 s45, s17
  s_mov_b32 s46, 1966080
  s_mov_b32 s47, 0x20000
  buffer_load_dwordx2 v[202:203], v237, s[52:55], s67 offen offset:0
  buffer_load_dwordx2 v[206:207], v237, s[52:55], s67 offen offset:32
  buffer_load_dwordx2 v[210:211], v237, s[52:55], s67 offen offset:128
  buffer_load_dwordx2 v[214:215], v237, s[52:55], s67 offen offset:160
  buffer_load_dwordx2 v[218:219], v237, s[52:55], s67 offen offset:256
  buffer_load_dwordx2 v[222:223], v237, s[52:55], s67 offen offset:288
  s_mov_b32 s69, s66
  s_mov_b32 s36, s24
  s_mov_b32 s37, s25
  s_mov_b32 s38, 16777216
  s_mov_b32 s39, 0x20000
  s_lshl2_add_u32 s63, s62, 0
  s_mul_i32 s64, s63, 205
  s_lshr_b32 s64, s64, 10
  s_mul_i32 s65, s64, 235
  s_add_u32 s65, s65, s63
  s_mul_i32 s64, s61, 5
  s_add_u32 s65, s65, s64
  s_lshl_b32 s65, s65, 10
  s_add_u32 s65, s65, 3145728
  s_cmp_lt_u32 s33, 120
  s_cselect_b32 s10, s65, 536870912
  s_lshl2_add_u32 s63, s62, 1
  s_mul_i32 s64, s63, 205
  s_lshr_b32 s64, s64, 10
  s_mul_i32 s65, s64, 235
  s_add_u32 s65, s65, s63
  s_mul_i32 s64, s61, 5
  s_add_u32 s65, s65, s64
  s_lshl_b32 s65, s65, 10
  s_add_u32 s65, s65, 3145728
  s_cmp_lt_u32 s33, 120
  s_cselect_b32 s11, s65, 536870912
  s_lshl2_add_u32 s63, s62, 2
  s_mul_i32 s64, s63, 205
  s_lshr_b32 s64, s64, 10
  s_mul_i32 s65, s64, 235
  s_add_u32 s65, s65, s63
  s_mul_i32 s64, s61, 5
  s_add_u32 s65, s65, s64
  s_lshl_b32 s65, s65, 10
  s_add_u32 s65, s65, 3145728
  s_cmp_lt_u32 s33, 120
  s_cselect_b32 s1, s65, 536870912
  s_lshl2_add_u32 s63, s62, 3
  s_mul_i32 s64, s63, 205
  s_lshr_b32 s64, s64, 10
  s_mul_i32 s65, s64, 235
  s_add_u32 s65, s65, s63
  s_mul_i32 s64, s61, 5
  s_add_u32 s65, s65, s64
  s_lshl_b32 s65, s65, 10
  s_add_u32 s65, s65, 3145728
  s_cmp_lt_u32 s33, 120
  s_cselect_b32 s3, s65, 536870912
  s_mov_b32 s52, s8
  s_mov_b32 s53, s9
  s_mov_b32 s54, 819200
  s_mov_b32 s55, 0x20000
  s_lshl1_add_u32 s60, s33, s26
  s_sub_u32 s60, s60, 2
  s_cmp_lt_u32 s60, 160
  s_cselect_b32 s75, 1, 2
  s_cmp_lt_u32 s60, 200
  s_cselect_b32 s75, s75, 0
  s_cmp_lt_u32 s26, 2
  s_cselect_b32 s75, 0, s75
  s_mul_i32 s61, s60, 6554
  s_lshr_b32 s61, s61, 16
  s_mul_i32 s62, s61, 10
  s_sub_u32 s62, s60, s62
  s_lshr_b32 s63, s61, 1
  s_and_b32 s64, s61, 1
  s_sub_u32 s65, s61, 16
  s_lshl_b32 s65, s65, 1
  s_cmp_eq_u32 s75, 2
  s_cselect_b32 s63, s65, s63
  s_cselect_b32 s64, 2, s64
  s_mov_b32 s70, 10240
  s_cselect_b32 s70, 92160, s70
  s_mul_i32 s0, s63, 102400
  s_mul_i32 s65, s64, 40960
  s_add_u32 s0, s0, s65
  s_lshl_b32 s65, s62, 7
  s_add_u32 s0, s0, s65
  s_mul_i32 s63, s63, 12800
  s_lshl_b32 s65, s64, 10
  s_cmp_eq_u32 s75, 2
  s_cselect_b32 s65, 10240, s65
  s_mov_b32 s66, 2048
  s_cselect_b32 s66, 512, s66
  s_add_u32 s63, s63, s65
  s_add_u32 s63, s63, 2097152
  s_lshl2_add_u32 s64, s62, 0
  s_mul_i32 s65, s64, 205
  s_lshr_b32 s65, s65, 10
  s_mul_i32 s67, s65, 5
  s_sub_u32 s64, s64, s67
  s_mul_i32 s65, s65, 102400
  s_mul_i32 s64, s64, s66
  s_add_u32 s65, s65, s64
  s_add_u32 s40, s65, s63
  s_lshl2_add_u32 s64, s62, 1
  s_mul_i32 s65, s64, 205
  s_lshr_b32 s65, s65, 10
  s_mul_i32 s67, s65, 5
  s_sub_u32 s64, s64, s67
  s_mul_i32 s65, s65, 102400
  s_mul_i32 s64, s64, s66
  s_add_u32 s65, s65, s64
  s_add_u32 s41, s65, s63
  s_lshl2_add_u32 s64, s62, 2
  s_mul_i32 s65, s64, 205
  s_lshr_b32 s65, s65, 10
  s_mul_i32 s67, s65, 5
  s_sub_u32 s64, s64, s67
  s_mul_i32 s65, s65, 102400
  s_mul_i32 s64, s64, s66
  s_add_u32 s65, s65, s64
  s_add_u32 s42, s65, s63
  s_lshl2_add_u32 s64, s62, 3
  s_mul_i32 s65, s64, 205
  s_lshr_b32 s65, s65, 10
  s_mul_i32 s67, s65, 5
  s_sub_u32 s64, s64, s67
  s_mul_i32 s65, s65, 102400
  s_mul_i32 s64, s64, s66
  s_add_u32 s65, s65, s64
  s_add_u32 s43, s65, s63
  s_lshl1_add_u32 s71, s27, s35
  s_mul_i32 s60, s71, 48
  s_mul_i32 s61, s30, 6
  s_add_u32 s60, s60, s61
  s_add_u32 s60, s60, s48
  s_lshl_b32 s60, s60, 12
  s_add_u32 s49, s60, 8388608
  s_add_u32 s50, s60, 8396800
  s_add_u32 s51, s60, 8404992
  s_mul_i32 s60, s71, 40
  s_lshl2_add_u32 s60, s28, s60
  s_lshl1_add_u32 s60, s29, s60
  s_add_u32 s60, s60, s48
  s_add_u32 s60, s60, 24
  s_lshl_b32 s60, s60, 11
  s_add_u32 s72, s60, 5242880
  s_lshl3_add_u32 s31, s71, s30
  s_lshl_b32 s31, s31, 7
  s_lshl1_add_u32 s60, s30, s48
  s_cmp_eq_u32 s60, 5
  s_cselect_b32 s74, 1, 0
  s_lshl_b32 s73, s71, 7
  s_add_u32 s73, s73, 32768
  s_cmp_lt_u32 s29, 6
  s_cselect_b32 s60, 1, s74
  s_cmp_eq_u32 s60, 1
  s_cselect_b32 s73, s73, 536870912
  s_cmp_ge_u32 s29, 6
  s_cselect_b64 vcc, -1, 0
  s_lshl_b32 s63, s26, 12
  s_add_u32 m0, s63, 137216
  s_nop 0
  buffer_load_dwordx4 v235, s[44:47], s69 offen lds
  s_add_u32 s69, s69, 10240
  s_add_u32 m0, s63, 138240
  s_nop 0
  buffer_load_dwordx4 v235, s[44:47], s69 offen lds
  s_add_u32 s69, s69, 10240
  s_add_u32 m0, s63, 139264
  s_nop 0
  buffer_load_dwordx4 v235, s[44:47], s69 offen lds
  s_add_u32 s69, s69, 10240
  s_add_u32 m0, s63, 140288
  s_nop 0
  buffer_load_dwordx4 v235, s[44:47], s69 offen lds
  s_add_u32 s69, s69, 10240
  s_cmp_eq_u32 s75, 0
  s_cbranch_scc1 L_r2_31
  s_add_u32 m0, s63, 145408
  s_nop 0
  buffer_load_dwordx4 v235, s[52:55], s0 offen lds
  s_add_u32 s0, s0, 10240
  s_add_u32 m0, s63, 146432
  s_nop 0
  buffer_load_dwordx4 v235, s[52:55], s0 offen lds
  s_add_u32 s0, s0, s70
  s_add_u32 m0, s63, 147456
  s_nop 0
  buffer_load_dwordx4 v235, s[52:55], s0 offen lds
  s_add_u32 s0, s0, 10240
  s_add_u32 m0, s63, 148480
  s_nop 0
  buffer_load_dwordx4 v235, s[52:55], s0 offen lds
L_r2_31:
  s_barrier
  ds_read_b128 v[112:115], v228 offset:0
  ds_read_b128 v[116:119], v228 offset:2048
  ds_read_b128 v[120:123], v228 offset:4096
  ds_read_b128 v[124:127], v228 offset:6144
  ds_read_b64_tr_b16 v[144:145], v230 offset:0
  ds_read_b64_tr_b16 v[146:147], v230 offset:2048
  ds_read_b64_tr_b16 v[148:149], v231 offset:0
  ds_read_b64_tr_b16 v[150:151], v231 offset:2048
  ds_read_b64_tr_b16 v[152:153], v230 offset:4096
  ds_read_b64_tr_b16 v[154:155], v230 offset:6144
  ds_read_b64_tr_b16 v[156:157], v231 offset:4096
  ds_read_b64_tr_b16 v[158:159], v231 offset:6144
  ds_read_b64_tr_b16 v[160:161], v230 offset:8192
  ds_read_b64_tr_b16 v[162:163], v230 offset:10240
  ds_read_b64_tr_b16 v[164:165], v231 offset:8192
  ds_read_b64_tr_b16 v[166:167], v231 offset:10240
  ds_read_b64_tr_b16 v[168:169], v232 offset:0
  ds_read_b64_tr_b16 v[170:171], v232 offset:1024
  s_mov_b64 exec, vcc
  ds_read_b128 v[168:171], v233 offset:0
  s_mov_b64 exec, -1
  s_waitcnt vmcnt(4)
  v_lshlrev_b32 v200, 16, v202
  v_and_b32 v201, 0xffff0000, v202
  v_lshlrev_b32 v202, 16, v203
  v_and_b32 v203, 0xffff0000, v203
  v_lshlrev_b32 v204, 16, v206
  v_and_b32 v205, 0xffff0000, v206
  v_lshlrev_b32 v206, 16, v207
  v_and_b32 v207, 0xffff0000, v207
  v_lshlrev_b32 v208, 16, v210
  v_and_b32 v209, 0xffff0000, v210
  v_lshlrev_b32 v210, 16, v211
  v_and_b32 v211, 0xffff0000, v211
  v_lshlrev_b32 v212, 16, v214
  v_and_b32 v213, 0xffff0000, v214
  v_lshlrev_b32 v214, 16, v215
  v_and_b32 v215, 0xffff0000, v215
  v_lshlrev_b32 v216, 16, v218
  v_and_b32 v217, 0xffff0000, v218
  v_lshlrev_b32 v218, 16, v219
  v_and_b32 v219, 0xffff0000, v219
  v_lshlrev_b32 v220, 16, v222
  v_and_b32 v221, 0xffff0000, v222
  v_lshlrev_b32 v222, 16, v223
  v_and_b32 v223, 0xffff0000, v223
  s_waitcnt lgkmcnt(0)
  s_barrier
  v_mfma_f32_16x16x32_bf16 v[0:3], v[144:147], v[112:115], v[200:203]
  ds_read_b128 v[128:131], v229 offset:0
  v_mfma_f32_16x16x32_bf16 v[4:7], v[144:147], v[116:119], v[200:203]
  ds_read_b128 v[132:135], v229 offset:2048
  v_mfma_f32_16x16x32_bf16 v[8:11], v[144:147], v[120:123], v[200:203]
  ds_read_b128 v[136:139], v229 offset:4096
  v_mfma_f32_16x16x32_bf16 v[12:15], v[144:147], v[124:127], v[200:203]
  ds_read_b128 v[140:143], v229 offset:6144
  v_mfma_f32_16x16x32_bf16 v[16:19], v[148:151], v[112:115], v[204:207]
  ds_read_b64_tr_b16 v[172:173], v230 offset:14336
  v_mfma_f32_16x16x32_bf16 v[20:23], v[148:151], v[116:119], v[204:207]
  ds_read_b64_tr_b16 v[174:175], v230 offset:16384
  v_mfma_f32_16x16x32_bf16 v[24:27], v[148:151], v[120:123], v[204:207]
  ds_read_b64_tr_b16 v[176:177], v231 offset:14336
  v_mfma_f32_16x16x32_bf16 v[28:31], v[148:151], v[124:127], v[204:207]
  ds_read_b64_tr_b16 v[178:179], v231 offset:16384
  v_mfma_f32_16x16x32_bf16 v[32:35], v[152:155], v[112:115], v[208:211]
  ds_read_b64_tr_b16 v[180:181], v230 offset:18432
  v_mfma_f32_16x16x32_bf16 v[36:39], v[152:155], v[116:119], v[208:211]
  ds_read_b64_tr_b16 v[182:183], v230 offset:20480
  v_mfma_f32_16x16x32_bf16 v[40:43], v[152:155], v[120:123], v[208:211]
  ds_read_b64_tr_b16 v[184:185], v231 offset:18432
  v_mfma_f32_16x16x32_bf16 v[44:47], v[152:155], v[124:127], v[208:211]
  ds_read_b64_tr_b16 v[186:187], v231 offset:20480
  v_mfma_f32_16x16x32_bf16 v[48:51], v[156:159], v[112:115], v[212:215]
  ds_read_b64_tr_b16 v[188:189], v230 offset:22528
  v_mfma_f32_16x16x32_bf16 v[52:55], v[156:159], v[116:119], v[212:215]
  ds_read_b64_tr_b16 v[190:191], v230 offset:24576
  v_mfma_f32_16x16x32_bf16 v[56:59], v[156:159], v[120:123], v[212:215]
  ds_read_b64_tr_b16 v[192:193], v231 offset:22528
  v_mfma_f32_16x16x32_bf16 v[60:63], v[156:159], v[124:127], v[212:215]
  ds_read_b64_tr_b16 v[194:195], v231 offset:24576
  v_mfma_f32_16x16x32_bf16 v[64:67], v[160:163], v[112:115], v[216:219]
  ds_read_b64_tr_b16 v[196:197], v232 offset:14336
  v_mfma_f32_16x16x32_bf16 v[68:71], v[160:163], v[116:119], v[216:219]
  ds_read_b64_tr_b16 v[198:199], v232 offset:15360
  v_mfma_f32_16x16x32_bf16 v[72:75], v[160:163], v[120:123], v[216:219]
  s_mov_b64 exec, vcc
  ds_read_b128 v[196:199], v233 offset:64
  s_mov_b64 exec, -1
  v_mfma_f32_16x16x32_bf16 v[76:79], v[160:163], v[124:127], v[216:219]
  v_mfma_f32_16x16x32_bf16 v[80:83], v[164:167], v[112:115], v[220:223]
  v_mfma_f32_16x16x32_bf16 v[84:87], v[164:167], v[116:119], v[220:223]
  v_mfma_f32_16x16x32_bf16 v[88:91], v[164:167], v[120:123], v[220:223]
  v_mfma_f32_16x16x32_bf16 v[92:95], v[164:167], v[124:127], v[220:223]
  v_mfma_f32_16x16x32_bf16 v[96:99], v[168:171], v[112:115], 0
  v_mfma_f32_16x16x32_bf16 v[100:103], v[168:171], v[116:119], 0
  v_mfma_f32_16x16x32_bf16 v[104:107], v[168:171], v[120:123], 0
  v_mfma_f32_16x16x32_bf16 v[108:111], v[168:171], v[124:127], 0
  s_waitcnt lgkmcnt(0)
  s_barrier
  v_mfma_f32_16x16x32_bf16 v[0:3], v[172:175], v[128:131], v[0:3]
  ds_read_b128 v[112:115], v228 offset:16384
  ds_read_b128 v[116:119], v228 offset:18432
  v_mfma_f32_16x16x32_bf16 v[4:7], v[172:175], v[132:135], v[4:7]
  ds_read_b128 v[120:123], v228 offset:20480
  v_mfma_f32_16x16x32_bf16 v[8:11], v[172:175], v[136:139], v[8:11]
  ds_read_b128 v[124:127], v228 offset:22528
  v_mfma_f32_16x16x32_bf16 v[12:15], v[172:175], v[140:143], v[12:15]
  ds_read_b64_tr_b16 v[144:145], v230 offset:28672
  v_mfma_f32_16x16x32_bf16 v[16:19], v[176:179], v[128:131], v[16:19]
  ds_read_b64_tr_b16 v[146:147], v230 offset:30720
  v_mfma_f32_16x16x32_bf16 v[20:23], v[176:179], v[132:135], v[20:23]
  ds_read_b64_tr_b16 v[148:149], v231 offset:28672
  v_mfma_f32_16x16x32_bf16 v[24:27], v[176:179], v[136:139], v[24:27]
  ds_read_b64_tr_b16 v[150:151], v231 offset:30720
  v_mfma_f32_16x16x32_bf16 v[28:31], v[176:179], v[140:143], v[28:31]
  ds_read_b64_tr_b16 v[152:153], v230 offset:32768
  v_mfma_f32_16x16x32_bf16 v[32:35], v[180:183], v[128:131], v[32:35]
  ds_read_b64_tr_b16 v[154:155], v230 offset:34816
  v_mfma_f32_16x16x32_bf16 v[36:39], v[180:183], v[132:135], v[36:39]
  ds_read_b64_tr_b16 v[156:157], v231 offset:32768
  v_mfma_f32_16x16x32_bf16 v[40:43], v[180:183], v[136:139], v[40:43]
  ds_read_b64_tr_b16 v[158:159], v231 offset:34816
  ds_read_b64_tr_b16 v[160:161], v230 offset:36864
  v_mfma_f32_16x16x32_bf16 v[44:47], v[180:183], v[140:143], v[44:47]
  ds_read_b64_tr_b16 v[162:163], v230 offset:38912
  v_mfma_f32_16x16x32_bf16 v[48:51], v[184:187], v[128:131], v[48:51]
  ds_read_b64_tr_b16 v[164:165], v231 offset:36864
  v_mfma_f32_16x16x32_bf16 v[52:55], v[184:187], v[132:135], v[52:55]
  ds_read_b64_tr_b16 v[166:167], v231 offset:38912
  v_mfma_f32_16x16x32_bf16 v[56:59], v[184:187], v[136:139], v[56:59]
  ds_read_b64_tr_b16 v[168:169], v232 offset:28672
  v_mfma_f32_16x16x32_bf16 v[60:63], v[184:187], v[140:143], v[60:63]
  ds_read_b64_tr_b16 v[170:171], v232 offset:29696
  v_mfma_f32_16x16x32_bf16 v[64:67], v[188:191], v[128:131], v[64:67]
  s_mov_b64 exec, vcc
  ds_read_b128 v[168:171], v233 offset:128
  s_mov_b64 exec, -1
  v_mfma_f32_16x16x32_bf16 v[68:71], v[188:191], v[132:135], v[68:71]
  v_add_u32 v230, 43008, v230
  v_mfma_f32_16x16x32_bf16 v[72:75], v[188:191], v[136:139], v[72:75]
  v_add_u32 v231, 43008, v231
  v_mfma_f32_16x16x32_bf16 v[76:79], v[188:191], v[140:143], v[76:79]
  v_add_u32 v232, 43008, v232
  v_mfma_f32_16x16x32_bf16 v[80:83], v[192:195], v[128:131], v[80:83]
  v_mfma_f32_16x16x32_bf16 v[84:87], v[192:195], v[132:135], v[84:87]
  v_mfma_f32_16x16x32_bf16 v[88:91], v[192:195], v[136:139], v[88:91]
  v_mfma_f32_16x16x32_bf16 v[92:95], v[192:195], v[140:143], v[92:95]
  v_mfma_f32_16x16x32_bf16 v[96:99], v[196:199], v[128:131], v[96:99]
  v_mfma_f32_16x16x32_bf16 v[100:103], v[196:199], v[132:135], v[100:103]
  v_mfma_f32_16x16x32_bf16 v[104:107], v[196:199], v[136:139], v[104:107]
  v_mfma_f32_16x16x32_bf16 v[108:111], v[196:199], v[140:143], v[108:111]
  s_waitcnt lgkmcnt(0)
  s_waitcnt vmcnt(0)
  v_mfma_f32_16x16x32_bf16 v[0:3], v[144:147], v[112:115], v[0:3]
  ds_read_b128 v[128:131], v229 offset:16384
  ds_read_b128 v[132:135], v229 offset:18432
  v_mfma_f32_16x16x32_bf16 v[4:7], v[144:147], v[116:119], v[4:7]
  ds_read_b128 v[136:139], v229 offset:20480
  v_mfma_f32_16x16x32_bf16 v[8:11], v[144:147], v[120:123], v[8:11]
  ds_read_b128 v[140:143], v229 offset:22528
  ds_read_b64_tr_b16 v[172:173], v230 offset:0
  v_mfma_f32_16x16x32_bf16 v[12:15], v[144:147], v[124:127], v[12:15]
  ds_read_b64_tr_b16 v[174:175], v230 offset:2048
  v_mfma_f32_16x16x32_bf16 v[16:19], v[148:151], v[112:115], v[16:19]
  ds_read_b64_tr_b16 v[176:177], v231 offset:0
  v_mfma_f32_16x16x32_bf16 v[20:23], v[148:151], v[116:119], v[20:23]
  ds_read_b64_tr_b16 v[178:179], v231 offset:2048
  ds_read_b64_tr_b16 v[180:181], v230 offset:4096
  v_mfma_f32_16x16x32_bf16 v[24:27], v[148:151], v[120:123], v[24:27]
  ds_read_b64_tr_b16 v[182:183], v230 offset:6144
  v_mfma_f32_16x16x32_bf16 v[28:31], v[148:151], v[124:127], v[28:31]
  ds_read_b64_tr_b16 v[184:185], v231 offset:4096
  v_mfma_f32_16x16x32_bf16 v[32:35], v[152:155], v[112:115], v[32:35]
  ds_read_b64_tr_b16 v[186:187], v231 offset:6144
  ds_read_b64_tr_b16 v[188:189], v230 offset:8192
  v_mfma_f32_16x16x32_bf16 v[36:39], v[152:155], v[116:119], v[36:39]
  ds_read_b64_tr_b16 v[190:191], v230 offset:10240
  v_mfma_f32_16x16x32_bf16 v[40:43], v[152:155], v[120:123], v[40:43]
  ds_read_b64_tr_b16 v[192:193], v231 offset:8192
  v_mfma_f32_16x16x32_bf16 v[44:47], v[152:155], v[124:127], v[44:47]
  ds_read_b64_tr_b16 v[194:195], v231 offset:10240
  ds_read_b64_tr_b16 v[196:197], v232 offset:0
  v_mfma_f32_16x16x32_bf16 v[48:51], v[156:159], v[112:115], v[48:51]
  ds_read_b64_tr_b16 v[198:199], v232 offset:1024
  v_mfma_f32_16x16x32_bf16 v[52:55], v[156:159], v[116:119], v[52:55]
  s_mov_b64 exec, vcc
  ds_read_b128 v[196:199], v233 offset:192
  s_mov_b64 exec, -1
  v_mfma_f32_16x16x32_bf16 v[56:59], v[156:159], v[120:123], v[56:59]
  ds_read_b64_tr_b16 v[200:201], v236 offset:0
  ds_read_b64_tr_b16 v[202:203], v236 offset:2048
  v_mfma_f32_16x16x32_bf16 v[60:63], v[156:159], v[124:127], v[60:63]
  ds_read_b64_tr_b16 v[204:205], v236 offset:32
  v_mfma_f32_16x16x32_bf16 v[64:67], v[160:163], v[112:115], v[64:67]
  ds_read_b64_tr_b16 v[206:207], v236 offset:2080
  v_mfma_f32_16x16x32_bf16 v[68:71], v[160:163], v[116:119], v[68:71]
  ds_read_b64_tr_b16 v[208:209], v236 offset:64
  ds_read_b64_tr_b16 v[210:211], v236 offset:2112
  v_mfma_f32_16x16x32_bf16 v[72:75], v[160:163], v[120:123], v[72:75]
  ds_read_b64_tr_b16 v[212:213], v236 offset:96
  v_mfma_f32_16x16x32_bf16 v[76:79], v[160:163], v[124:127], v[76:79]
  ds_read_b64_tr_b16 v[214:215], v236 offset:2144
  v_mfma_f32_16x16x32_bf16 v[80:83], v[164:167], v[112:115], v[80:83]
  v_mfma_f32_16x16x32_bf16 v[84:87], v[164:167], v[116:119], v[84:87]
  v_mfma_f32_16x16x32_bf16 v[88:91], v[164:167], v[120:123], v[88:91]
  v_mfma_f32_16x16x32_bf16 v[92:95], v[164:167], v[124:127], v[92:95]
  v_mfma_f32_16x16x32_bf16 v[96:99], v[168:171], v[112:115], v[96:99]
  v_mfma_f32_16x16x32_bf16 v[100:103], v[168:171], v[116:119], v[100:103]
  v_mfma_f32_16x16x32_bf16 v[104:107], v[168:171], v[120:123], v[104:107]
  v_mfma_f32_16x16x32_bf16 v[108:111], v[168:171], v[124:127], v[108:111]
  s_waitcnt lgkmcnt(0)
  s_barrier
  s_setprio 3
  v_mfma_f32_16x16x32_bf16 v[0:3], v[172:175], v[128:131], v[0:3]
  ds_read_b128 v[112:115], v228 offset:32768
  ds_read_b128 v[116:119], v228 offset:34816
  v_mfma_f32_16x16x32_bf16 v[4:7], v[172:175], v[132:135], v[4:7]
  ds_read_b128 v[120:123], v228 offset:36864
  ds_read_b128 v[124:127], v228 offset:38912
  v_mfma_f32_16x16x32_bf16 v[8:11], v[172:175], v[136:139], v[8:11]
  ds_read_b64_tr_b16 v[144:145], v230 offset:14336
  v_mfma_f32_16x16x32_bf16 v[12:15], v[172:175], v[140:143], v[12:15]
  ds_read_b64_tr_b16 v[146:147], v230 offset:16384
  ds_read_b64_tr_b16 v[148:149], v231 offset:14336
  v_mfma_f32_16x16x32_bf16 v[16:19], v[176:179], v[128:131], v[16:19]
  ds_read_b64_tr_b16 v[150:151], v231 offset:16384
  v_mfma_f32_16x16x32_bf16 v[20:23], v[176:179], v[132:135], v[20:23]
  ds_read_b64_tr_b16 v[152:153], v230 offset:18432
  ds_read_b64_tr_b16 v[154:155], v230 offset:20480
  v_mfma_f32_16x16x32_bf16 v[24:27], v[176:179], v[136:139], v[24:27]
  ds_read_b64_tr_b16 v[156:157], v231 offset:18432
  v_mfma_f32_16x16x32_bf16 v[28:31], v[176:179], v[140:143], v[28:31]
  ds_read_b64_tr_b16 v[158:159], v231 offset:20480
  ds_read_b64_tr_b16 v[160:161], v230 offset:22528
  v_mfma_f32_16x16x32_bf16 v[32:35], v[180:183], v[128:131], v[32:35]
  ds_read_b64_tr_b16 v[162:163], v230 offset:24576
  v_mfma_f32_16x16x32_bf16 v[36:39], v[180:183], v[132:135], v[36:39]
  ds_read_b64_tr_b16 v[164:165], v231 offset:22528
  ds_read_b64_tr_b16 v[166:167], v231 offset:24576
  v_mfma_f32_16x16x32_bf16 v[40:43], v[180:183], v[136:139], v[40:43]
  ds_read_b64_tr_b16 v[168:169], v232 offset:14336
  ds_read_b64_tr_b16 v[170:171], v232 offset:15360
  v_mfma_f32_16x16x32_bf16 v[44:47], v[180:183], v[140:143], v[44:47]
  s_mov_b64 exec, vcc
  ds_read_b128 v[168:171], v233 offset:256
  s_mov_b64 exec, -1
  v_mfma_f32_16x16x32_bf16 v[48:51], v[184:187], v[128:131], v[48:51]
  buffer_store_dwordx4 v[200:203], v234, s[36:39], s10 offen sc1
  buffer_store_dwordx4 v[204:207], v234, s[36:39], s11 offen sc1
  v_mfma_f32_16x16x32_bf16 v[52:55], v[184:187], v[132:135], v[52:55]
  buffer_store_dwordx4 v[208:211], v234, s[36:39], s1 offen sc1
  v_mfma_f32_16x16x32_bf16 v[56:59], v[184:187], v[136:139], v[56:59]
  buffer_store_dwordx4 v[212:215], v234, s[36:39], s3 offen sc1
  ds_read_b64_tr_b16 v[200:201], v236 offset:8192+0
  v_mfma_f32_16x16x32_bf16 v[60:63], v[184:187], v[140:143], v[60:63]
  ds_read_b64_tr_b16 v[202:203], v236 offset:8192+2048
  v_mfma_f32_16x16x32_bf16 v[64:67], v[188:191], v[128:131], v[64:67]
  ds_read_b64_tr_b16 v[204:205], v236 offset:8192+32
  ds_read_b64_tr_b16 v[206:207], v236 offset:8192+2080
  v_mfma_f32_16x16x32_bf16 v[68:71], v[188:191], v[132:135], v[68:71]
  ds_read_b64_tr_b16 v[208:209], v236 offset:8192+64
  v_mfma_f32_16x16x32_bf16 v[72:75], v[188:191], v[136:139], v[72:75]
  ds_read_b64_tr_b16 v[210:211], v236 offset:8192+2112
  ds_read_b64_tr_b16 v[212:213], v236 offset:8192+96
  v_mfma_f32_16x16x32_bf16 v[76:79], v[188:191], v[140:143], v[76:79]
  ds_read_b64_tr_b16 v[214:215], v236 offset:8192+2144
  v_mfma_f32_16x16x32_bf16 v[80:83], v[192:195], v[128:131], v[80:83]
  v_mfma_f32_16x16x32_bf16 v[84:87], v[192:195], v[132:135], v[84:87]
  v_mfma_f32_16x16x32_bf16 v[88:91], v[192:195], v[136:139], v[88:91]
  v_mfma_f32_16x16x32_bf16 v[92:95], v[192:195], v[140:143], v[92:95]
  v_mfma_f32_16x16x32_bf16 v[96:99], v[196:199], v[128:131], v[96:99]
  v_mfma_f32_16x16x32_bf16 v[100:103], v[196:199], v[132:135], v[100:103]
  v_mfma_f32_16x16x32_bf16 v[104:107], v[196:199], v[136:139], v[104:107]
  v_mfma_f32_16x16x32_bf16 v[108:111], v[196:199], v[140:143], v[108:111]
  s_waitcnt lgkmcnt(0)
  v_mfma_f32_16x16x32_bf16 v[0:3], v[144:147], v[112:115], v[0:3]
  ds_read_b128 v[128:131], v229 offset:32768
  ds_read_b128 v[132:135], v229 offset:34816
  v_mfma_f32_16x16x32_bf16 v[4:7], v[144:147], v[116:119], v[4:7]
  ds_read_b128 v[136:139], v229 offset:36864
  ds_read_b128 v[140:143], v229 offset:38912
  v_mfma_f32_16x16x32_bf16 v[8:11], v[144:147], v[120:123], v[8:11]
  ds_read_b64_tr_b16 v[172:173], v230 offset:28672
  v_mfma_f32_16x16x32_bf16 v[12:15], v[144:147], v[124:127], v[12:15]
  ds_read_b64_tr_b16 v[174:175], v230 offset:30720
  ds_read_b64_tr_b16 v[176:177], v231 offset:28672
  v_mfma_f32_16x16x32_bf16 v[16:19], v[148:151], v[112:115], v[16:19]
  ds_read_b64_tr_b16 v[178:179], v231 offset:30720
  ds_read_b64_tr_b16 v[180:181], v230 offset:32768
  v_mfma_f32_16x16x32_bf16 v[20:23], v[148:151], v[116:119], v[20:23]
  ds_read_b64_tr_b16 v[182:183], v230 offset:34816
  v_mfma_f32_16x16x32_bf16 v[24:27], v[148:151], v[120:123], v[24:27]
  ds_read_b64_tr_b16 v[184:185], v231 offset:32768
  ds_read_b64_tr_b16 v[186:187], v231 offset:34816
  v_mfma_f32_16x16x32_bf16 v[28:31], v[148:151], v[124:127], v[28:31]
  ds_read_b64_tr_b16 v[188:189], v230 offset:36864
  ds_read_b64_tr_b16 v[190:191], v230 offset:38912
  v_mfma_f32_16x16x32_bf16 v[32:35], v[152:155], v[112:115], v[32:35]
  ds_read_b64_tr_b16 v[192:193], v231 offset:36864
  v_mfma_f32_16x16x32_bf16 v[36:39], v[152:155], v[116:119], v[36:39]
  ds_read_b64_tr_b16 v[194:195], v231 offset:38912
  ds_read_b64_tr_b16 v[196:197], v232 offset:28672
  v_mfma_f32_16x16x32_bf16 v[40:43], v[152:155], v[120:123], v[40:43]
  ds_read_b64_tr_b16 v[198:199], v232 offset:29696
  s_mov_b64 exec, vcc
  ds_read_b128 v[196:199], v233 offset:320
  s_mov_b64 exec, -1
  v_mfma_f32_16x16x32_bf16 v[44:47], v[152:155], v[124:127], v[44:47]
  s_cmp_eq_u32 s75, 0
  s_cbranch_scc1 L_r2_32
  s_cmp_eq_u32 s75, 2
  s_cbranch_scc1 L_r2_33
  buffer_store_dwordx4 v[200:203], v234, s[36:39], s40 offen sc1
  buffer_store_dwordx4 v[204:207], v234, s[36:39], s41 offen sc1
  buffer_store_dwordx4 v[208:211], v234, s[36:39], s42 offen sc1
  buffer_store_dwordx4 v[212:215], v234, s[36:39], s43 offen sc1
  s_branch L_r2_32
L_r2_33:
  v_lshrrev_b32 v238, 1, v234
  buffer_store_dwordx2 v[200:201], v238, s[36:39], s40 offen sc1
  s_add_u32 s40, s40, 12800
  buffer_store_dwordx2 v[202:203], v238, s[36:39], s40 offen sc1
  buffer_store_dwordx2 v[204:205], v238, s[36:39], s41 offen sc1
  s_add_u32 s41, s41, 12800
  buffer_store_dwordx2 v[206:207], v238, s[36:39], s41 offen sc1
  buffer_store_dwordx2 v[208:209], v238, s[36:39], s42 offen sc1
  s_add_u32 s42, s42, 12800
  buffer_store_dwordx2 v[210:211], v238, s[36:39], s42 offen sc1
  buffer_store_dwordx2 v[212:213], v238, s[36:39], s43 offen sc1
  s_add_u32 s43, s43, 12800
  buffer_store_dwordx2 v[214:215], v238, s[36:39], s43 offen sc1
L_r2_32:
  v_mfma_f32_16x16x32_bf16 v[48:51], v[156:159], v[112:115], v[48:51]
  s_lshl_b32 s60, s33, 9
  s_mul_i32 s61, s26, 1048576
  v_mfma_f32_16x16x32_bf16 v[52:55], v[156:159], v[116:119], v[52:55]
  s_add_u32 s60, s60, s61
  s_cmp_lt_u32 s26, 2
  v_mfma_f32_16x16x32_bf16 v[56:59], v[156:159], v[120:123], v[56:59]
  s_cselect_b32 s60, s60, 536870912
  v_mfma_f32_16x16x32_bf16 v[60:63], v[156:159], v[124:127], v[60:63]
  v_mov_b32 v216, 0
  v_mov_b32 v217, 0
  v_mfma_f32_16x16x32_bf16 v[64:67], v[160:163], v[112:115], v[64:67]
  v_mov_b32 v218, 0
  v_mov_b32 v219, 0
  v_mfma_f32_16x16x32_bf16 v[68:71], v[160:163], v[116:119], v[68:71]
  s_mov_b32 exec_hi, 0
  buffer_store_dwordx4 v[216:219], v234, s[36:39], s60 offen sc1
  s_mov_b32 exec_hi, -1
  v_mfma_f32_16x16x32_bf16 v[72:75], v[160:163], v[120:123], v[72:75]
  v_subrev_u32 v230, 43008, v230
  v_subrev_u32 v231, 43008, v231
  v_mfma_f32_16x16x32_bf16 v[76:79], v[160:163], v[124:127], v[76:79]
  v_subrev_u32 v232, 43008, v232
  v_mfma_f32_16x16x32_bf16 v[80:83], v[164:167], v[112:115], v[80:83]
  v_mfma_f32_16x16x32_bf16 v[84:87], v[164:167], v[116:119], v[84:87]
  v_mfma_f32_16x16x32_bf16 v[88:91], v[164:167], v[120:123], v[88:91]
  v_mfma_f32_16x16x32_bf16 v[92:95], v[164:167], v[124:127], v[92:95]
  v_mfma_f32_16x16x32_bf16 v[96:99], v[168:171], v[112:115], v[96:99]
  v_mfma_f32_16x16x32_bf16 v[100:103], v[168:171], v[116:119], v[100:103]
  v_mfma_f32_16x16x32_bf16 v[104:107], v[168:171], v[120:123], v[104:107]
  v_mfma_f32_16x16x32_bf16 v[108:111], v[168:171], v[124:127], v[108:111]
  s_setprio 0
  s_waitcnt lgkmcnt(0)
  s_barrier
  v_mfma_f32_16x16x32_bf16 v[0:3], v[172:175], v[128:131], v[0:3]
  ds_read_b128 v[112:115], v228 offset:0
  v_mfma_f32_16x16x32_bf16 v[4:7], v[172:175], v[132:135], v[4:7]
  ds_read_b128 v[116:119], v228 offset:2048
  v_mfma_f32_16x16x32_bf16 v[8:11], v[172:175], v[136:139], v[8:11]
  ds_read_b128 v[120:123], v228 offset:4096
  v_mfma_f32_16x16x32_bf16 v[12:15], v[172:175], v[140:143], v[12:15]
  ds_read_b128 v[124:127], v228 offset:6144
  v_mfma_f32_16x16x32_bf16 v[16:19], v[176:179], v[128:131], v[16:19]
  ds_read_b64_tr_b16 v[144:145], v230 offset:0
  v_mfma_f32_16x16x32_bf16 v[20:23], v[176:179], v[132:135], v[20:23]
  ds_read_b64_tr_b16 v[146:147], v230 offset:2048
  v_mfma_f32_16x16x32_bf16 v[24:27], v[176:179], v[136:139], v[24:27]
  ds_read_b64_tr_b16 v[148:149], v231 offset:0
  v_mfma_f32_16x16x32_bf16 v[28:31], v[176:179], v[140:143], v[28:31]
  ds_read_b64_tr_b16 v[150:151], v231 offset:2048
  v_mfma_f32_16x16x32_bf16 v[32:35], v[180:183], v[128:131], v[32:35]
  ds_read_b64_tr_b16 v[152:153], v230 offset:4096
  v_mfma_f32_16x16x32_bf16 v[36:39], v[180:183], v[132:135], v[36:39]
  ds_read_b64_tr_b16 v[154:155], v230 offset:6144
  v_mfma_f32_16x16x32_bf16 v[40:43], v[180:183], v[136:139], v[40:43]
  ds_read_b64_tr_b16 v[156:157], v231 offset:4096
  v_mfma_f32_16x16x32_bf16 v[44:47], v[180:183], v[140:143], v[44:47]
  ds_read_b64_tr_b16 v[158:159], v231 offset:6144
  v_mfma_f32_16x16x32_bf16 v[48:51], v[184:187], v[128:131], v[48:51]
  ds_read_b64_tr_b16 v[160:161], v230 offset:8192
  v_mfma_f32_16x16x32_bf16 v[52:55], v[184:187], v[132:135], v[52:55]
  ds_read_b64_tr_b16 v[162:163], v230 offset:10240
  v_mfma_f32_16x16x32_bf16 v[56:59], v[184:187], v[136:139], v[56:59]
  ds_read_b64_tr_b16 v[164:165], v231 offset:8192
  v_mfma_f32_16x16x32_bf16 v[60:63], v[184:187], v[140:143], v[60:63]
  ds_read_b64_tr_b16 v[166:167], v231 offset:10240
  v_mfma_f32_16x16x32_bf16 v[64:67], v[188:191], v[128:131], v[64:67]
  ds_read_b64_tr_b16 v[168:169], v232 offset:0
  v_mfma_f32_16x16x32_bf16 v[68:71], v[188:191], v[132:135], v[68:71]
  ds_read_b64_tr_b16 v[170:171], v232 offset:1024
  v_mfma_f32_16x16x32_bf16 v[72:75], v[188:191], v[136:139], v[72:75]
  s_mov_b64 exec, vcc
  ds_read_b128 v[168:171], v233 offset:384
  s_mov_b64 exec, -1
  v_mfma_f32_16x16x32_bf16 v[76:79], v[188:191], v[140:143], v[76:79]
  v_mfma_f32_16x16x32_bf16 v[80:83], v[192:195], v[128:131], v[80:83]
  v_mfma_f32_16x16x32_bf16 v[84:87], v[192:195], v[132:135], v[84:87]
  v_mfma_f32_16x16x32_bf16 v[88:91], v[192:195], v[136:139], v[88:91]
  v_mfma_f32_16x16x32_bf16 v[92:95], v[192:195], v[140:143], v[92:95]
  v_mfma_f32_16x16x32_bf16 v[96:99], v[196:199], v[128:131], v[96:99]
  v_mfma_f32_16x16x32_bf16 v[100:103], v[196:199], v[132:135], v[100:103]
  v_mfma_f32_16x16x32_bf16 v[104:107], v[196:199], v[136:139], v[104:107]
  v_mfma_f32_16x16x32_bf16 v[108:111], v[196:199], v[140:143], v[108:111]
  s_waitcnt lgkmcnt(0)
  v_mfma_f32_16x16x32_bf16 v[0:3], v[144:147], v[112:115], v[0:3]
  ds_read_b128 v[128:131], v229 offset:0
  v_mfma_f32_16x16x32_bf16 v[4:7], v[144:147], v[116:119], v[4:7]
  ds_read_b128 v[132:135], v229 offset:2048
  v_mfma_f32_16x16x32_bf16 v[8:11], v[144:147], v[120:123], v[8:11]
  ds_read_b128 v[136:139], v229 offset:4096
  v_mfma_f32_16x16x32_bf16 v[12:15], v[144:147], v[124:127], v[12:15]
  ds_read_b128 v[140:143], v229 offset:6144
  v_mfma_f32_16x16x32_bf16 v[16:19], v[148:151], v[112:115], v[16:19]
  ds_read_b64_tr_b16 v[172:173], v230 offset:14336
  v_mfma_f32_16x16x32_bf16 v[20:23], v[148:151], v[116:119], v[20:23]
  ds_read_b64_tr_b16 v[174:175], v230 offset:16384
  v_mfma_f32_16x16x32_bf16 v[24:27], v[148:151], v[120:123], v[24:27]
  ds_read_b64_tr_b16 v[176:177], v231 offset:14336
  v_mfma_f32_16x16x32_bf16 v[28:31], v[148:151], v[124:127], v[28:31]
  ds_read_b64_tr_b16 v[178:179], v231 offset:16384
  v_mfma_f32_16x16x32_bf16 v[32:35], v[152:155], v[112:115], v[32:35]
  ds_read_b64_tr_b16 v[180:181], v230 offset:18432
  v_mfma_f32_16x16x32_bf16 v[36:39], v[152:155], v[116:119], v[36:39]
  ds_read_b64_tr_b16 v[182:183], v230 offset:20480
  v_mfma_f32_16x16x32_bf16 v[40:43], v[152:155], v[120:123], v[40:43]
  ds_read_b64_tr_b16 v[184:185], v231 offset:18432
  v_mfma_f32_16x16x32_bf16 v[44:47], v[152:155], v[124:127], v[44:47]
  ds_read_b64_tr_b16 v[186:187], v231 offset:20480
  v_mfma_f32_16x16x32_bf16 v[48:51], v[156:159], v[112:115], v[48:51]
  ds_read_b64_tr_b16 v[188:189], v230 offset:22528
  v_mfma_f32_16x16x32_bf16 v[52:55], v[156:159], v[116:119], v[52:55]
  ds_read_b64_tr_b16 v[190:191], v230 offset:24576
  v_mfma_f32_16x16x32_bf16 v[56:59], v[156:159], v[120:123], v[56:59]
  ds_read_b64_tr_b16 v[192:193], v231 offset:22528
  v_mfma_f32_16x16x32_bf16 v[60:63], v[156:159], v[124:127], v[60:63]
  ds_read_b64_tr_b16 v[194:195], v231 offset:24576
  v_mfma_f32_16x16x32_bf16 v[64:67], v[160:163], v[112:115], v[64:67]
  ds_read_b64_tr_b16 v[196:197], v232 offset:14336
  v_mfma_f32_16x16x32_bf16 v[68:71], v[160:163], v[116:119], v[68:71]
  ds_read_b64_tr_b16 v[198:199], v232 offset:15360
  v_mfma_f32_16x16x32_bf16 v[72:75], v[160:163], v[120:123], v[72:75]
  s_mov_b64 exec, vcc
  ds_read_b128 v[196:199], v233 offset:448
  s_mov_b64 exec, -1
  v_mfma_f32_16x16x32_bf16 v[76:79], v[160:163], v[124:127], v[76:79]
  v_mfma_f32_16x16x32_bf16 v[80:83], v[164:167], v[112:115], v[80:83]
  v_mfma_f32_16x16x32_bf16 v[84:87], v[164:167], v[116:119], v[84:87]
  v_mfma_f32_16x16x32_bf16 v[88:91], v[164:167], v[120:123], v[88:91]
  v_mfma_f32_16x16x32_bf16 v[92:95], v[164:167], v[124:127], v[92:95]
  v_mfma_f32_16x16x32_bf16 v[96:99], v[168:171], v[112:115], v[96:99]
  v_mfma_f32_16x16x32_bf16 v[100:103], v[168:171], v[116:119], v[100:103]
  v_mfma_f32_16x16x32_bf16 v[104:107], v[168:171], v[120:123], v[104:107]
  v_mfma_f32_16x16x32_bf16 v[108:111], v[168:171], v[124:127], v[108:111]
  s_waitcnt vmcnt(0)
  s_waitcnt lgkmcnt(0)
  s_barrier
  v_mfma_f32_16x16x32_bf16 v[0:3], v[172:175], v[128:131], v[0:3]
  ds_read_b128 v[112:115], v228 offset:16384
  ds_read_b128 v[116:119], v228 offset:18432
  v_mfma_f32_16x16x32_bf16 v[4:7], v[172:175], v[132:135], v[4:7]
  ds_read_b128 v[120:123], v228 offset:20480
  v_mfma_f32_16x16x32_bf16 v[8:11], v[172:175], v[136:139], v[8:11]
  ds_read_b128 v[124:127], v228 offset:22528
  v_mfma_f32_16x16x32_bf16 v[12:15], v[172:175], v[140:143], v[12:15]
  ds_read_b64_tr_b16 v[144:145], v230 offset:28672
  v_mfma_f32_16x16x32_bf16 v[16:19], v[176:179], v[128:131], v[16:19]
  ds_read_b64_tr_b16 v[146:147], v230 offset:30720
  v_mfma_f32_16x16x32_bf16 v[20:23], v[176:179], v[132:135], v[20:23]
  ds_read_b64_tr_b16 v[148:149], v231 offset:28672
  v_mfma_f32_16x16x32_bf16 v[24:27], v[176:179], v[136:139], v[24:27]
  ds_read_b64_tr_b16 v[150:151], v231 offset:30720
  v_mfma_f32_16x16x32_bf16 v[28:31], v[176:179], v[140:143], v[28:31]
  ds_read_b64_tr_b16 v[152:153], v230 offset:32768
  v_mfma_f32_16x16x32_bf16 v[32:35], v[180:183], v[128:131], v[32:35]
  ds_read_b64_tr_b16 v[154:155], v230 offset:34816
  v_mfma_f32_16x16x32_bf16 v[36:39], v[180:183], v[132:135], v[36:39]
  ds_read_b64_tr_b16 v[156:157], v231 offset:32768
  v_mfma_f32_16x16x32_bf16 v[40:43], v[180:183], v[136:139], v[40:43]
  ds_read_b64_tr_b16 v[158:159], v231 offset:34816
  ds_read_b64_tr_b16 v[160:161], v230 offset:36864
  v_mfma_f32_16x16x32_bf16 v[44:47], v[180:183], v[140:143], v[44:47]
  ds_read_b64_tr_b16 v[162:163], v230 offset:38912
  v_mfma_f32_16x16x32_bf16 v[48:51], v[184:187], v[128:131], v[48:51]
  ds_read_b64_tr_b16 v[164:165], v231 offset:36864
  v_mfma_f32_16x16x32_bf16 v[52:55], v[184:187], v[132:135], v[52:55]
  ds_read_b64_tr_b16 v[166:167], v231 offset:38912
  v_mfma_f32_16x16x32_bf16 v[56:59], v[184:187], v[136:139], v[56:59]
  ds_read_b64_tr_b16 v[168:169], v232 offset:28672
  v_mfma_f32_16x16x32_bf16 v[60:63], v[184:187], v[140:143], v[60:63]
  ds_read_b64_tr_b16 v[170:171], v232 offset:29696
  v_mfma_f32_16x16x32_bf16 v[64:67], v[188:191], v[128:131], v[64:67]
  s_mov_b64 exec, vcc
  ds_read_b128 v[168:171], v233 offset:512
  s_mov_b64 exec, -1
  v_mfma_f32_16x16x32_bf16 v[68:71], v[188:191], v[132:135], v[68:71]
  v_add_u32 v230, 43008, v230
  v_mfma_f32_16x16x32_bf16 v[72:75], v[188:191], v[136:139], v[72:75]
  v_add_u32 v231, 43008, v231
  v_mfma_f32_16x16x32_bf16 v[76:79], v[188:191], v[140:143], v[76:79]
  v_add_u32 v232, 43008, v232
  v_mfma_f32_16x16x32_bf16 v[80:83], v[192:195], v[128:131], v[80:83]
  v_mfma_f32_16x16x32_bf16 v[84:87], v[192:195], v[132:135], v[84:87]
  v_mfma_f32_16x16x32_bf16 v[88:91], v[192:195], v[136:139], v[88:91]
  v_mfma_f32_16x16x32_bf16 v[92:95], v[192:195], v[140:143], v[92:95]
  v_mfma_f32_16x16x32_bf16 v[96:99], v[196:199], v[128:131], v[96:99]
  v_mfma_f32_16x16x32_bf16 v[100:103], v[196:199], v[132:135], v[100:103]
  v_mfma_f32_16x16x32_bf16 v[104:107], v[196:199], v[136:139], v[104:107]
  v_mfma_f32_16x16x32_bf16 v[108:111], v[196:199], v[140:143], v[108:111]
  s_waitcnt lgkmcnt(0)
  v_mfma_f32_16x16x32_bf16 v[0:3], v[144:147], v[112:115], v[0:3]
  ds_read_b128 v[128:131], v229 offset:16384
  v_mfma_f32_16x16x32_bf16 v[4:7], v[144:147], v[116:119], v[4:7]
  ds_read_b128 v[132:135], v229 offset:18432
  v_mfma_f32_16x16x32_bf16 v[8:11], v[144:147], v[120:123], v[8:11]
  ds_read_b128 v[136:139], v229 offset:20480
  v_mfma_f32_16x16x32_bf16 v[12:15], v[144:147], v[124:127], v[12:15]
  ds_read_b128 v[140:143], v229 offset:22528
  v_mfma_f32_16x16x32_bf16 v[16:19], v[148:151], v[112:115], v[16:19]
  ds_read_b64_tr_b16 v[172:173], v230 offset:0
  v_mfma_f32_16x16x32_bf16 v[20:23], v[148:151], v[116:119], v[20:23]
  ds_read_b64_tr_b16 v[174:175], v230 offset:2048
  v_mfma_f32_16x16x32_bf16 v[24:27], v[148:151], v[120:123], v[24:27]
  ds_read_b64_tr_b16 v[176:177], v231 offset:0
  v_mfma_f32_16x16x32_bf16 v[28:31], v[148:151], v[124:127], v[28:31]
  ds_read_b64_tr_b16 v[178:179], v231 offset:2048
  v_mfma_f32_16x16x32_bf16 v[32:35], v[152:155], v[112:115], v[32:35]
  ds_read_b64_tr_b16 v[180:181], v230 offset:4096
  v_mfma_f32_16x16x32_bf16 v[36:39], v[152:155], v[116:119], v[36:39]
  ds_read_b64_tr_b16 v[182:183], v230 offset:6144
  v_mfma_f32_16x16x32_bf16 v[40:43], v[152:155], v[120:123], v[40:43]
  ds_read_b64_tr_b16 v[184:185], v231 offset:4096
  v_mfma_f32_16x16x32_bf16 v[44:47], v[152:155], v[124:127], v[44:47]
  ds_read_b64_tr_b16 v[186:187], v231 offset:6144
  v_mfma_f32_16x16x32_bf16 v[48:51], v[156:159], v[112:115], v[48:51]
  ds_read_b64_tr_b16 v[188:189], v230 offset:8192
  v_mfma_f32_16x16x32_bf16 v[52:55], v[156:159], v[116:119], v[52:55]
  ds_read_b64_tr_b16 v[190:191], v230 offset:10240
  v_mfma_f32_16x16x32_bf16 v[56:59], v[156:159], v[120:123], v[56:59]
  ds_read_b64_tr_b16 v[192:193], v231 offset:8192
  v_mfma_f32_16x16x32_bf16 v[60:63], v[156:159], v[124:127], v[60:63]
  ds_read_b64_tr_b16 v[194:195], v231 offset:10240
  v_mfma_f32_16x16x32_bf16 v[64:67], v[160:163], v[112:115], v[64:67]
  ds_read_b64_tr_b16 v[196:197], v232 offset:0
  v_mfma_f32_16x16x32_bf16 v[68:71], v[160:163], v[116:119], v[68:71]
  ds_read_b64_tr_b16 v[198:199], v232 offset:1024
  v_mfma_f32_16x16x32_bf16 v[72:75], v[160:163], v[120:123], v[72:75]
  s_mov_b64 exec, vcc
  ds_read_b128 v[196:199], v233 offset:576
  s_mov_b64 exec, -1
  v_mfma_f32_16x16x32_bf16 v[76:79], v[160:163], v[124:127], v[76:79]
  v_mfma_f32_16x16x32_bf16 v[80:83], v[164:167], v[112:115], v[80:83]
  v_mfma_f32_16x16x32_bf16 v[84:87], v[164:167], v[116:119], v[84:87]
  v_mfma_f32_16x16x32_bf16 v[88:91], v[164:167], v[120:123], v[88:91]
  v_mfma_f32_16x16x32_bf16 v[92:95], v[164:167], v[124:127], v[92:95]
  v_mfma_f32_16x16x32_bf16 v[96:99], v[168:171], v[112:115], v[96:99]
  v_mfma_f32_16x16x32_bf16 v[100:103], v[168:171], v[116:119], v[100:103]
  v_mfma_f32_16x16x32_bf16 v[104:107], v[168:171], v[120:123], v[104:107]
  v_mfma_f32_16x16x32_bf16 v[108:111], v[168:171], v[124:127], v[108:111]
  s_waitcnt lgkmcnt(0)
  s_barrier
  v_mfma_f32_16x16x32_bf16 v[0:3], v[172:175], v[128:131], v[0:3]
  ds_read_b128 v[112:115], v228 offset:32768
  v_mfma_f32_16x16x32_bf16 v[4:7], v[172:175], v[132:135], v[4:7]
  ds_read_b128 v[116:119], v228 offset:34816
  v_mfma_f32_16x16x32_bf16 v[8:11], v[172:175], v[136:139], v[8:11]
  ds_read_b128 v[120:123], v228 offset:36864
  v_mfma_f32_16x16x32_bf16 v[12:15], v[172:175], v[140:143], v[12:15]
  ds_read_b128 v[124:127], v228 offset:38912
  v_mfma_f32_16x16x32_bf16 v[16:19], v[176:179], v[128:131], v[16:19]
  ds_read_b64_tr_b16 v[144:145], v230 offset:14336
  v_mfma_f32_16x16x32_bf16 v[20:23], v[176:179], v[132:135], v[20:23]
  ds_read_b64_tr_b16 v[146:147], v230 offset:16384
  v_mfma_f32_16x16x32_bf16 v[24:27], v[176:179], v[136:139], v[24:27]
  ds_read_b64_tr_b16 v[148:149], v231 offset:14336
  v_mfma_f32_16x16x32_bf16 v[28:31], v[176:179], v[140:143], v[28:31]
  ds_read_b64_tr_b16 v[150:151], v231 offset:16384
  v_mfma_f32_16x16x32_bf16 v[32:35], v[180:183], v[128:131], v[32:35]
  ds_read_b64_tr_b16 v[152:153], v230 offset:18432
  v_mfma_f32_16x16x32_bf16 v[36:39], v[180:183], v[132:135], v[36:39]
  ds_read_b64_tr_b16 v[154:155], v230 offset:20480
  v_mfma_f32_16x16x32_bf16 v[40:43], v[180:183], v[136:139], v[40:43]
  ds_read_b64_tr_b16 v[156:157], v231 offset:18432
  v_mfma_f32_16x16x32_bf16 v[44:47], v[180:183], v[140:143], v[44:47]
  ds_read_b64_tr_b16 v[158:159], v231 offset:20480
  v_mfma_f32_16x16x32_bf16 v[48:51], v[184:187], v[128:131], v[48:51]
  ds_read_b64_tr_b16 v[160:161], v230 offset:22528
  v_mfma_f32_16x16x32_bf16 v[52:55], v[184:187], v[132:135], v[52:55]
  ds_read_b64_tr_b16 v[162:163], v230 offset:24576
  v_mfma_f32_16x16x32_bf16 v[56:59], v[184:187], v[136:139], v[56:59]
  ds_read_b64_tr_b16 v[164:165], v231 offset:22528
  v_mfma_f32_16x16x32_bf16 v[60:63], v[184:187], v[140:143], v[60:63]
  ds_read_b64_tr_b16 v[166:167], v231 offset:24576
  v_mfma_f32_16x16x32_bf16 v[64:67], v[188:191], v[128:131], v[64:67]
  ds_read_b64_tr_b16 v[168:169], v232 offset:14336
  v_mfma_f32_16x16x32_bf16 v[68:71], v[188:191], v[132:135], v[68:71]
  ds_read_b64_tr_b16 v[170:171], v232 offset:15360
  v_mfma_f32_16x16x32_bf16 v[72:75], v[188:191], v[136:139], v[72:75]
  s_mov_b64 exec, vcc
  ds_read_b128 v[168:171], v233 offset:640
  s_mov_b64 exec, -1
  v_mfma_f32_16x16x32_bf16 v[76:79], v[188:191], v[140:143], v[76:79]
  v_mfma_f32_16x16x32_bf16 v[80:83], v[192:195], v[128:131], v[80:83]
  v_mfma_f32_16x16x32_bf16 v[84:87], v[192:195], v[132:135], v[84:87]
  v_mfma_f32_16x16x32_bf16 v[88:91], v[192:195], v[136:139], v[88:91]
  v_mfma_f32_16x16x32_bf16 v[92:95], v[192:195], v[140:143], v[92:95]
  v_mfma_f32_16x16x32_bf16 v[96:99], v[196:199], v[128:131], v[96:99]
  v_mfma_f32_16x16x32_bf16 v[100:103], v[196:199], v[132:135], v[100:103]
  v_mfma_f32_16x16x32_bf16 v[104:107], v[196:199], v[136:139], v[104:107]
  v_mfma_f32_16x16x32_bf16 v[108:111], v[196:199], v[140:143], v[108:111]
  s_waitcnt lgkmcnt(0)
  v_mfma_f32_16x16x32_bf16 v[0:3], v[144:147], v[112:115], v[0:3]
  ds_read_b128 v[128:131], v229 offset:32768
  ds_read_b128 v[132:135], v229 offset:34816
  v_mfma_f32_16x16x32_bf16 v[4:7], v[144:147], v[116:119], v[4:7]
  ds_read_b128 v[136:139], v229 offset:36864
  v_mfma_f32_16x16x32_bf16 v[8:11], v[144:147], v[120:123], v[8:11]
  ds_read_b128 v[140:143], v229 offset:38912
  v_mfma_f32_16x16x32_bf16 v[12:15], v[144:147], v[124:127], v[12:15]
  ds_read_b64_tr_b16 v[172:173], v230 offset:28672
  v_mfma_f32_16x16x32_bf16 v[16:19], v[148:151], v[112:115], v[16:19]
  ds_read_b64_tr_b16 v[174:175], v230 offset:30720
  v_mfma_f32_16x16x32_bf16 v[20:23], v[148:151], v[116:119], v[20:23]
  ds_read_b64_tr_b16 v[176:177], v231 offset:28672
  v_mfma_f32_16x16x32_bf16 v[24:27], v[148:151], v[120:123], v[24:27]
  ds_read_b64_tr_b16 v[178:179], v231 offset:30720
  v_mfma_f32_16x16x32_bf16 v[28:31], v[148:151], v[124:127], v[28:31]
  ds_read_b64_tr_b16 v[180:181], v230 offset:32768
  v_mfma_f32_16x16x32_bf16 v[32:35], v[152:155], v[112:115], v[32:35]
  ds_read_b64_tr_b16 v[182:183], v230 offset:34816
  v_mfma_f32_16x16x32_bf16 v[36:39], v[152:155], v[116:119], v[36:39]
  ds_read_b64_tr_b16 v[184:185], v231 offset:32768
  v_mfma_f32_16x16x32_bf16 v[40:43], v[152:155], v[120:123], v[40:43]
  ds_read_b64_tr_b16 v[186:187], v231 offset:34816
  ds_read_b64_tr_b16 v[188:189], v230 offset:36864
  v_mfma_f32_16x16x32_bf16 v[44:47], v[152:155], v[124:127], v[44:47]
  ds_read_b64_tr_b16 v[190:191], v230 offset:38912
  v_mfma_f32_16x16x32_bf16 v[48:51], v[156:159], v[112:115], v[48:51]
  ds_read_b64_tr_b16 v[192:193], v231 offset:36864
  v_mfma_f32_16x16x32_bf16 v[52:55], v[156:159], v[116:119], v[52:55]
  ds_read_b64_tr_b16 v[194:195], v231 offset:38912
  v_mfma_f32_16x16x32_bf16 v[56:59], v[156:159], v[120:123], v[56:59]
  ds_read_b64_tr_b16 v[196:197], v232 offset:28672
  v_mfma_f32_16x16x32_bf16 v[60:63], v[156:159], v[124:127], v[60:63]
  ds_read_b64_tr_b16 v[198:199], v232 offset:29696
  v_mfma_f32_16x16x32_bf16 v[64:67], v[160:163], v[112:115], v[64:67]
  s_mov_b64 exec, vcc
  ds_read_b128 v[196:199], v233 offset:704
  s_mov_b64 exec, -1
  v_mfma_f32_16x16x32_bf16 v[68:71], v[160:163], v[116:119], v[68:71]
  v_subrev_u32 v230, 43008, v230
  v_mfma_f32_16x16x32_bf16 v[72:75], v[160:163], v[120:123], v[72:75]
  v_subrev_u32 v231, 43008, v231
  v_mfma_f32_16x16x32_bf16 v[76:79], v[160:163], v[124:127], v[76:79]
  v_subrev_u32 v232, 43008, v232
  v_mfma_f32_16x16x32_bf16 v[80:83], v[164:167], v[112:115], v[80:83]
  v_mfma_f32_16x16x32_bf16 v[84:87], v[164:167], v[116:119], v[84:87]
  v_mfma_f32_16x16x32_bf16 v[88:91], v[164:167], v[120:123], v[88:91]
  v_mfma_f32_16x16x32_bf16 v[92:95], v[164:167], v[124:127], v[92:95]
  v_mfma_f32_16x16x32_bf16 v[96:99], v[168:171], v[112:115], v[96:99]
  v_mfma_f32_16x16x32_bf16 v[100:103], v[168:171], v[116:119], v[100:103]
  v_mfma_f32_16x16x32_bf16 v[104:107], v[168:171], v[120:123], v[104:107]
  v_mfma_f32_16x16x32_bf16 v[108:111], v[168:171], v[124:127], v[108:111]
  s_waitcnt lgkmcnt(0)
  s_barrier
  v_mfma_f32_16x16x32_bf16 v[0:3], v[172:175], v[128:131], v[0:3]
  ds_read_b128 v[112:115], v228 offset:0
  v_mfma_f32_16x16x32_bf16 v[4:7], v[172:175], v[132:135], v[4:7]
  ds_read_b128 v[116:119], v228 offset:2048
  v_mfma_f32_16x16x32_bf16 v[8:11], v[172:175], v[136:139], v[8:11]
  ds_read_b128 v[120:123], v228 offset:4096
  v_mfma_f32_16x16x32_bf16 v[12:15], v[172:175], v[140:143], v[12:15]
  ds_read_b128 v[124:127], v228 offset:6144
  v_mfma_f32_16x16x32_bf16 v[16:19], v[176:179], v[128:131], v[16:19]
  ds_read_b64_tr_b16 v[144:145], v230 offset:0
  v_mfma_f32_16x16x32_bf16 v[20:23], v[176:179], v[132:135], v[20:23]
  ds_read_b64_tr_b16 v[146:147], v230 offset:2048
  v_mfma_f32_16x16x32_bf16 v[24:27], v[176:179], v[136:139], v[24:27]
  ds_read_b64_tr_b16 v[148:149], v231 offset:0
  v_mfma_f32_16x16x32_bf16 v[28:31], v[176:179], v[140:143], v[28:31]
  ds_read_b64_tr_b16 v[150:151], v231 offset:2048
  v_mfma_f32_16x16x32_bf16 v[32:35], v[180:183], v[128:131], v[32:35]
  ds_read_b64_tr_b16 v[152:153], v230 offset:4096
  v_mfma_f32_16x16x32_bf16 v[36:39], v[180:183], v[132:135], v[36:39]
  ds_read_b64_tr_b16 v[154:155], v230 offset:6144
  v_mfma_f32_16x16x32_bf16 v[40:43], v[180:183], v[136:139], v[40:43]
  ds_read_b64_tr_b16 v[156:157], v231 offset:4096
  v_mfma_f32_16x16x32_bf16 v[44:47], v[180:183], v[140:143], v[44:47]
  ds_read_b64_tr_b16 v[158:159], v231 offset:6144
  v_mfma_f32_16x16x32_bf16 v[48:51], v[184:187], v[128:131], v[48:51]
  ds_read_b64_tr_b16 v[160:161], v230 offset:8192
  v_mfma_f32_16x16x32_bf16 v[52:55], v[184:187], v[132:135], v[52:55]
  ds_read_b64_tr_b16 v[162:163], v230 offset:10240
  v_mfma_f32_16x16x32_bf16 v[56:59], v[184:187], v[136:139], v[56:59]
  ds_read_b64_tr_b16 v[164:165], v231 offset:8192
  v_mfma_f32_16x16x32_bf16 v[60:63], v[184:187], v[140:143], v[60:63]
  ds_read_b64_tr_b16 v[166:167], v231 offset:10240
  v_mfma_f32_16x16x32_bf16 v[64:67], v[188:191], v[128:131], v[64:67]
  ds_read_b64_tr_b16 v[168:169], v232 offset:0
  v_mfma_f32_16x16x32_bf16 v[68:71], v[188:191], v[132:135], v[68:71]
  ds_read_b64_tr_b16 v[170:171], v232 offset:1024
  v_mfma_f32_16x16x32_bf16 v[72:75], v[188:191], v[136:139], v[72:75]
  s_mov_b64 exec, vcc
  ds_read_b128 v[168:171], v233 offset:768
  s_mov_b64 exec, -1
  v_mfma_f32_16x16x32_bf16 v[76:79], v[188:191], v[140:143], v[76:79]
  v_mfma_f32_16x16x32_bf16 v[80:83], v[192:195], v[128:131], v[80:83]
  v_mfma_f32_16x16x32_bf16 v[84:87], v[192:195], v[132:135], v[84:87]
  v_mfma_f32_16x16x32_bf16 v[88:91], v[192:195], v[136:139], v[88:91]
  v_mfma_f32_16x16x32_bf16 v[92:95], v[192:195], v[140:143], v[92:95]
  v_mfma_f32_16x16x32_bf16 v[96:99], v[196:199], v[128:131], v[96:99]
  v_mfma_f32_16x16x32_bf16 v[100:103], v[196:199], v[132:135], v[100:103]
  v_mfma_f32_16x16x32_bf16 v[104:107], v[196:199], v[136:139], v[104:107]
  v_mfma_f32_16x16x32_bf16 v[108:111], v[196:199], v[140:143], v[108:111]
  s_waitcnt lgkmcnt(0)
  v_mfma_f32_16x16x32_bf16 v[0:3], v[144:147], v[112:115], v[0:3]
  ds_read_b128 v[128:131], v229 offset:0
  v_mfma_f32_16x16x32_bf16 v[4:7], v[144:147], v[116:119], v[4:7]
  ds_read_b128 v[132:135], v229 offset:2048
  v_mfma_f32_16x16x32_bf16 v[8:11], v[144:147], v[120:123], v[8:11]
  ds_read_b128 v[136:139], v229 offset:4096
  v_mfma_f32_16x16x32_bf16 v[12:15], v[144:147], v[124:127], v[12:15]
  ds_read_b128 v[140:143], v229 offset:6144
  v_mfma_f32_16x16x32_bf16 v[16:19], v[148:151], v[112:115], v[16:19]
  ds_read_b64_tr_b16 v[172:173], v230 offset:14336
  v_mfma_f32_16x16x32_bf16 v[20:23], v[148:151], v[116:119], v[20:23]
  ds_read_b64_tr_b16 v[174:175], v230 offset:16384
  v_mfma_f32_16x16x32_bf16 v[24:27], v[148:151], v[120:123], v[24:27]
  ds_read_b64_tr_b16 v[176:177], v231 offset:14336
  v_mfma_f32_16x16x32_bf16 v[28:31], v[148:151], v[124:127], v[28:31]
  ds_read_b64_tr_b16 v[178:179], v231 offset:16384
  v_mfma_f32_16x16x32_bf16 v[32:35], v[152:155], v[112:115], v[32:35]
  ds_read_b64_tr_b16 v[180:181], v230 offset:18432
  v_mfma_f32_16x16x32_bf16 v[36:39], v[152:155], v[116:119], v[36:39]
  ds_read_b64_tr_b16 v[182:183], v230 offset:20480
  v_mfma_f32_16x16x32_bf16 v[40:43], v[152:155], v[120:123], v[40:43]
  ds_read_b64_tr_b16 v[184:185], v231 offset:18432
  v_mfma_f32_16x16x32_bf16 v[44:47], v[152:155], v[124:127], v[44:47]
  ds_read_b64_tr_b16 v[186:187], v231 offset:20480
  v_mfma_f32_16x16x32_bf16 v[48:51], v[156:159], v[112:115], v[48:51]
  ds_read_b64_tr_b16 v[188:189], v230 offset:22528
  v_mfma_f32_16x16x32_bf16 v[52:55], v[156:159], v[116:119], v[52:55]
  ds_read_b64_tr_b16 v[190:191], v230 offset:24576
  v_mfma_f32_16x16x32_bf16 v[56:59], v[156:159], v[120:123], v[56:59]
  ds_read_b64_tr_b16 v[192:193], v231 offset:22528
  v_mfma_f32_16x16x32_bf16 v[60:63], v[156:159], v[124:127], v[60:63]
  ds_read_b64_tr_b16 v[194:195], v231 offset:24576
  v_mfma_f32_16x16x32_bf16 v[64:67], v[160:163], v[112:115], v[64:67]
  ds_read_b64_tr_b16 v[196:197], v232 offset:14336
  v_mfma_f32_16x16x32_bf16 v[68:71], v[160:163], v[116:119], v[68:71]
  ds_read_b64_tr_b16 v[198:199], v232 offset:15360
  v_mfma_f32_16x16x32_bf16 v[72:75], v[160:163], v[120:123], v[72:75]
  s_mov_b64 exec, vcc
  ds_read_b128 v[196:199], v233 offset:832
  s_mov_b64 exec, -1
  v_mfma_f32_16x16x32_bf16 v[76:79], v[160:163], v[124:127], v[76:79]
  v_mfma_f32_16x16x32_bf16 v[80:83], v[164:167], v[112:115], v[80:83]
  v_mfma_f32_16x16x32_bf16 v[84:87], v[164:167], v[116:119], v[84:87]
  v_mfma_f32_16x16x32_bf16 v[88:91], v[164:167], v[120:123], v[88:91]
  v_mfma_f32_16x16x32_bf16 v[92:95], v[164:167], v[124:127], v[92:95]
  v_mfma_f32_16x16x32_bf16 v[96:99], v[168:171], v[112:115], v[96:99]
  v_mfma_f32_16x16x32_bf16 v[100:103], v[168:171], v[116:119], v[100:103]
  v_mfma_f32_16x16x32_bf16 v[104:107], v[168:171], v[120:123], v[104:107]
  v_mfma_f32_16x16x32_bf16 v[108:111], v[168:171], v[124:127], v[108:111]
  s_waitcnt lgkmcnt(0)
  s_barrier
  v_mfma_f32_16x16x32_bf16 v[0:3], v[172:175], v[128:131], v[0:3]
  ds_read_b128 v[112:115], v228 offset:16384
  ds_read_b128 v[116:119], v228 offset:18432
  v_mfma_f32_16x16x32_bf16 v[4:7], v[172:175], v[132:135], v[4:7]
  ds_read_b128 v[120:123], v228 offset:20480
  v_mfma_f32_16x16x32_bf16 v[8:11], v[172:175], v[136:139], v[8:11]
  ds_read_b128 v[124:127], v228 offset:22528
  v_mfma_f32_16x16x32_bf16 v[12:15], v[172:175], v[140:143], v[12:15]
  ds_read_b64_tr_b16 v[144:145], v230 offset:28672
  v_mfma_f32_16x16x32_bf16 v[16:19], v[176:179], v[128:131], v[16:19]
  ds_read_b64_tr_b16 v[146:147], v230 offset:30720
  v_mfma_f32_16x16x32_bf16 v[20:23], v[176:179], v[132:135], v[20:23]
  ds_read_b64_tr_b16 v[148:149], v231 offset:28672
  v_mfma_f32_16x16x32_bf16 v[24:27], v[176:179], v[136:139], v[24:27]
  ds_read_b64_tr_b16 v[150:151], v231 offset:30720
  v_mfma_f32_16x16x32_bf16 v[28:31], v[176:179], v[140:143], v[28:31]
  ds_read_b64_tr_b16 v[152:153], v230 offset:32768
  v_mfma_f32_16x16x32_bf16 v[32:35], v[180:183], v[128:131], v[32:35]
  ds_read_b64_tr_b16 v[154:155], v230 offset:34816
  v_mfma_f32_16x16x32_bf16 v[36:39], v[180:183], v[132:135], v[36:39]
  ds_read_b64_tr_b16 v[156:157], v231 offset:32768
  v_mfma_f32_16x16x32_bf16 v[40:43], v[180:183], v[136:139], v[40:43]
  ds_read_b64_tr_b16 v[158:159], v231 offset:34816
  ds_read_b64_tr_b16 v[160:161], v230 offset:36864
  v_mfma_f32_16x16x32_bf16 v[44:47], v[180:183], v[140:143], v[44:47]
  ds_read_b64_tr_b16 v[162:163], v230 offset:38912
  v_mfma_f32_16x16x32_bf16 v[48:51], v[184:187], v[128:131], v[48:51]
  ds_read_b64_tr_b16 v[164:165], v231 offset:36864
  v_mfma_f32_16x16x32_bf16 v[52:55], v[184:187], v[132:135], v[52:55]
  ds_read_b64_tr_b16 v[166:167], v231 offset:38912
  v_mfma_f32_16x16x32_bf16 v[56:59], v[184:187], v[136:139], v[56:59]
  ds_read_b64_tr_b16 v[168:169], v232 offset:28672
  v_mfma_f32_16x16x32_bf16 v[60:63], v[184:187], v[140:143], v[60:63]
  ds_read_b64_tr_b16 v[170:171], v232 offset:29696
  v_mfma_f32_16x16x32_bf16 v[64:67], v[188:191], v[128:131], v[64:67]
  s_mov_b64 exec, vcc
  ds_read_b128 v[168:171], v233 offset:896
  s_mov_b64 exec, -1
  v_mfma_f32_16x16x32_bf16 v[68:71], v[188:191], v[132:135], v[68:71]
  v_add_u32 v230, 43008, v230
  v_mfma_f32_16x16x32_bf16 v[72:75], v[188:191], v[136:139], v[72:75]
  v_add_u32 v231, 43008, v231
  v_mfma_f32_16x16x32_bf16 v[76:79], v[188:191], v[140:143], v[76:79]
  v_add_u32 v232, 43008, v232
  v_mfma_f32_16x16x32_bf16 v[80:83], v[192:195], v[128:131], v[80:83]
  v_mfma_f32_16x16x32_bf16 v[84:87], v[192:195], v[132:135], v[84:87]
  v_mfma_f32_16x16x32_bf16 v[88:91], v[192:195], v[136:139], v[88:91]
  v_mfma_f32_16x16x32_bf16 v[92:95], v[192:195], v[140:143], v[92:95]
  v_mfma_f32_16x16x32_bf16 v[96:99], v[196:199], v[128:131], v[96:99]
  v_mfma_f32_16x16x32_bf16 v[100:103], v[196:199], v[132:135], v[100:103]
  v_mfma_f32_16x16x32_bf16 v[104:107], v[196:199], v[136:139], v[104:107]
  v_mfma_f32_16x16x32_bf16 v[108:111], v[196:199], v[140:143], v[108:111]
  s_waitcnt lgkmcnt(0)
  v_mfma_f32_16x16x32_bf16 v[0:3], v[144:147], v[112:115], v[0:3]
  ds_read_b128 v[128:131], v229 offset:16384
  v_mfma_f32_16x16x32_bf16 v[4:7], v[144:147], v[116:119], v[4:7]
  ds_read_b128 v[132:135], v229 offset:18432
  v_mfma_f32_16x16x32_bf16 v[8:11], v[144:147], v[120:123], v[8:11]
  ds_read_b128 v[136:139], v229 offset:20480
  v_mfma_f32_16x16x32_bf16 v[12:15], v[144:147], v[124:127], v[12:15]
  ds_read_b128 v[140:143], v229 offset:22528
  v_mfma_f32_16x16x32_bf16 v[16:19], v[148:151], v[112:115], v[16:19]
  ds_read_b64_tr_b16 v[172:173], v230 offset:0
  v_mfma_f32_16x16x32_bf16 v[20:23], v[148:151], v[116:119], v[20:23]
  ds_read_b64_tr_b16 v[174:175], v230 offset:2048
  v_mfma_f32_16x16x32_bf16 v[24:27], v[148:151], v[120:123], v[24:27]
  ds_read_b64_tr_b16 v[176:177], v231 offset:0
  v_mfma_f32_16x16x32_bf16 v[28:31], v[148:151], v[124:127], v[28:31]
  ds_read_b64_tr_b16 v[178:179], v231 offset:2048
  v_mfma_f32_16x16x32_bf16 v[32:35], v[152:155], v[112:115], v[32:35]
  ds_read_b64_tr_b16 v[180:181], v230 offset:4096
  v_mfma_f32_16x16x32_bf16 v[36:39], v[152:155], v[116:119], v[36:39]
  ds_read_b64_tr_b16 v[182:183], v230 offset:6144
  v_mfma_f32_16x16x32_bf16 v[40:43], v[152:155], v[120:123], v[40:43]
  ds_read_b64_tr_b16 v[184:185], v231 offset:4096
  v_mfma_f32_16x16x32_bf16 v[44:47], v[152:155], v[124:127], v[44:47]
  ds_read_b64_tr_b16 v[186:187], v231 offset:6144
  v_mfma_f32_16x16x32_bf16 v[48:51], v[156:159], v[112:115], v[48:51]
  ds_read_b64_tr_b16 v[188:189], v230 offset:8192
  v_mfma_f32_16x16x32_bf16 v[52:55], v[156:159], v[116:119], v[52:55]
  ds_read_b64_tr_b16 v[190:191], v230 offset:10240
  v_mfma_f32_16x16x32_bf16 v[56:59], v[156:159], v[120:123], v[56:59]
  ds_read_b64_tr_b16 v[192:193], v231 offset:8192
  v_mfma_f32_16x16x32_bf16 v[60:63], v[156:159], v[124:127], v[60:63]
  ds_read_b64_tr_b16 v[194:195], v231 offset:10240
  v_mfma_f32_16x16x32_bf16 v[64:67], v[160:163], v[112:115], v[64:67]
  ds_read_b64_tr_b16 v[196:197], v232 offset:0
  v_mfma_f32_16x16x32_bf16 v[68:71], v[160:163], v[116:119], v[68:71]
  ds_read_b64_tr_b16 v[198:199], v232 offset:1024
  v_mfma_f32_16x16x32_bf16 v[72:75], v[160:163], v[120:123], v[72:75]
  s_mov_b64 exec, vcc
  ds_read_b128 v[196:199], v233 offset:960
  s_mov_b64 exec, -1
  v_mfma_f32_16x16x32_bf16 v[76:79], v[160:163], v[124:127], v[76:79]
  v_mfma_f32_16x16x32_bf16 v[80:83], v[164:167], v[112:115], v[80:83]
  v_mfma_f32_16x16x32_bf16 v[84:87], v[164:167], v[116:119], v[84:87]
  v_mfma_f32_16x16x32_bf16 v[88:91], v[164:167], v[120:123], v[88:91]
  v_mfma_f32_16x16x32_bf16 v[92:95], v[164:167], v[124:127], v[92:95]
  v_mfma_f32_16x16x32_bf16 v[96:99], v[168:171], v[112:115], v[96:99]
  v_mfma_f32_16x16x32_bf16 v[100:103], v[168:171], v[116:119], v[100:103]
  v_mfma_f32_16x16x32_bf16 v[104:107], v[168:171], v[120:123], v[104:107]
  v_mfma_f32_16x16x32_bf16 v[108:111], v[168:171], v[124:127], v[108:111]
  s_waitcnt lgkmcnt(0)
  s_barrier
  v_mfma_f32_16x16x32_bf16 v[0:3], v[172:175], v[128:131], v[0:3]
  ds_read_b128 v[112:115], v228 offset:32768
  v_mfma_f32_16x16x32_bf16 v[4:7], v[172:175], v[132:135], v[4:7]
  ds_read_b128 v[116:119], v228 offset:34816
  v_mfma_f32_16x16x32_bf16 v[8:11], v[172:175], v[136:139], v[8:11]
  ds_read_b128 v[120:123], v228 offset:36864
  v_mfma_f32_16x16x32_bf16 v[12:15], v[172:175], v[140:143], v[12:15]
  ds_read_b128 v[124:127], v228 offset:38912
  v_mfma_f32_16x16x32_bf16 v[16:19], v[176:179], v[128:131], v[16:19]
  ds_read_b64_tr_b16 v[144:145], v230 offset:14336
  v_mfma_f32_16x16x32_bf16 v[20:23], v[176:179], v[132:135], v[20:23]
  ds_read_b64_tr_b16 v[146:147], v230 offset:16384
  v_mfma_f32_16x16x32_bf16 v[24:27], v[176:179], v[136:139], v[24:27]
  ds_read_b64_tr_b16 v[148:149], v231 offset:14336
  v_mfma_f32_16x16x32_bf16 v[28:31], v[176:179], v[140:143], v[28:31]
  ds_read_b64_tr_b16 v[150:151], v231 offset:16384
  v_mfma_f32_16x16x32_bf16 v[32:35], v[180:183], v[128:131], v[32:35]
  ds_read_b64_tr_b16 v[152:153], v230 offset:18432
  v_mfma_f32_16x16x32_bf16 v[36:39], v[180:183], v[132:135], v[36:39]
  ds_read_b64_tr_b16 v[154:155], v230 offset:20480
  v_mfma_f32_16x16x32_bf16 v[40:43], v[180:183], v[136:139], v[40:43]
  ds_read_b64_tr_b16 v[156:157], v231 offset:18432
  v_mfma_f32_16x16x32_bf16 v[44:47], v[180:183], v[140:143], v[44:47]
  ds_read_b64_tr_b16 v[158:159], v231 offset:20480
  v_mfma_f32_16x16x32_bf16 v[48:51], v[184:187], v[128:131], v[48:51]
  ds_read_b64_tr_b16 v[160:161], v230 offset:22528
  v_mfma_f32_16x16x32_bf16 v[52:55], v[184:187], v[132:135], v[52:55]
  ds_read_b64_tr_b16 v[162:163], v230 offset:24576
  v_mfma_f32_16x16x32_bf16 v[56:59], v[184:187], v[136:139], v[56:59]
  ds_read_b64_tr_b16 v[164:165], v231 offset:22528
  v_mfma_f32_16x16x32_bf16 v[60:63], v[184:187], v[140:143], v[60:63]
  ds_read_b64_tr_b16 v[166:167], v231 offset:24576
  v_mfma_f32_16x16x32_bf16 v[64:67], v[188:191], v[128:131], v[64:67]
  ds_read_b64_tr_b16 v[168:169], v232 offset:14336
  v_mfma_f32_16x16x32_bf16 v[68:71], v[188:191], v[132:135], v[68:71]
  ds_read_b64_tr_b16 v[170:171], v232 offset:15360
  v_mfma_f32_16x16x32_bf16 v[72:75], v[188:191], v[136:139], v[72:75]
  s_mov_b64 exec, vcc
  ds_read_b128 v[168:171], v233 offset:1024
  s_mov_b64 exec, -1
  v_mfma_f32_16x16x32_bf16 v[76:79], v[188:191], v[140:143], v[76:79]
  v_mfma_f32_16x16x32_bf16 v[80:83], v[192:195], v[128:131], v[80:83]
  v_mfma_f32_16x16x32_bf16 v[84:87], v[192:195], v[132:135], v[84:87]
  v_mfma_f32_16x16x32_bf16 v[88:91], v[192:195], v[136:139], v[88:91]
  v_mfma_f32_16x16x32_bf16 v[92:95], v[192:195], v[140:143], v[92:95]
  v_mfma_f32_16x16x32_bf16 v[96:99], v[196:199], v[128:131], v[96:99]
  v_mfma_f32_16x16x32_bf16 v[100:103], v[196:199], v[132:135], v[100:103]
  v_mfma_f32_16x16x32_bf16 v[104:107], v[196:199], v[136:139], v[104:107]
  v_mfma_f32_16x16x32_bf16 v[108:111], v[196:199], v[140:143], v[108:111]
  s_waitcnt lgkmcnt(0)
  v_mfma_f32_16x16x32_bf16 v[0:3], v[144:147], v[112:115], v[0:3]
  ds_read_b128 v[128:131], v229 offset:32768
  ds_read_b128 v[132:135], v229 offset:34816
  v_mfma_f32_16x16x32_bf16 v[4:7], v[144:147], v[116:119], v[4:7]
  ds_read_b128 v[136:139], v229 offset:36864
  v_mfma_f32_16x16x32_bf16 v[8:11], v[144:147], v[120:123], v[8:11]
  ds_read_b128 v[140:143], v229 offset:38912
  v_mfma_f32_16x16x32_bf16 v[12:15], v[144:147], v[124:127], v[12:15]
  ds_read_b64_tr_b16 v[172:173], v230 offset:28672
  v_mfma_f32_16x16x32_bf16 v[16:19], v[148:151], v[112:115], v[16:19]
  ds_read_b64_tr_b16 v[174:175], v230 offset:30720
  v_mfma_f32_16x16x32_bf16 v[20:23], v[148:151], v[116:119], v[20:23]
  ds_read_b64_tr_b16 v[176:177], v231 offset:28672
  v_mfma_f32_16x16x32_bf16 v[24:27], v[148:151], v[120:123], v[24:27]
  ds_read_b64_tr_b16 v[178:179], v231 offset:30720
  v_mfma_f32_16x16x32_bf16 v[28:31], v[148:151], v[124:127], v[28:31]
  ds_read_b64_tr_b16 v[180:181], v230 offset:32768
  v_mfma_f32_16x16x32_bf16 v[32:35], v[152:155], v[112:115], v[32:35]
  ds_read_b64_tr_b16 v[182:183], v230 offset:34816
  v_mfma_f32_16x16x32_bf16 v[36:39], v[152:155], v[116:119], v[36:39]
  ds_read_b64_tr_b16 v[184:185], v231 offset:32768
  v_mfma_f32_16x16x32_bf16 v[40:43], v[152:155], v[120:123], v[40:43]
  ds_read_b64_tr_b16 v[186:187], v231 offset:34816
  ds_read_b64_tr_b16 v[188:189], v230 offset:36864
  v_mfma_f32_16x16x32_bf16 v[44:47], v[152:155], v[124:127], v[44:47]
  ds_read_b64_tr_b16 v[190:191], v230 offset:38912
  v_mfma_f32_16x16x32_bf16 v[48:51], v[156:159], v[112:115], v[48:51]
  ds_read_b64_tr_b16 v[192:193], v231 offset:36864
  v_mfma_f32_16x16x32_bf16 v[52:55], v[156:159], v[116:119], v[52:55]
  ds_read_b64_tr_b16 v[194:195], v231 offset:38912
  v_mfma_f32_16x16x32_bf16 v[56:59], v[156:159], v[120:123], v[56:59]
  ds_read_b64_tr_b16 v[196:197], v232 offset:28672
  v_mfma_f32_16x16x32_bf16 v[60:63], v[156:159], v[124:127], v[60:63]
  ds_read_b64_tr_b16 v[198:199], v232 offset:29696
  v_mfma_f32_16x16x32_bf16 v[64:67], v[160:163], v[112:115], v[64:67]
  s_mov_b64 exec, vcc
  ds_read_b128 v[196:199], v233 offset:1088
  s_mov_b64 exec, -1
  v_mfma_f32_16x16x32_bf16 v[68:71], v[160:163], v[116:119], v[68:71]
  v_subrev_u32 v230, 43008, v230
  v_mfma_f32_16x16x32_bf16 v[72:75], v[160:163], v[120:123], v[72:75]
  v_subrev_u32 v231, 43008, v231
  v_mfma_f32_16x16x32_bf16 v[76:79], v[160:163], v[124:127], v[76:79]
  v_subrev_u32 v232, 43008, v232
  v_mfma_f32_16x16x32_bf16 v[80:83], v[164:167], v[112:115], v[80:83]
  v_mfma_f32_16x16x32_bf16 v[84:87], v[164:167], v[116:119], v[84:87]
  v_mfma_f32_16x16x32_bf16 v[88:91], v[164:167], v[120:123], v[88:91]
  v_mfma_f32_16x16x32_bf16 v[92:95], v[164:167], v[124:127], v[92:95]
  v_mfma_f32_16x16x32_bf16 v[96:99], v[168:171], v[112:115], v[96:99]
  v_mfma_f32_16x16x32_bf16 v[100:103], v[168:171], v[116:119], v[100:103]
  v_mfma_f32_16x16x32_bf16 v[104:107], v[168:171], v[120:123], v[104:107]
  v_mfma_f32_16x16x32_bf16 v[108:111], v[168:171], v[124:127], v[108:111]
  s_waitcnt lgkmcnt(0)
  s_barrier
  v_mfma_f32_16x16x32_bf16 v[0:3], v[172:175], v[128:131], v[0:3]
  ds_read_b128 v[112:115], v228 offset:0
  v_mfma_f32_16x16x32_bf16 v[4:7], v[172:175], v[132:135], v[4:7]
  ds_read_b128 v[116:119], v228 offset:2048
  v_mfma_f32_16x16x32_bf16 v[8:11], v[172:175], v[136:139], v[8:11]
  ds_read_b128 v[120:123], v228 offset:4096
  v_mfma_f32_16x16x32_bf16 v[12:15], v[172:175], v[140:143], v[12:15]
  ds_read_b128 v[124:127], v228 offset:6144
  v_mfma_f32_16x16x32_bf16 v[16:19], v[176:179], v[128:131], v[16:19]
  ds_read_b64_tr_b16 v[144:145], v230 offset:0
  v_mfma_f32_16x16x32_bf16 v[20:23], v[176:179], v[132:135], v[20:23]
  ds_read_b64_tr_b16 v[146:147], v230 offset:2048
  v_mfma_f32_16x16x32_bf16 v[24:27], v[176:179], v[136:139], v[24:27]
  ds_read_b64_tr_b16 v[148:149], v231 offset:0
  v_mfma_f32_16x16x32_bf16 v[28:31], v[176:179], v[140:143], v[28:31]
  ds_read_b64_tr_b16 v[150:151], v231 offset:2048
  v_mfma_f32_16x16x32_bf16 v[32:35], v[180:183], v[128:131], v[32:35]
  ds_read_b64_tr_b16 v[152:153], v230 offset:4096
  v_mfma_f32_16x16x32_bf16 v[36:39], v[180:183], v[132:135], v[36:39]
  ds_read_b64_tr_b16 v[154:155], v230 offset:6144
  v_mfma_f32_16x16x32_bf16 v[40:43], v[180:183], v[136:139], v[40:43]
  ds_read_b64_tr_b16 v[156:157], v231 offset:4096
  v_mfma_f32_16x16x32_bf16 v[44:47], v[180:183], v[140:143], v[44:47]
  ds_read_b64_tr_b16 v[158:159], v231 offset:6144
  v_mfma_f32_16x16x32_bf16 v[48:51], v[184:187], v[128:131], v[48:51]
  ds_read_b64_tr_b16 v[160:161], v230 offset:8192
  v_mfma_f32_16x16x32_bf16 v[52:55], v[184:187], v[132:135], v[52:55]
  ds_read_b64_tr_b16 v[162:163], v230 offset:10240
  v_mfma_f32_16x16x32_bf16 v[56:59], v[184:187], v[136:139], v[56:59]
  ds_read_b64_tr_b16 v[164:165], v231 offset:8192
  v_mfma_f32_16x16x32_bf16 v[60:63], v[184:187], v[140:143], v[60:63]
  ds_read_b64_tr_b16 v[166:167], v231 offset:10240
  v_mfma_f32_16x16x32_bf16 v[64:67], v[188:191], v[128:131], v[64:67]
  ds_read_b64_tr_b16 v[168:169], v232 offset:0
  v_mfma_f32_16x16x32_bf16 v[68:71], v[188:191], v[132:135], v[68:71]
  ds_read_b64_tr_b16 v[170:171], v232 offset:1024
  v_mfma_f32_16x16x32_bf16 v[72:75], v[188:191], v[136:139], v[72:75]
  s_mov_b64 exec, vcc
  ds_read_b128 v[168:171], v233 offset:1152
  s_mov_b64 exec, -1
  v_mfma_f32_16x16x32_bf16 v[76:79], v[188:191], v[140:143], v[76:79]
  v_mfma_f32_16x16x32_bf16 v[80:83], v[192:195], v[128:131], v[80:83]
  v_mfma_f32_16x16x32_bf16 v[84:87], v[192:195], v[132:135], v[84:87]
  v_mfma_f32_16x16x32_bf16 v[88:91], v[192:195], v[136:139], v[88:91]
  v_mfma_f32_16x16x32_bf16 v[92:95], v[192:195], v[140:143], v[92:95]
  v_mfma_f32_16x16x32_bf16 v[96:99], v[196:199], v[128:131], v[96:99]
  v_mfma_f32_16x16x32_bf16 v[100:103], v[196:199], v[132:135], v[100:103]
  v_mfma_f32_16x16x32_bf16 v[104:107], v[196:199], v[136:139], v[104:107]
  v_mfma_f32_16x16x32_bf16 v[108:111], v[196:199], v[140:143], v[108:111]
  s_waitcnt lgkmcnt(0)
  v_mfma_f32_16x16x32_bf16 v[0:3], v[144:147], v[112:115], v[0:3]
  ds_read_b128 v[128:131], v229 offset:0
  v_mfma_f32_16x16x32_bf16 v[4:7], v[144:147], v[116:119], v[4:7]
  ds_read_b128 v[132:135], v229 offset:2048
  v_mfma_f32_16x16x32_bf16 v[8:11], v[144:147], v[120:123], v[8:11]
  ds_read_b128 v[136:139], v229 offset:4096
  v_mfma_f32_16x16x32_bf16 v[12:15], v[144:147], v[124:127], v[12:15]
  ds_read_b128 v[140:143], v229 offset:6144
  v_mfma_f32_16x16x32_bf16 v[16:19], v[148:151], v[112:115], v[16:19]
  ds_read_b64_tr_b16 v[172:173], v230 offset:14336
  v_mfma_f32_16x16x32_bf16 v[20:23], v[148:151], v[116:119], v[20:23]
  ds_read_b64_tr_b16 v[174:175], v230 offset:16384
  v_mfma_f32_16x16x32_bf16 v[24:27], v[148:151], v[120:123], v[24:27]
  ds_read_b64_tr_b16 v[176:177], v231 offset:14336
  v_mfma_f32_16x16x32_bf16 v[28:31], v[148:151], v[124:127], v[28:31]
  ds_read_b64_tr_b16 v[178:179], v231 offset:16384
  v_mfma_f32_16x16x32_bf16 v[32:35], v[152:155], v[112:115], v[32:35]
  ds_read_b64_tr_b16 v[180:181], v230 offset:18432
  v_mfma_f32_16x16x32_bf16 v[36:39], v[152:155], v[116:119], v[36:39]
  ds_read_b64_tr_b16 v[182:183], v230 offset:20480
  v_mfma_f32_16x16x32_bf16 v[40:43], v[152:155], v[120:123], v[40:43]
  ds_read_b64_tr_b16 v[184:185], v231 offset:18432
  v_mfma_f32_16x16x32_bf16 v[44:47], v[152:155], v[124:127], v[44:47]
  ds_read_b64_tr_b16 v[186:187], v231 offset:20480
  v_mfma_f32_16x16x32_bf16 v[48:51], v[156:159], v[112:115], v[48:51]
  ds_read_b64_tr_b16 v[188:189], v230 offset:22528
  v_mfma_f32_16x16x32_bf16 v[52:55], v[156:159], v[116:119], v[52:55]
  ds_read_b64_tr_b16 v[190:191], v230 offset:24576
  v_mfma_f32_16x16x32_bf16 v[56:59], v[156:159], v[120:123], v[56:59]
  ds_read_b64_tr_b16 v[192:193], v231 offset:22528
  v_mfma_f32_16x16x32_bf16 v[60:63], v[156:159], v[124:127], v[60:63]
  ds_read_b64_tr_b16 v[194:195], v231 offset:24576
  v_mfma_f32_16x16x32_bf16 v[64:67], v[160:163], v[112:115], v[64:67]
  ds_read_b64_tr_b16 v[196:197], v232 offset:14336
  v_mfma_f32_16x16x32_bf16 v[68:71], v[160:163], v[116:119], v[68:71]
  ds_read_b64_tr_b16 v[198:199], v232 offset:15360
  v_mfma_f32_16x16x32_bf16 v[72:75], v[160:163], v[120:123], v[72:75]
  s_mov_b64 exec, vcc
  ds_read_b128 v[196:199], v233 offset:1216
  s_mov_b64 exec, -1
  v_mfma_f32_16x16x32_bf16 v[76:79], v[160:163], v[124:127], v[76:79]
  v_mfma_f32_16x16x32_bf16 v[80:83], v[164:167], v[112:115], v[80:83]
  v_mfma_f32_16x16x32_bf16 v[84:87], v[164:167], v[116:119], v[84:87]
  v_mfma_f32_16x16x32_bf16 v[88:91], v[164:167], v[120:123], v[88:91]
  v_mfma_f32_16x16x32_bf16 v[92:95], v[164:167], v[124:127], v[92:95]
  v_mfma_f32_16x16x32_bf16 v[96:99], v[168:171], v[112:115], v[96:99]
  v_mfma_f32_16x16x32_bf16 v[100:103], v[168:171], v[116:119], v[100:103]
  v_mfma_f32_16x16x32_bf16 v[104:107], v[168:171], v[120:123], v[104:107]
  v_mfma_f32_16x16x32_bf16 v[108:111], v[168:171], v[124:127], v[108:111]
  s_waitcnt lgkmcnt(0)
  v_mfma_f32_16x16x32_bf16 v[96:99], v[196:199], v[128:131], v[96:99]
  v_mfma_f32_16x16x32_bf16 v[100:103], v[196:199], v[132:135], v[100:103]
  v_mfma_f32_16x16x32_bf16 v[104:107], v[196:199], v[136:139], v[104:107]
  v_mfma_f32_16x16x32_bf16 v[108:111], v[196:199], v[140:143], v[108:111]
  v_mfma_f32_16x16x32_bf16 v[0:3], v[172:175], v[128:131], v[0:3]
  v_mfma_f32_16x16x32_bf16 v[4:7], v[172:175], v[132:135], v[4:7]
  v_mfma_f32_16x16x32_bf16 v[8:11], v[172:175], v[136:139], v[8:11]
  v_mfma_f32_16x16x32_bf16 v[12:15], v[172:175], v[140:143], v[12:15]
  v_mfma_f32_16x16x32_bf16 v[16:19], v[176:179], v[128:131], v[16:19]
  v_mfma_f32_16x16x32_bf16 v[20:23], v[176:179], v[132:135], v[20:23]
  v_mfma_f32_16x16x32_bf16 v[24:27], v[176:179], v[136:139], v[24:27]
  v_mfma_f32_16x16x32_bf16 v[28:31], v[176:179], v[140:143], v[28:31]
  v_mfma_f32_16x16x32_bf16 v[32:35], v[180:183], v[128:131], v[32:35]
  v_mfma_f32_16x16x32_bf16 v[36:39], v[180:183], v[132:135], v[36:39]
  s_barrier
  v_mfma_f32_16x16x32_bf16 v[40:43], v[180:183], v[136:139], v[40:43]
  v_mfma_f32_16x16x32_bf16 v[44:47], v[180:183], v[140:143], v[44:47]
  v_mfma_f32_16x16x32_bf16 v[48:51], v[184:187], v[128:131], v[48:51]
  v_mfma_f32_16x16x32_bf16 v[52:55], v[184:187], v[132:135], v[52:55]
  v_mfma_f32_16x16x32_bf16 v[56:59], v[184:187], v[136:139], v[56:59]
  v_mfma_f32_16x16x32_bf16 v[60:63], v[184:187], v[140:143], v[60:63]
  v_mfma_f32_16x16x32_bf16 v[64:67], v[188:191], v[128:131], v[64:67]
  v_mfma_f32_16x16x32_bf16 v[68:71], v[188:191], v[132:135], v[68:71]
  v_mfma_f32_16x16x32_bf16 v[72:75], v[188:191], v[136:139], v[72:75]
  v_mfma_f32_16x16x32_bf16 v[76:79], v[188:191], v[140:143], v[76:79]
  v_mfma_f32_16x16x32_bf16 v[80:83], v[192:195], v[128:131], v[80:83]
  v_mfma_f32_16x16x32_bf16 v[84:87], v[192:195], v[132:135], v[84:87]
  v_mfma_f32_16x16x32_bf16 v[88:91], v[192:195], v[136:139], v[88:91]
  v_mfma_f32_16x16x32_bf16 v[92:95], v[192:195], v[140:143], v[92:95]
  s_nop 3
  s_cbranch_vccnz L_epG_37
  s_mov_b32 s98, 0x3f800008
  s_mov_b32 s99, 0x3f800008
  s_mov_b32 s100, 0x358637bd
  s_mov_b32 s101, 0x358637bd
  v_pk_mul_f32 v[112:113], v[96:97], s[96:97]
  v_pk_mul_f32 v[114:115], v[98:99], s[96:97]
  v_exp_f32 v112, v112 clamp
  v_exp_f32 v113, v113 clamp
  v_exp_f32 v114, v114 clamp
  v_exp_f32 v115, v115 clamp
  v_pk_add_f32 v[96:97], v[96:97], s[98:99]
  v_pk_add_f32 v[98:99], v[98:99], s[98:99]
  v_pk_add_f32 v[112:113], v[112:113], s[100:101]
  v_pk_add_f32 v[114:115], v[114:115], s[100:101]
  v_max_f32 v112, v112, v96
  v_max_f32 v113, v113, v97
  v_max_f32 v114, v114, v98
  v_max_f32 v115, v115, v99
  v_cvt_pk_bf16_f32 v96, v112, v113
  v_cvt_pk_bf16_f32 v97, v114, v115
  v_pk_mul_f32 v[116:117], v[100:101], s[96:97]
  v_pk_mul_f32 v[118:119], v[102:103], s[96:97]
  v_exp_f32 v116, v116 clamp
  v_exp_f32 v117, v117 clamp
  v_exp_f32 v118, v118 clamp
  v_exp_f32 v119, v119 clamp
  v_pk_add_f32 v[100:101], v[100:101], s[98:99]
  v_pk_add_f32 v[102:103], v[102:103], s[98:99]
  v_pk_add_f32 v[116:117], v[116:117], s[100:101]
  v_pk_add_f32 v[118:119], v[118:119], s[100:101]
  v_max_f32 v116, v116, v100
  v_max_f32 v117, v117, v101
  v_max_f32 v118, v118, v102
  v_max_f32 v119, v119, v103
  v_cvt_pk_bf16_f32 v98, v116, v117
  v_cvt_pk_bf16_f32 v99, v118, v119
  buffer_store_dwordx4 v[96:99], v234, s[36:39], s72 offen offset:0 sc1
  v_pk_mul_f32 v[112:113], v[104:105], s[96:97]
  v_pk_mul_f32 v[114:115], v[106:107], s[96:97]
  v_exp_f32 v112, v112 clamp
  v_exp_f32 v113, v113 clamp
  v_exp_f32 v114, v114 clamp
  v_exp_f32 v115, v115 clamp
  v_pk_add_f32 v[104:105], v[104:105], s[98:99]
  v_pk_add_f32 v[106:107], v[106:107], s[98:99]
  v_pk_add_f32 v[112:113], v[112:113], s[100:101]
  v_pk_add_f32 v[114:115], v[114:115], s[100:101]
  v_max_f32 v112, v112, v104
  v_max_f32 v113, v113, v105
  v_max_f32 v114, v114, v106
  v_max_f32 v115, v115, v107
  v_cvt_pk_bf16_f32 v104, v112, v113
  v_cvt_pk_bf16_f32 v105, v114, v115
  v_pk_mul_f32 v[116:117], v[108:109], s[96:97]
  v_pk_mul_f32 v[118:119], v[110:111], s[96:97]
  v_exp_f32 v116, v116 clamp
  v_exp_f32 v117, v117 clamp
  v_exp_f32 v118, v118 clamp
  v_exp_f32 v119, v119 clamp
  v_pk_add_f32 v[108:109], v[108:109], s[98:99]
  v_pk_add_f32 v[110:111], v[110:111], s[98:99]
  v_pk_add_f32 v[116:117], v[116:117], s[100:101]
  v_pk_add_f32 v[118:119], v[118:119], s[100:101]
  v_max_f32 v116, v116, v108
  v_max_f32 v117, v117, v109
  v_max_f32 v118, v118, v110
  v_max_f32 v119, v119, v111
  v_cvt_pk_bf16_f32 v106, v116, v117
  v_cvt_pk_bf16_f32 v107, v118, v119
  buffer_store_dwordx4 v[104:107], v234, s[36:39], s72 offen offset:1024 sc1
  s_branch L_epE_38
L_epG_37:
  s_cmp_eq_u32 s74, 0
  s_cbranch_scc1 L_epE_38
  v_cmp_le_u32 vcc, 16, v253
  v_cmp_le_u32 s[62:63], 32, v253
  v_cmp_le_u32 s[64:65], 48, v253
  s_nop 0
  v_cndmask_b32 v96, v96, v100, vcc
  v_cndmask_b32 v96, v96, v104, s[62:63]
  v_cndmask_b32 v96, v96, v108, s[64:65]
  s_mov_b32 s60, 0x42700000
  v_min_f32 v96, s60, v96
  v_max_f32 v96, -s60, v96
  v_mul_f32 v96, s96, v96
  v_exp_f32 v96, v96
  s_lshl_b32 s60, s71, 8
  s_add_u32 s60, s60, 65536
  v_add_f32 v98, 1.0, v96
  v_rcp_f32 v98, v98
  v_lshlrev_b32 v97, 2, v253
  s_add_u32 s61, s60, 8192
  buffer_store_dword v96, v97, s[36:39], s60 offen sc1
  buffer_store_dword v98, v97, s[36:39], s61 offen sc1
L_epE_38:
  s_mov_b32 s98, 0x3f3504f3
  s_mov_b32 s99, 0x3f3504f3
  v_pk_fma_f32 v[112:113], v[0:1], s[96:97], -0.5 op_sel_hi:[1,1,0]
  v_pk_fma_f32 v[114:115], v[2:3], s[96:97], -0.5 op_sel_hi:[1,1,0]
  v_exp_f32 v112, v112
  v_exp_f32 v113, v113
  v_exp_f32 v114, v114
  v_exp_f32 v115, v115
  v_pk_add_f32 v[112:113], v[112:113], s[98:99]
  v_pk_add_f32 v[114:115], v[114:115], s[98:99]
  v_pk_fma_f32 v[112:113], v[112:113], v[112:113], 0.5 op_sel_hi:[1,1,0]
  v_pk_fma_f32 v[114:115], v[114:115], v[114:115], 0.5 op_sel_hi:[1,1,0]
  v_rcp_f32 v112, v112
  v_rcp_f32 v113, v113
  v_rcp_f32 v114, v114
  v_rcp_f32 v115, v115
  v_pk_fma_f32 v[112:113], v[0:1], v[112:113], v[0:1] neg_lo:[1,0,0] neg_hi:[1,0,0]
  v_pk_fma_f32 v[114:115], v[2:3], v[114:115], v[2:3] neg_lo:[1,0,0] neg_hi:[1,0,0]
  v_cvt_pk_bf16_f32 v0, v112, v113
  v_cvt_pk_bf16_f32 v1, v114, v115
  v_pk_fma_f32 v[116:117], v[16:17], s[96:97], -0.5 op_sel_hi:[1,1,0]
  v_pk_fma_f32 v[118:119], v[18:19], s[96:97], -0.5 op_sel_hi:[1,1,0]
  v_exp_f32 v116, v116
  v_exp_f32 v117, v117
  v_exp_f32 v118, v118
  v_exp_f32 v119, v119
  v_pk_add_f32 v[116:117], v[116:117], s[98:99]
  v_pk_add_f32 v[118:119], v[118:119], s[98:99]
  v_pk_fma_f32 v[116:117], v[116:117], v[116:117], 0.5 op_sel_hi:[1,1,0]
  v_pk_fma_f32 v[118:119], v[118:119], v[118:119], 0.5 op_sel_hi:[1,1,0]
  v_rcp_f32 v116, v116
  v_rcp_f32 v117, v117
  v_rcp_f32 v118, v118
  v_rcp_f32 v119, v119
  v_pk_fma_f32 v[116:117], v[16:17], v[116:117], v[16:17] neg_lo:[1,0,0] neg_hi:[1,0,0]
  v_pk_fma_f32 v[118:119], v[18:19], v[118:119], v[18:19] neg_lo:[1,0,0] neg_hi:[1,0,0]
  v_cvt_pk_bf16_f32 v2, v116, v117
  v_cvt_pk_bf16_f32 v3, v118, v119
  buffer_store_dwordx4 v[0:3], v234, s[36:39], s49 offen offset:0 sc1
  v_pk_fma_f32 v[120:121], v[4:5], s[96:97], -0.5 op_sel_hi:[1,1,0]
  v_pk_fma_f32 v[122:123], v[6:7], s[96:97], -0.5 op_sel_hi:[1,1,0]
  v_exp_f32 v120, v120
  v_exp_f32 v121, v121
  v_exp_f32 v122, v122
  v_exp_f32 v123, v123
  v_pk_add_f32 v[120:121], v[120:121], s[98:99]
  v_pk_add_f32 v[122:123], v[122:123], s[98:99]
  v_pk_fma_f32 v[120:121], v[120:121], v[120:121], 0.5 op_sel_hi:[1,1,0]
  v_pk_fma_f32 v[122:123], v[122:123], v[122:123], 0.5 op_sel_hi:[1,1,0]
  v_rcp_f32 v120, v120
  v_rcp_f32 v121, v121
  v_rcp_f32 v122, v122
  v_rcp_f32 v123, v123
  v_pk_fma_f32 v[120:121], v[4:5], v[120:121], v[4:5] neg_lo:[1,0,0] neg_hi:[1,0,0]
  v_pk_fma_f32 v[122:123], v[6:7], v[122:123], v[6:7] neg_lo:[1,0,0] neg_hi:[1,0,0]
  v_cvt_pk_bf16_f32 v4, v120, v121
  v_cvt_pk_bf16_f32 v5, v122, v123
  v_pk_fma_f32 v[124:125], v[20:21], s[96:97], -0.5 op_sel_hi:[1,1,0]
  v_pk_fma_f32 v[126:127], v[22:23], s[96:97], -0.5 op_sel_hi:[1,1,0]
  v_exp_f32 v124, v124
  v_exp_f32 v125, v125
  v_exp_f32 v126, v126
  v_exp_f32 v127, v127
  v_pk_add_f32 v[124:125], v[124:125], s[98:99]
  v_pk_add_f32 v[126:127], v[126:127], s[98:99]
  v_pk_fma_f32 v[124:125], v[124:125], v[124:125], 0.5 op_sel_hi:[1,1,0]
  v_pk_fma_f32 v[126:127], v[126:127], v[126:127], 0.5 op_sel_hi:[1,1,0]
  v_rcp_f32 v124, v124
  v_rcp_f32 v125, v125
  v_rcp_f32 v126, v126
  v_rcp_f32 v127, v127
  v_pk_fma_f32 v[124:125], v[20:21], v[124:125], v[20:21] neg_lo:[1,0,0] neg_hi:[1,0,0]
  v_pk_fma_f32 v[126:127], v[22:23], v[126:127], v[22:23] neg_lo:[1,0,0] neg_hi:[1,0,0]
  v_cvt_pk_bf16_f32 v6, v124, v125
  v_cvt_pk_bf16_f32 v7, v126, v127
  buffer_store_dwordx4 v[4:7], v234, s[36:39], s49 offen offset:1024 sc1
  v_pk_fma_f32 v[112:113], v[8:9], s[96:97], -0.5 op_sel_hi:[1,1,0]
  v_pk_fma_f32 v[114:115], v[10:11], s[96:97], -0.5 op_sel_hi:[1,1,0]
  v_exp_f32 v112, v112
  v_exp_f32 v113, v113
  v_exp_f32 v114, v114
  v_exp_f32 v115, v115
  v_pk_add_f32 v[112:113], v[112:113], s[98:99]
  v_pk_add_f32 v[114:115], v[114:115], s[98:99]
  v_pk_fma_f32 v[112:113], v[112:113], v[112:113], 0.5 op_sel_hi:[1,1,0]
  v_pk_fma_f32 v[114:115], v[114:115], v[114:115], 0.5 op_sel_hi:[1,1,0]
  v_rcp_f32 v112, v112
  v_rcp_f32 v113, v113
  v_rcp_f32 v114, v114
  v_rcp_f32 v115, v115
  v_pk_fma_f32 v[112:113], v[8:9], v[112:113], v[8:9] neg_lo:[1,0,0] neg_hi:[1,0,0]
  v_pk_fma_f32 v[114:115], v[10:11], v[114:115], v[10:11] neg_lo:[1,0,0] neg_hi:[1,0,0]
  v_cvt_pk_bf16_f32 v8, v112, v113
  v_cvt_pk_bf16_f32 v9, v114, v115
  v_pk_fma_f32 v[116:117], v[24:25], s[96:97], -0.5 op_sel_hi:[1,1,0]
  v_pk_fma_f32 v[118:119], v[26:27], s[96:97], -0.5 op_sel_hi:[1,1,0]
  v_exp_f32 v116, v116
  v_exp_f32 v117, v117
  v_exp_f32 v118, v118
  v_exp_f32 v119, v119
  v_pk_add_f32 v[116:117], v[116:117], s[98:99]
  v_pk_add_f32 v[118:119], v[118:119], s[98:99]
  v_pk_fma_f32 v[116:117], v[116:117], v[116:117], 0.5 op_sel_hi:[1,1,0]
  v_pk_fma_f32 v[118:119], v[118:119], v[118:119], 0.5 op_sel_hi:[1,1,0]
  v_rcp_f32 v116, v116
  v_rcp_f32 v117, v117
  v_rcp_f32 v118, v118
  v_rcp_f32 v119, v119
  v_pk_fma_f32 v[116:117], v[24:25], v[116:117], v[24:25] neg_lo:[1,0,0] neg_hi:[1,0,0]
  v_pk_fma_f32 v[118:119], v[26:27], v[118:119], v[26:27] neg_lo:[1,0,0] neg_hi:[1,0,0]
  v_cvt_pk_bf16_f32 v10, v116, v117
  v_cvt_pk_bf16_f32 v11, v118, v119
  buffer_store_dwordx4 v[8:11], v234, s[36:39], s49 offen offset:2048 sc1
  v_pk_fma_f32 v[120:121], v[12:13], s[96:97], -0.5 op_sel_hi:[1,1,0]
  v_pk_fma_f32 v[122:123], v[14:15], s[96:97], -0.5 op_sel_hi:[1,1,0]
  v_exp_f32 v120, v120
  v_exp_f32 v121, v121
  v_exp_f32 v122, v122
  v_exp_f32 v123, v123
  v_pk_add_f32 v[120:121], v[120:121], s[98:99]
  v_pk_add_f32 v[122:123], v[122:123], s[98:99]
  v_pk_fma_f32 v[120:121], v[120:121], v[120:121], 0.5 op_sel_hi:[1,1,0]
  v_pk_fma_f32 v[122:123], v[122:123], v[122:123], 0.5 op_sel_hi:[1,1,0]
  v_rcp_f32 v120, v120
  v_rcp_f32 v121, v121
  v_rcp_f32 v122, v122
  v_rcp_f32 v123, v123
  v_pk_fma_f32 v[120:121], v[12:13], v[120:121], v[12:13] neg_lo:[1,0,0] neg_hi:[1,0,0]
  v_pk_fma_f32 v[122:123], v[14:15], v[122:123], v[14:15] neg_lo:[1,0,0] neg_hi:[1,0,0]
  v_cvt_pk_bf16_f32 v12, v120, v121
  v_cvt_pk_bf16_f32 v13, v122, v123
  v_pk_fma_f32 v[124:125], v[28:29], s[96:97], -0.5 op_sel_hi:[1,1,0]
  v_pk_fma_f32 v[126:127], v[30:31], s[96:97], -0.5 op_sel_hi:[1,1,0]
  v_exp_f32 v124, v124
  v_exp_f32 v125, v125
  v_exp_f32 v126, v126
  v_exp_f32 v127, v127
  v_pk_add_f32 v[124:125], v[124:125], s[98:99]
  v_pk_add_f32 v[126:127], v[126:127], s[98:99]
  v_pk_fma_f32 v[124:125], v[124:125], v[124:125], 0.5 op_sel_hi:[1,1,0]
  v_pk_fma_f32 v[126:127], v[126:127], v[126:127], 0.5 op_sel_hi:[1,1,0]
  v_rcp_f32 v124, v124
  v_rcp_f32 v125, v125
  v_rcp_f32 v126, v126
  v_rcp_f32 v127, v127
  v_pk_fma_f32 v[124:125], v[28:29], v[124:125], v[28:29] neg_lo:[1,0,0] neg_hi:[1,0,0]
  v_pk_fma_f32 v[126:127], v[30:31], v[126:127], v[30:31] neg_lo:[1,0,0] neg_hi:[1,0,0]
  v_cvt_pk_bf16_f32 v14, v124, v125
  v_cvt_pk_bf16_f32 v15, v126, v127
  buffer_store_dwordx4 v[12:15], v234, s[36:39], s49 offen offset:3072 sc1
  v_pk_fma_f32 v[112:113], v[32:33], s[96:97], -0.5 op_sel_hi:[1,1,0]
  v_pk_fma_f32 v[114:115], v[34:35], s[96:97], -0.5 op_sel_hi:[1,1,0]
  v_exp_f32 v112, v112
  v_exp_f32 v113, v113
  v_exp_f32 v114, v114
  v_exp_f32 v115, v115
  v_pk_add_f32 v[112:113], v[112:113], s[98:99]
  v_pk_add_f32 v[114:115], v[114:115], s[98:99]
  v_pk_fma_f32 v[112:113], v[112:113], v[112:113], 0.5 op_sel_hi:[1,1,0]
  v_pk_fma_f32 v[114:115], v[114:115], v[114:115], 0.5 op_sel_hi:[1,1,0]
  v_rcp_f32 v112, v112
  v_rcp_f32 v113, v113
  v_rcp_f32 v114, v114
  v_rcp_f32 v115, v115
  v_pk_fma_f32 v[112:113], v[32:33], v[112:113], v[32:33] neg_lo:[1,0,0] neg_hi:[1,0,0]
  v_pk_fma_f32 v[114:115], v[34:35], v[114:115], v[34:35] neg_lo:[1,0,0] neg_hi:[1,0,0]
  v_cvt_pk_bf16_f32 v32, v112, v113
  v_cvt_pk_bf16_f32 v33, v114, v115
  v_pk_fma_f32 v[116:117], v[48:49], s[96:97], -0.5 op_sel_hi:[1,1,0]
  v_pk_fma_f32 v[118:119], v[50:51], s[96:97], -0.5 op_sel_hi:[1,1,0]
  v_exp_f32 v116, v116
  v_exp_f32 v117, v117
  v_exp_f32 v118, v118
  v_exp_f32 v119, v119
  v_pk_add_f32 v[116:117], v[116:117], s[98:99]
  v_pk_add_f32 v[118:119], v[118:119], s[98:99]
  v_pk_fma_f32 v[116:117], v[116:117], v[116:117], 0.5 op_sel_hi:[1,1,0]
  v_pk_fma_f32 v[118:119], v[118:119], v[118:119], 0.5 op_sel_hi:[1,1,0]
  v_rcp_f32 v116, v116
  v_rcp_f32 v117, v117
  v_rcp_f32 v118, v118
  v_rcp_f32 v119, v119
  v_pk_fma_f32 v[116:117], v[48:49], v[116:117], v[48:49] neg_lo:[1,0,0] neg_hi:[1,0,0]
  v_pk_fma_f32 v[118:119], v[50:51], v[118:119], v[50:51] neg_lo:[1,0,0] neg_hi:[1,0,0]
  v_cvt_pk_bf16_f32 v34, v116, v117
  v_cvt_pk_bf16_f32 v35, v118, v119
  buffer_store_dwordx4 v[32:35], v234, s[36:39], s50 offen offset:0 sc1
  v_pk_fma_f32 v[120:121], v[36:37], s[96:97], -0.5 op_sel_hi:[1,1,0]
  v_pk_fma_f32 v[122:123], v[38:39], s[96:97], -0.5 op_sel_hi:[1,1,0]
  v_exp_f32 v120, v120
  v_exp_f32 v121, v121
  v_exp_f32 v122, v122
  v_exp_f32 v123, v123
  v_pk_add_f32 v[120:121], v[120:121], s[98:99]
  v_pk_add_f32 v[122:123], v[122:123], s[98:99]
  v_pk_fma_f32 v[120:121], v[120:121], v[120:121], 0.5 op_sel_hi:[1,1,0]
  v_pk_fma_f32 v[122:123], v[122:123], v[122:123], 0.5 op_sel_hi:[1,1,0]
  v_rcp_f32 v120, v120
  v_rcp_f32 v121, v121
  v_rcp_f32 v122, v122
  v_rcp_f32 v123, v123
  v_pk_fma_f32 v[120:121], v[36:37], v[120:121], v[36:37] neg_lo:[1,0,0] neg_hi:[1,0,0]
  v_pk_fma_f32 v[122:123], v[38:39], v[122:123], v[38:39] neg_lo:[1,0,0] neg_hi:[1,0,0]
  v_cvt_pk_bf16_f32 v36, v120, v121
  v_cvt_pk_bf16_f32 v37, v122, v123
  v_pk_fma_f32 v[124:125], v[52:53], s[96:97], -0.5 op_sel_hi:[1,1,0]
  v_pk_fma_f32 v[126:127], v[54:55], s[96:97], -0.5 op_sel_hi:[1,1,0]
  v_exp_f32 v124, v124
  v_exp_f32 v125, v125
  v_exp_f32 v126, v126
  v_exp_f32 v127, v127
  v_pk_add_f32 v[124:125], v[124:125], s[98:99]
  v_pk_add_f32 v[126:127], v[126:127], s[98:99]
  v_pk_fma_f32 v[124:125], v[124:125], v[124:125], 0.5 op_sel_hi:[1,1,0]
  v_pk_fma_f32 v[126:127], v[126:127], v[126:127], 0.5 op_sel_hi:[1,1,0]
  v_rcp_f32 v124, v124
  v_rcp_f32 v125, v125
  v_rcp_f32 v126, v126
  v_rcp_f32 v127, v127
  v_pk_fma_f32 v[124:125], v[52:53], v[124:125], v[52:53] neg_lo:[1,0,0] neg_hi:[1,0,0]
  v_pk_fma_f32 v[126:127], v[54:55], v[126:127], v[54:55] neg_lo:[1,0,0] neg_hi:[1,0,0]
  v_cvt_pk_bf16_f32 v38, v124, v125
  v_cvt_pk_bf16_f32 v39, v126, v127
  buffer_store_dwordx4 v[36:39], v234, s[36:39], s50 offen offset:1024 sc1
  v_pk_fma_f32 v[112:113], v[40:41], s[96:97], -0.5 op_sel_hi:[1,1,0]
  v_pk_fma_f32 v[114:115], v[42:43], s[96:97], -0.5 op_sel_hi:[1,1,0]
  v_exp_f32 v112, v112
  v_exp_f32 v113, v113
  v_exp_f32 v114, v114
  v_exp_f32 v115, v115
  v_pk_add_f32 v[112:113], v[112:113], s[98:99]
  v_pk_add_f32 v[114:115], v[114:115], s[98:99]
  v_pk_fma_f32 v[112:113], v[112:113], v[112:113], 0.5 op_sel_hi:[1,1,0]
  v_pk_fma_f32 v[114:115], v[114:115], v[114:115], 0.5 op_sel_hi:[1,1,0]
  v_rcp_f32 v112, v112
  v_rcp_f32 v113, v113
  v_rcp_f32 v114, v114
  v_rcp_f32 v115, v115
  v_pk_fma_f32 v[112:113], v[40:41], v[112:113], v[40:41] neg_lo:[1,0,0] neg_hi:[1,0,0]
  v_pk_fma_f32 v[114:115], v[42:43], v[114:115], v[42:43] neg_lo:[1,0,0] neg_hi:[1,0,0]
  v_cvt_pk_bf16_f32 v40, v112, v113
  v_cvt_pk_bf16_f32 v41, v114, v115
  v_pk_fma_f32 v[116:117], v[56:57], s[96:97], -0.5 op_sel_hi:[1,1,0]
  v_pk_fma_f32 v[118:119], v[58:59], s[96:97], -0.5 op_sel_hi:[1,1,0]
  v_exp_f32 v116, v116
  v_exp_f32 v117, v117
  v_exp_f32 v118, v118
  v_exp_f32 v119, v119
  v_pk_add_f32 v[116:117], v[116:117], s[98:99]
  v_pk_add_f32 v[118:119], v[118:119], s[98:99]
  v_pk_fma_f32 v[116:117], v[116:117], v[116:117], 0.5 op_sel_hi:[1,1,0]
  v_pk_fma_f32 v[118:119], v[118:119], v[118:119], 0.5 op_sel_hi:[1,1,0]
  v_rcp_f32 v116, v116
  v_rcp_f32 v117, v117
  v_rcp_f32 v118, v118
  v_rcp_f32 v119, v119
  v_pk_fma_f32 v[116:117], v[56:57], v[116:117], v[56:57] neg_lo:[1,0,0] neg_hi:[1,0,0]
  v_pk_fma_f32 v[118:119], v[58:59], v[118:119], v[58:59] neg_lo:[1,0,0] neg_hi:[1,0,0]
  v_cvt_pk_bf16_f32 v42, v116, v117
  v_cvt_pk_bf16_f32 v43, v118, v119
  buffer_store_dwordx4 v[40:43], v234, s[36:39], s50 offen offset:2048 sc1
  v_pk_fma_f32 v[120:121], v[44:45], s[96:97], -0.5 op_sel_hi:[1,1,0]
  v_pk_fma_f32 v[122:123], v[46:47], s[96:97], -0.5 op_sel_hi:[1,1,0]
  v_exp_f32 v120, v120
  v_exp_f32 v121, v121
  v_exp_f32 v122, v122
  v_exp_f32 v123, v123
  v_pk_add_f32 v[120:121], v[120:121], s[98:99]
  v_pk_add_f32 v[122:123], v[122:123], s[98:99]
  v_pk_fma_f32 v[120:121], v[120:121], v[120:121], 0.5 op_sel_hi:[1,1,0]
  v_pk_fma_f32 v[122:123], v[122:123], v[122:123], 0.5 op_sel_hi:[1,1,0]
  v_rcp_f32 v120, v120
  v_rcp_f32 v121, v121
  v_rcp_f32 v122, v122
  v_rcp_f32 v123, v123
  v_pk_fma_f32 v[120:121], v[44:45], v[120:121], v[44:45] neg_lo:[1,0,0] neg_hi:[1,0,0]
  v_pk_fma_f32 v[122:123], v[46:47], v[122:123], v[46:47] neg_lo:[1,0,0] neg_hi:[1,0,0]
  v_cvt_pk_bf16_f32 v44, v120, v121
  v_cvt_pk_bf16_f32 v45, v122, v123
  v_pk_fma_f32 v[124:125], v[60:61], s[96:97], -0.5 op_sel_hi:[1,1,0]
  v_pk_fma_f32 v[126:127], v[62:63], s[96:97], -0.5 op_sel_hi:[1,1,0]
  v_exp_f32 v124, v124
  v_exp_f32 v125, v125
  v_exp_f32 v126, v126
  v_exp_f32 v127, v127
  v_pk_add_f32 v[124:125], v[124:125], s[98:99]
  v_pk_add_f32 v[126:127], v[126:127], s[98:99]
  v_pk_fma_f32 v[124:125], v[124:125], v[124:125], 0.5 op_sel_hi:[1,1,0]
  v_pk_fma_f32 v[126:127], v[126:127], v[126:127], 0.5 op_sel_hi:[1,1,0]
  v_rcp_f32 v124, v124
  v_rcp_f32 v125, v125
  v_rcp_f32 v126, v126
  v_rcp_f32 v127, v127
  v_pk_fma_f32 v[124:125], v[60:61], v[124:125], v[60:61] neg_lo:[1,0,0] neg_hi:[1,0,0]
  v_pk_fma_f32 v[126:127], v[62:63], v[126:127], v[62:63] neg_lo:[1,0,0] neg_hi:[1,0,0]
  v_cvt_pk_bf16_f32 v46, v124, v125
  v_cvt_pk_bf16_f32 v47, v126, v127
  buffer_store_dwordx4 v[44:47], v234, s[36:39], s50 offen offset:3072 sc1
  v_pk_fma_f32 v[112:113], v[64:65], s[96:97], -0.5 op_sel_hi:[1,1,0]
  v_pk_fma_f32 v[114:115], v[66:67], s[96:97], -0.5 op_sel_hi:[1,1,0]
  v_exp_f32 v112, v112
  v_exp_f32 v113, v113
  v_exp_f32 v114, v114
  v_exp_f32 v115, v115
  v_pk_add_f32 v[112:113], v[112:113], s[98:99]
  v_pk_add_f32 v[114:115], v[114:115], s[98:99]
  v_pk_fma_f32 v[112:113], v[112:113], v[112:113], 0.5 op_sel_hi:[1,1,0]
  v_pk_fma_f32 v[114:115], v[114:115], v[114:115], 0.5 op_sel_hi:[1,1,0]
  v_rcp_f32 v112, v112
  v_rcp_f32 v113, v113
  v_rcp_f32 v114, v114
  v_rcp_f32 v115, v115
  v_pk_fma_f32 v[112:113], v[64:65], v[112:113], v[64:65] neg_lo:[1,0,0] neg_hi:[1,0,0]
  v_pk_fma_f32 v[114:115], v[66:67], v[114:115], v[66:67] neg_lo:[1,0,0] neg_hi:[1,0,0]
  v_cvt_pk_bf16_f32 v64, v112, v113
  v_cvt_pk_bf16_f32 v65, v114, v115
  v_pk_fma_f32 v[116:117], v[80:81], s[96:97], -0.5 op_sel_hi:[1,1,0]
  v_pk_fma_f32 v[118:119], v[82:83], s[96:97], -0.5 op_sel_hi:[1,1,0]
  v_exp_f32 v116, v116
  v_exp_f32 v117, v117
  v_exp_f32 v118, v118
  v_exp_f32 v119, v119
  v_pk_add_f32 v[116:117], v[116:117], s[98:99]
  v_pk_add_f32 v[118:119], v[118:119], s[98:99]
  v_pk_fma_f32 v[116:117], v[116:117], v[116:117], 0.5 op_sel_hi:[1,1,0]
  v_pk_fma_f32 v[118:119], v[118:119], v[118:119], 0.5 op_sel_hi:[1,1,0]
  v_rcp_f32 v116, v116
  v_rcp_f32 v117, v117
  v_rcp_f32 v118, v118
  v_rcp_f32 v119, v119
  v_pk_fma_f32 v[116:117], v[80:81], v[116:117], v[80:81] neg_lo:[1,0,0] neg_hi:[1,0,0]
  v_pk_fma_f32 v[118:119], v[82:83], v[118:119], v[82:83] neg_lo:[1,0,0] neg_hi:[1,0,0]
  v_cvt_pk_bf16_f32 v66, v116, v117
  v_cvt_pk_bf16_f32 v67, v118, v119
  buffer_store_dwordx4 v[64:67], v234, s[36:39], s51 offen offset:0 sc1
  v_pk_fma_f32 v[120:121], v[68:69], s[96:97], -0.5 op_sel_hi:[1,1,0]
  v_pk_fma_f32 v[122:123], v[70:71], s[96:97], -0.5 op_sel_hi:[1,1,0]
  v_exp_f32 v120, v120
  v_exp_f32 v121, v121
  v_exp_f32 v122, v122
  v_exp_f32 v123, v123
  v_pk_add_f32 v[120:121], v[120:121], s[98:99]
  v_pk_add_f32 v[122:123], v[122:123], s[98:99]
  v_pk_fma_f32 v[120:121], v[120:121], v[120:121], 0.5 op_sel_hi:[1,1,0]
  v_pk_fma_f32 v[122:123], v[122:123], v[122:123], 0.5 op_sel_hi:[1,1,0]
  v_rcp_f32 v120, v120
  v_rcp_f32 v121, v121
  v_rcp_f32 v122, v122
  v_rcp_f32 v123, v123
  v_pk_fma_f32 v[120:121], v[68:69], v[120:121], v[68:69] neg_lo:[1,0,0] neg_hi:[1,0,0]
  v_pk_fma_f32 v[122:123], v[70:71], v[122:123], v[70:71] neg_lo:[1,0,0] neg_hi:[1,0,0]
  v_cvt_pk_bf16_f32 v68, v120, v121
  v_cvt_pk_bf16_f32 v69, v122, v123
  v_pk_fma_f32 v[124:125], v[84:85], s[96:97], -0.5 op_sel_hi:[1,1,0]
  v_pk_fma_f32 v[126:127], v[86:87], s[96:97], -0.5 op_sel_hi:[1,1,0]
  v_exp_f32 v124, v124
  v_exp_f32 v125, v125
  v_exp_f32 v126, v126
  v_exp_f32 v127, v127
  v_pk_add_f32 v[124:125], v[124:125], s[98:99]
  v_pk_add_f32 v[126:127], v[126:127], s[98:99]
  v_pk_fma_f32 v[124:125], v[124:125], v[124:125], 0.5 op_sel_hi:[1,1,0]
  v_pk_fma_f32 v[126:127], v[126:127], v[126:127], 0.5 op_sel_hi:[1,1,0]
  v_rcp_f32 v124, v124
  v_rcp_f32 v125, v125
  v_rcp_f32 v126, v126
  v_rcp_f32 v127, v127
  v_pk_fma_f32 v[124:125], v[84:85], v[124:125], v[84:85] neg_lo:[1,0,0] neg_hi:[1,0,0]
  v_pk_fma_f32 v[126:127], v[86:87], v[126:127], v[86:87] neg_lo:[1,0,0] neg_hi:[1,0,0]
  v_cvt_pk_bf16_f32 v70, v124, v125
  v_cvt_pk_bf16_f32 v71, v126, v127
  buffer_store_dwordx4 v[68:71], v234, s[36:39], s51 offen offset:1024 sc1
  v_pk_fma_f32 v[112:113], v[72:73], s[96:97], -0.5 op_sel_hi:[1,1,0]
  v_pk_fma_f32 v[114:115], v[74:75], s[96:97], -0.5 op_sel_hi:[1,1,0]
  v_exp_f32 v112, v112
  v_exp_f32 v113, v113
  v_exp_f32 v114, v114
  v_exp_f32 v115, v115
  v_pk_add_f32 v[112:113], v[112:113], s[98:99]
  v_pk_add_f32 v[114:115], v[114:115], s[98:99]
  v_pk_fma_f32 v[112:113], v[112:113], v[112:113], 0.5 op_sel_hi:[1,1,0]
  v_pk_fma_f32 v[114:115], v[114:115], v[114:115], 0.5 op_sel_hi:[1,1,0]
  v_rcp_f32 v112, v112
  v_rcp_f32 v113, v113
  v_rcp_f32 v114, v114
  v_rcp_f32 v115, v115
  v_pk_fma_f32 v[112:113], v[72:73], v[112:113], v[72:73] neg_lo:[1,0,0] neg_hi:[1,0,0]
  v_pk_fma_f32 v[114:115], v[74:75], v[114:115], v[74:75] neg_lo:[1,0,0] neg_hi:[1,0,0]
  v_cvt_pk_bf16_f32 v72, v112, v113
  v_cvt_pk_bf16_f32 v73, v114, v115
  v_pk_fma_f32 v[116:117], v[88:89], s[96:97], -0.5 op_sel_hi:[1,1,0]
  v_pk_fma_f32 v[118:119], v[90:91], s[96:97], -0.5 op_sel_hi:[1,1,0]
  v_exp_f32 v116, v116
  v_exp_f32 v117, v117
  v_exp_f32 v118, v118
  v_exp_f32 v119, v119
  v_pk_add_f32 v[116:117], v[116:117], s[98:99]
  v_pk_add_f32 v[118:119], v[118:119], s[98:99]
  v_pk_fma_f32 v[116:117], v[116:117], v[116:117], 0.5 op_sel_hi:[1,1,0]
  v_pk_fma_f32 v[118:119], v[118:119], v[118:119], 0.5 op_sel_hi:[1,1,0]
  v_rcp_f32 v116, v116
  v_rcp_f32 v117, v117
  v_rcp_f32 v118, v118
  v_rcp_f32 v119, v119
  v_pk_fma_f32 v[116:117], v[88:89], v[116:117], v[88:89] neg_lo:[1,0,0] neg_hi:[1,0,0]
  v_pk_fma_f32 v[118:119], v[90:91], v[118:119], v[90:91] neg_lo:[1,0,0] neg_hi:[1,0,0]
  v_cvt_pk_bf16_f32 v74, v116, v117
  v_cvt_pk_bf16_f32 v75, v118, v119
  buffer_store_dwordx4 v[72:75], v234, s[36:39], s51 offen offset:2048 sc1
  v_pk_fma_f32 v[120:121], v[76:77], s[96:97], -0.5 op_sel_hi:[1,1,0]
  v_pk_fma_f32 v[122:123], v[78:79], s[96:97], -0.5 op_sel_hi:[1,1,0]
  v_exp_f32 v120, v120
  v_exp_f32 v121, v121
  v_exp_f32 v122, v122
  v_exp_f32 v123, v123
  v_pk_add_f32 v[120:121], v[120:121], s[98:99]
  v_pk_add_f32 v[122:123], v[122:123], s[98:99]
  v_pk_fma_f32 v[120:121], v[120:121], v[120:121], 0.5 op_sel_hi:[1,1,0]
  v_pk_fma_f32 v[122:123], v[122:123], v[122:123], 0.5 op_sel_hi:[1,1,0]
  v_rcp_f32 v120, v120
  v_rcp_f32 v121, v121
  v_rcp_f32 v122, v122
  v_rcp_f32 v123, v123
  v_pk_fma_f32 v[120:121], v[76:77], v[120:121], v[76:77] neg_lo:[1,0,0] neg_hi:[1,0,0]
  v_pk_fma_f32 v[122:123], v[78:79], v[122:123], v[78:79] neg_lo:[1,0,0] neg_hi:[1,0,0]
  v_cvt_pk_bf16_f32 v76, v120, v121
  v_cvt_pk_bf16_f32 v77, v122, v123
  v_pk_fma_f32 v[124:125], v[92:93], s[96:97], -0.5 op_sel_hi:[1,1,0]
  v_pk_fma_f32 v[126:127], v[94:95], s[96:97], -0.5 op_sel_hi:[1,1,0]
  v_exp_f32 v124, v124
  v_exp_f32 v125, v125
  v_exp_f32 v126, v126
  v_exp_f32 v127, v127
  v_pk_add_f32 v[124:125], v[124:125], s[98:99]
  v_pk_add_f32 v[126:127], v[126:127], s[98:99]
  v_pk_fma_f32 v[124:125], v[124:125], v[124:125], 0.5 op_sel_hi:[1,1,0]
  v_pk_fma_f32 v[126:127], v[126:127], v[126:127], 0.5 op_sel_hi:[1,1,0]
  v_rcp_f32 v124, v124
  v_rcp_f32 v125, v125
  v_rcp_f32 v126, v126
  v_rcp_f32 v127, v127
  v_pk_fma_f32 v[124:125], v[92:93], v[124:125], v[92:93] neg_lo:[1,0,0] neg_hi:[1,0,0]
  v_pk_fma_f32 v[126:127], v[94:95], v[126:127], v[94:95] neg_lo:[1,0,0] neg_hi:[1,0,0]
  v_cvt_pk_bf16_f32 v78, v124, v125
  v_cvt_pk_bf16_f32 v79, v126, v127
  buffer_store_dwordx4 v[76:79], v234, s[36:39], s51 offen offset:3072 sc1
  v_mov_b32 v0, v253
  s_bfe_u32 s62, s2, 0x20001
  s_bfe_u32 s63, s2, 0x30003
  s_lshl3_add_u32 s27, s62, s63
  s_and_b32 s62, s2, 1
  s_lshr_b32 s63, s2, 6
  s_lshl2_add_u32 s28, s62, s63
  v_lshlrev_b32 v254, 4, v0
  v_add_u32 v255, 4096, v254
  s_mov_b32 s60, 0
  s_mul_i32 s61, s26, 6
  s_mul_i32 s62, s28, 245760
  s_add_u32 s62, s62, 3145728
  s_mul_i32 s63, s27, 196608
  s_add_u32 s63, s63, 8388608
  s_add_u32 s64, s61, s60
  s_mul_i32 s40, s64, 5120
  s_add_u32 s40, s40, s62
  s_lshl_b32 s46, s64, 12
  s_add_u32 s46, s46, s63
  s_add_u32 s60, s60, 1
  s_cmp_eq_u32 s60, 6
  s_cselect_b32 s60, 0, s60
  s_add_u32 s64, s61, s60
  s_mul_i32 s41, s64, 5120
  s_add_u32 s41, s41, s62
  s_lshl_b32 s47, s64, 12
  s_add_u32 s47, s47, s63
  s_add_u32 s60, s60, 1
  s_cmp_eq_u32 s60, 6
  s_cselect_b32 s60, 0, s60
  s_add_u32 s64, s61, s60
  s_mul_i32 s42, s64, 5120
  s_add_u32 s42, s42, s62
  s_lshl_b32 s48, s64, 12
  s_add_u32 s48, s48, s63
  s_add_u32 s60, s60, 1
  s_cmp_eq_u32 s60, 6
  s_cselect_b32 s60, 0, s60
  s_add_u32 s64, s61, s60
  s_mul_i32 s43, s64, 5120
  s_add_u32 s43, s43, s62
  s_lshl_b32 s49, s64, 12
  s_add_u32 s49, s49, s63
  s_add_u32 s60, s60, 1
  s_cmp_eq_u32 s60, 6
  s_cselect_b32 s60, 0, s60
  s_add_u32 s64, s61, s60
  s_mul_i32 s44, s64, 5120
  s_add_u32 s44, s44, s62
  s_lshl_b32 s50, s64, 12
  s_add_u32 s50, s50, s63
  s_add_u32 s60, s60, 1
  s_cmp_eq_u32 s60, 6
  s_cselect_b32 s60, 0, s60
  s_add_u32 s64, s61, s60
  s_mul_i32 s45, s64, 5120
  s_add_u32 s45, s45, s62
  s_lshl_b32 s51, s64, 12
  s_add_u32 s51, s51, s63
  s_lshl3_add_u32 s10, s27, s26
  s_lshl_b32 s10, s10, 7
  s_lshl_b32 s11, s27, 7
  s_add_u32 s11, s11, 32768
  s_mul_i32 s0, s27, 40
  s_mul_i32 s60, s26, 5
  s_add_u32 s0, s0, s60
  s_lshl_b32 s0, s0, 11
  s_add_u32 s0, s0, 5242880
  s_lshl3_add_u32 s1, s28, s26
  s_mul_i32 s1, s1, 12800
  s_add_u32 s1, s1, 2097152
  s_mul_i32 s3, s26, 7168
  s_add_u32 s3, s3, 1048576
  s_lshl_b32 s29, s26, 9
  s_add_u32 s29, s29, 36864
  s_mov_b32 s32, s73
  v_lshrrev_b32 v255, 4, v254
  s_xor_b32 s30, s26, 4
  s_mul_i32 s30, s30, 20480
  s_mov_b32 s33, -208
  v_and_b32 v44, 15, v255
  v_lshrrev_b32 v45, 4, v255
  s_add_u32 s62, s30, 13312
  v_mul_u32_u24 v47, 336, v45
  v_add_u32 v47, s62, v47
  v_add_u32 v62, s30, v254
  s_add_u32 s62, s62, 7056
  v_mov_b32 v57, s62
  v_subrev_u32 v58, 1344, v57
  v_subrev_u32 v59, 2688, v57
  v_subrev_u32 v60, 4032, v57
  v_subrev_u32 v61, 5376, v57
  v_add_u32 v50, 0, v44
  v_mul_u32_u24 v48, 3277, v50
  v_lshrrev_b32 v48, 16, v48
  v_lshl_add_u32 v50, v50, 4, v47
  v_mad_i32_i24 v49, v48, s33, v50
  v_mad_i32_i24 v48, v48, -5, v45
  v_add_u32 v52, 0, v48
  v_add_u32 v53, 4, v48
  v_cmp_gt_u32 s[64:65], 5, v52
  v_cmp_gt_u32 s[66:67], 5, v53
  s_nop 0
  v_cndmask_b32 v20, v57, v49, s[64:65]
  v_cndmask_b32 v21, v58, v49, s[66:67]
  v_add_u32 v50, 16, v44
  v_mul_u32_u24 v48, 3277, v50
  v_lshrrev_b32 v48, 16, v48
  v_lshl_add_u32 v50, v50, 4, v47
  v_mad_i32_i24 v49, v48, s33, v50
  v_mad_i32_i24 v48, v48, -5, v45
  v_add_u32 v52, 0, v48
  v_add_u32 v53, 4, v48
  v_add_u32 v54, 8, v48
  v_cmp_gt_u32 s[64:65], 5, v52
  v_cmp_gt_u32 s[66:67], 5, v53
  v_cmp_gt_u32 s[68:69], 5, v54
  s_nop 0
  v_cndmask_b32 v22, v57, v49, s[64:65]
  v_cndmask_b32 v23, v58, v49, s[66:67]
  v_cndmask_b32 v24, v59, v49, s[68:69]
  v_add_u32 v50, 32, v44
  v_mul_u32_u24 v48, 3277, v50
  v_lshrrev_b32 v48, 16, v48
  v_lshl_add_u32 v50, v50, 4, v47
  v_mad_i32_i24 v49, v48, s33, v50
  v_mad_i32_i24 v48, v48, -5, v45
  v_add_u32 v52, 4, v48
  v_add_u32 v53, 8, v48
  v_add_u32 v54, 12, v48
  v_cmp_gt_u32 s[64:65], 5, v52
  v_cmp_gt_u32 s[66:67], 5, v53
  v_cmp_gt_u32 s[68:69], 5, v54
  s_nop 0
  v_cndmask_b32 v25, v58, v49, s[64:65]
  v_cndmask_b32 v26, v59, v49, s[66:67]
  v_cndmask_b32 v27, v60, v49, s[68:69]
  v_add_u32 v50, 48, v44
  v_mul_u32_u24 v48, 3277, v50
  v_lshrrev_b32 v48, 16, v48
  v_lshl_add_u32 v50, v50, 4, v47
  v_mad_i32_i24 v49, v48, s33, v50
  v_mad_i32_i24 v48, v48, -5, v45
  v_add_u32 v52, 8, v48
  v_add_u32 v53, 12, v48
  v_add_u32 v54, 16, v48
  v_cmp_gt_u32 s[64:65], 5, v52
  v_cmp_gt_u32 s[66:67], 5, v53
  v_cmp_gt_u32 s[68:69], 5, v54
  s_nop 0
  v_cndmask_b32 v28, v59, v49, s[64:65]
  v_cndmask_b32 v29, v60, v49, s[66:67]
  v_cndmask_b32 v31, v61, v49, s[68:69]
  v_add_u32 v50, 64, v44
  v_mul_u32_u24 v48, 3277, v50
  v_lshrrev_b32 v48, 16, v48
  v_lshl_add_u32 v50, v50, 4, v47
  v_mad_i32_i24 v49, v48, s33, v50
  v_mad_i32_i24 v48, v48, -5, v45
  v_add_u32 v52, 12, v48
  v_add_u32 v53, 16, v48
  v_cmp_gt_u32 s[64:65], 5, v52
  v_cmp_gt_u32 s[66:67], 5, v53
  s_nop 0
  v_cndmask_b32 v30, v60, v49, s[64:65]
  v_cndmask_b32 v32, v61, v49, s[66:67]
  v_and_b32 v48, 3, v255
  v_mul_u32_u24 v49, 112, v48
  v_add_u32 v50, 320, v47
  v_add_u32 v49, v49, v50
  v_mad_i32_i24 v48, v48, -5, v45
  v_add_u32 v52, 0, v48
  v_add_u32 v53, 4, v48
  v_add_u32 v54, 8, v48
  v_add_u32 v55, 12, v48
  v_add_u32 v56, 16, v48
  v_cmp_gt_u32 s[64:65], 5, v52
  v_cmp_gt_u32 s[66:67], 5, v53
  v_cmp_gt_u32 s[68:69], 5, v54
  v_cmp_gt_u32 s[70:71], 5, v55
  v_cmp_gt_u32 s[72:73], 5, v56
  s_nop 0
  v_cndmask_b32 v33, v57, v49, s[64:65]
  v_cndmask_b32 v34, v58, v49, s[66:67]
  v_cndmask_b32 v35, v59, v49, s[68:69]
  v_cndmask_b32 v36, v60, v49, s[70:71]
  v_cndmask_b32 v37, v61, v49, s[72:73]
  s_waitcnt vmcnt(0)
  v_mov_b32 v70, 1
  v_mov_b32 v71, 0
  s_mov_b64 exec, 1
  buffer_atomic_add v70, v71, s[36:39], s31 offen offset:0 sc1
  s_mov_b64 exec, -1
  v_mov_b32 v70, 1
  v_mov_b32 v71, 0
  s_mov_b64 exec, 1
  buffer_atomic_add v70, v71, s[36:39], s32 offen offset:0 sc1
  s_mov_b64 exec, -1
  s_branch L_g2
L_kv:
  v_mov_b32 v253, v0
  v_and_b32 v1, 15, v0
  v_lshrrev_b32 v2, 4, v0
  v_lshrrev_b32 v3, 1, v1
  v_xor_b32 v3, v3, v2
  v_lshlrev_b32 v3, 4, v3
  v_lshl_add_u32 v3, v1, 7, v3
  s_lshl_b32 s60, s26, 12
  v_add_u32 v240, s60, v3
  v_xor_b32 v241, 64, v240
  v_lshrrev_b32 v3, 2, v0
  v_and_b32 v4, 3, v0
  v_lshlrev_b32 v4, 3, v4
  v_mul_u32_u24 v5, 160, v3
  v_add_u32 v5, v5, v4
  v_add_u32 v242, 49152, v5
  v_lshl_add_u32 v5, v3, 7, v4
  v_bfe_u32 v6, v0, 3, 2
  v_lshl_add_u32 v5, v6, 5, v5
  v_add_u32 v243, 59392, v5
  v_xor_b32 v244, 32, v243
  v_xor_b32 v245, 64, v243
  v_xor_b32 v246, 96, v243
  v_lshlrev_b32 v247, 4, v0
  s_lshr_b32 s60, s26, 1
  s_lshl1_add_u32 s61, s27, s60
  s_lshl_b32 s73, s61, 7
  s_add_u32 s73, s73, 32768
  s_mul_i32 s61, s61, 40
  s_lshl2_add_u32 s61, s30, s61
  s_and_b32 s60, s26, 1
  s_lshl1_add_u32 s61, s61, s60
  s_lshl_b32 s61, s61, 10
  s_add_u32 s72, s61, 5242880
  s_lshl2_add_u32 s60, s30, s26
  s_lshl_b32 s31, s60, 7
  s_add_u32 s31, s31, 36864
  s_mul_i32 s60, s60, 1792
  s_add_u32 s74, s60, 1048576
  s_mov_b32 s96, 0x3fb8aa3b
  s_mov_b32 s97, 0x3fb8aa3b
  s_mov_b32 s98, 0x3f800008
  s_mov_b32 s99, 0x3f800008
  s_mov_b32 s100, 0x358637bd
  s_mov_b32 s101, 0x358637bd
  s_waitcnt lgkmcnt(0)
  s_mov_b32 s36, s24
  s_mov_b32 s37, s25
  s_mov_b32 s38, 16777216
  s_mov_b32 s39, 0x20000
  s_barrier
  ds_read_b128 v[112:115], v240 offset:0
  ds_read_b128 v[116:119], v240 offset:2048
  ds_read_b64_tr_b16 v[128:129], v242 offset:0
  ds_read_b64_tr_b16 v[130:131], v242 offset:2560
  ds_read_b64_tr_b16 v[132:133], v242 offset:32
  ds_read_b64_tr_b16 v[134:135], v242 offset:2592
  ds_read_b64_tr_b16 v[136:137], v242 offset:64
  ds_read_b64_tr_b16 v[138:139], v242 offset:2624
  ds_read_b64_tr_b16 v[140:141], v242 offset:96
  ds_read_b64_tr_b16 v[142:143], v242 offset:2656
  ds_read_b64_tr_b16 v[144:145], v242 offset:128
  ds_read_b64_tr_b16 v[146:147], v242 offset:2688
  ds_read_b64_tr_b16 v[148:149], v242 offset:5120
  ds_read_b64_tr_b16 v[150:151], v242 offset:7680
  ds_read_b64_tr_b16 v[152:153], v242 offset:5152
  ds_read_b64_tr_b16 v[154:155], v242 offset:7712
  ds_read_b64_tr_b16 v[156:157], v242 offset:5184
  ds_read_b64_tr_b16 v[158:159], v242 offset:7744
  ds_read_b64_tr_b16 v[160:161], v242 offset:5216
  ds_read_b64_tr_b16 v[162:163], v242 offset:7776
  ds_read_b64_tr_b16 v[164:165], v242 offset:5248
  ds_read_b64_tr_b16 v[166:167], v242 offset:7808
  ds_read_b64_tr_b16 v[168:169], v243 offset:0
  ds_read_b64_tr_b16 v[170:171], v243 offset:2048
  ds_read_b64_tr_b16 v[172:173], v244 offset:0
  ds_read_b64_tr_b16 v[174:175], v244 offset:2048
  ds_read_b64_tr_b16 v[176:177], v245 offset:0
  ds_read_b64_tr_b16 v[178:179], v245 offset:2048
  ds_read_b64_tr_b16 v[180:181], v246 offset:0
  ds_read_b64_tr_b16 v[182:183], v246 offset:2048
  s_waitcnt lgkmcnt(0)
  s_barrier
  v_mfma_f32_16x16x32_bf16 v[0:3], v[112:115], v[128:131], 0
  ds_read_b128 v[120:123], v241 offset:0
  ds_read_b128 v[124:127], v241 offset:2048
  v_mfma_f32_16x16x32_bf16 v[4:7], v[116:119], v[128:131], 0
  ds_read_b64_tr_b16 v[184:185], v242 offset:14336
  v_mfma_f32_16x16x32_bf16 v[8:11], v[112:115], v[132:135], 0
  ds_read_b64_tr_b16 v[186:187], v242 offset:16896
  v_mfma_f32_16x16x32_bf16 v[12:15], v[116:119], v[132:135], 0
  ds_read_b64_tr_b16 v[188:189], v242 offset:14368
  v_mfma_f32_16x16x32_bf16 v[16:19], v[112:115], v[136:139], 0
  ds_read_b64_tr_b16 v[190:191], v242 offset:16928
  ds_read_b64_tr_b16 v[192:193], v242 offset:14400
  v_mfma_f32_16x16x32_bf16 v[20:23], v[116:119], v[136:139], 0
  ds_read_b64_tr_b16 v[194:195], v242 offset:16960
  v_mfma_f32_16x16x32_bf16 v[24:27], v[112:115], v[140:143], 0
  ds_read_b64_tr_b16 v[196:197], v242 offset:14432
  v_mfma_f32_16x16x32_bf16 v[28:31], v[116:119], v[140:143], 0
  ds_read_b64_tr_b16 v[198:199], v242 offset:16992
  v_mfma_f32_16x16x32_bf16 v[32:35], v[112:115], v[144:147], 0
  ds_read_b64_tr_b16 v[200:201], v242 offset:14464
  ds_read_b64_tr_b16 v[202:203], v242 offset:17024
  v_mfma_f32_16x16x32_bf16 v[36:39], v[116:119], v[144:147], 0
  ds_read_b64_tr_b16 v[204:205], v242 offset:19456
  v_mfma_f32_16x16x32_bf16 v[40:43], v[112:115], v[148:151], 0
  ds_read_b64_tr_b16 v[206:207], v242 offset:22016
  v_mfma_f32_16x16x32_bf16 v[44:47], v[116:119], v[148:151], 0
  ds_read_b64_tr_b16 v[208:209], v242 offset:19488
  v_mfma_f32_16x16x32_bf16 v[48:51], v[112:115], v[152:155], 0
  ds_read_b64_tr_b16 v[210:211], v242 offset:22048
  ds_read_b64_tr_b16 v[212:213], v242 offset:19520
  v_mfma_f32_16x16x32_bf16 v[52:55], v[116:119], v[152:155], 0
  ds_read_b64_tr_b16 v[214:215], v242 offset:22080
  v_mfma_f32_16x16x32_bf16 v[56:59], v[112:115], v[156:159], 0
  ds_read_b64_tr_b16 v[216:217], v242 offset:19552
  v_mfma_f32_16x16x32_bf16 v[60:63], v[116:119], v[156:159], 0
  ds_read_b64_tr_b16 v[218:219], v242 offset:22112
  v_mfma_f32_16x16x32_bf16 v[64:67], v[112:115], v[160:163], 0
  ds_read_b64_tr_b16 v[220:221], v242 offset:19584
  ds_read_b64_tr_b16 v[222:223], v242 offset:22144
  v_mfma_f32_16x16x32_bf16 v[68:71], v[116:119], v[160:163], 0
  ds_read_b64_tr_b16 v[224:225], v243 offset:14336
  v_mfma_f32_16x16x32_bf16 v[72:75], v[112:115], v[164:167], 0
  ds_read_b64_tr_b16 v[226:227], v243 offset:16384
  v_mfma_f32_16x16x32_bf16 v[76:79], v[116:119], v[164:167], 0
  ds_read_b64_tr_b16 v[228:229], v244 offset:14336
  v_mfma_f32_16x16x32_bf16 v[80:83], v[168:171], v[112:115], 0
  ds_read_b64_tr_b16 v[230:231], v244 offset:16384
  ds_read_b64_tr_b16 v[232:233], v245 offset:14336
  v_mfma_f32_16x16x32_bf16 v[84:87], v[168:171], v[116:119], 0
  ds_read_b64_tr_b16 v[234:235], v245 offset:16384
  v_mfma_f32_16x16x32_bf16 v[88:91], v[172:175], v[112:115], 0
  ds_read_b64_tr_b16 v[236:237], v246 offset:14336
  v_mfma_f32_16x16x32_bf16 v[92:95], v[172:175], v[116:119], 0
  ds_read_b64_tr_b16 v[238:239], v246 offset:16384
  v_mfma_f32_16x16x32_bf16 v[96:99], v[176:179], v[112:115], 0
  v_mfma_f32_16x16x32_bf16 v[100:103], v[176:179], v[116:119], 0
  v_mfma_f32_16x16x32_bf16 v[104:107], v[180:183], v[112:115], 0
  v_mfma_f32_16x16x32_bf16 v[108:111], v[180:183], v[116:119], 0
  s_waitcnt lgkmcnt(0)
  s_barrier
  v_mfma_f32_16x16x32_bf16 v[0:3], v[120:123], v[184:187], v[0:3]
  ds_read_b128 v[112:115], v240 offset:16384
  ds_read_b128 v[116:119], v240 offset:18432
  v_mfma_f32_16x16x32_bf16 v[4:7], v[124:127], v[184:187], v[4:7]
  ds_read_b64_tr_b16 v[128:129], v242 offset:28672
  v_mfma_f32_16x16x32_bf16 v[8:11], v[120:123], v[188:191], v[8:11]
  ds_read_b64_tr_b16 v[130:131], v242 offset:31232
  ds_read_b64_tr_b16 v[132:133], v242 offset:28704
  v_mfma_f32_16x16x32_bf16 v[12:15], v[124:127], v[188:191], v[12:15]
  ds_read_b64_tr_b16 v[134:135], v242 offset:31264
  v_mfma_f32_16x16x32_bf16 v[16:19], v[120:123], v[192:195], v[16:19]
  ds_read_b64_tr_b16 v[136:137], v242 offset:28736
  ds_read_b64_tr_b16 v[138:139], v242 offset:31296
  v_mfma_f32_16x16x32_bf16 v[20:23], v[124:127], v[192:195], v[20:23]
  ds_read_b64_tr_b16 v[140:141], v242 offset:28768
  v_mfma_f32_16x16x32_bf16 v[24:27], v[120:123], v[196:199], v[24:27]
  ds_read_b64_tr_b16 v[142:143], v242 offset:31328
  ds_read_b64_tr_b16 v[144:145], v242 offset:28800
  v_mfma_f32_16x16x32_bf16 v[28:31], v[124:127], v[196:199], v[28:31]
  ds_read_b64_tr_b16 v[146:147], v242 offset:31360
  v_mfma_f32_16x16x32_bf16 v[32:35], v[120:123], v[200:203], v[32:35]
  ds_read_b64_tr_b16 v[148:149], v242 offset:33792
  ds_read_b64_tr_b16 v[150:151], v242 offset:36352
  v_mfma_f32_16x16x32_bf16 v[36:39], v[124:127], v[200:203], v[36:39]
  ds_read_b64_tr_b16 v[152:153], v242 offset:33824
  v_mfma_f32_16x16x32_bf16 v[40:43], v[120:123], v[204:207], v[40:43]
  ds_read_b64_tr_b16 v[154:155], v242 offset:36384
  ds_read_b64_tr_b16 v[156:157], v242 offset:33856
  v_mfma_f32_16x16x32_bf16 v[44:47], v[124:127], v[204:207], v[44:47]
  ds_read_b64_tr_b16 v[158:159], v242 offset:36416
  v_mfma_f32_16x16x32_bf16 v[48:51], v[120:123], v[208:211], v[48:51]
  ds_read_b64_tr_b16 v[160:161], v242 offset:33888
  v_mfma_f32_16x16x32_bf16 v[52:55], v[124:127], v[208:211], v[52:55]
  ds_read_b64_tr_b16 v[162:163], v242 offset:36448
  ds_read_b64_tr_b16 v[164:165], v242 offset:33920
  v_mfma_f32_16x16x32_bf16 v[56:59], v[120:123], v[212:215], v[56:59]
  ds_read_b64_tr_b16 v[166:167], v242 offset:36480
  v_mfma_f32_16x16x32_bf16 v[60:63], v[124:127], v[212:215], v[60:63]
  ds_read_b64_tr_b16 v[168:169], v243 offset:28672
  ds_read_b64_tr_b16 v[170:171], v243 offset:30720
  v_mfma_f32_16x16x32_bf16 v[64:67], v[120:123], v[216:219], v[64:67]
  ds_read_b64_tr_b16 v[172:173], v244 offset:28672
  v_mfma_f32_16x16x32_bf16 v[68:71], v[124:127], v[216:219], v[68:71]
  ds_read_b64_tr_b16 v[174:175], v244 offset:30720
  ds_read_b64_tr_b16 v[176:177], v245 offset:28672
  v_mfma_f32_16x16x32_bf16 v[72:75], v[120:123], v[220:223], v[72:75]
  ds_read_b64_tr_b16 v[178:179], v245 offset:30720
  v_mfma_f32_16x16x32_bf16 v[76:79], v[124:127], v[220:223], v[76:79]
  ds_read_b64_tr_b16 v[180:181], v246 offset:28672
  ds_read_b64_tr_b16 v[182:183], v246 offset:30720
  v_mfma_f32_16x16x32_bf16 v[80:83], v[224:227], v[120:123], v[80:83]
  v_add_u32 v242, 43008, v242
  v_mfma_f32_16x16x32_bf16 v[84:87], v[224:227], v[124:127], v[84:87]
  v_add_u32 v243, 43008, v243
  v_add_u32 v244, 43008, v244
  v_mfma_f32_16x16x32_bf16 v[88:91], v[228:231], v[120:123], v[88:91]
  v_add_u32 v245, 43008, v245
  v_mfma_f32_16x16x32_bf16 v[92:95], v[228:231], v[124:127], v[92:95]
  v_add_u32 v246, 43008, v246
  v_mfma_f32_16x16x32_bf16 v[96:99], v[232:235], v[120:123], v[96:99]
  v_mfma_f32_16x16x32_bf16 v[100:103], v[232:235], v[124:127], v[100:103]
  v_mfma_f32_16x16x32_bf16 v[104:107], v[236:239], v[120:123], v[104:107]
  v_mfma_f32_16x16x32_bf16 v[108:111], v[236:239], v[124:127], v[108:111]
  s_waitcnt lgkmcnt(0)
  v_mfma_f32_16x16x32_bf16 v[0:3], v[112:115], v[128:131], v[0:3]
  ds_read_b128 v[120:123], v241 offset:16384
  ds_read_b128 v[124:127], v241 offset:18432
  v_mfma_f32_16x16x32_bf16 v[4:7], v[116:119], v[128:131], v[4:7]
  ds_read_b64_tr_b16 v[184:185], v242 offset:0
  v_mfma_f32_16x16x32_bf16 v[8:11], v[112:115], v[132:135], v[8:11]
  ds_read_b64_tr_b16 v[186:187], v242 offset:2560
  v_mfma_f32_16x16x32_bf16 v[12:15], v[116:119], v[132:135], v[12:15]
  ds_read_b64_tr_b16 v[188:189], v242 offset:32
  v_mfma_f32_16x16x32_bf16 v[16:19], v[112:115], v[136:139], v[16:19]
  ds_read_b64_tr_b16 v[190:191], v242 offset:2592
  ds_read_b64_tr_b16 v[192:193], v242 offset:64
  v_mfma_f32_16x16x32_bf16 v[20:23], v[116:119], v[136:139], v[20:23]
  ds_read_b64_tr_b16 v[194:195], v242 offset:2624
  v_mfma_f32_16x16x32_bf16 v[24:27], v[112:115], v[140:143], v[24:27]
  ds_read_b64_tr_b16 v[196:197], v242 offset:96
  v_mfma_f32_16x16x32_bf16 v[28:31], v[116:119], v[140:143], v[28:31]
  ds_read_b64_tr_b16 v[198:199], v242 offset:2656
  v_mfma_f32_16x16x32_bf16 v[32:35], v[112:115], v[144:147], v[32:35]
  ds_read_b64_tr_b16 v[200:201], v242 offset:128
  ds_read_b64_tr_b16 v[202:203], v242 offset:2688
  v_mfma_f32_16x16x32_bf16 v[36:39], v[116:119], v[144:147], v[36:39]
  ds_read_b64_tr_b16 v[204:205], v242 offset:5120
  v_mfma_f32_16x16x32_bf16 v[40:43], v[112:115], v[148:151], v[40:43]
  ds_read_b64_tr_b16 v[206:207], v242 offset:7680
  v_mfma_f32_16x16x32_bf16 v[44:47], v[116:119], v[148:151], v[44:47]
  ds_read_b64_tr_b16 v[208:209], v242 offset:5152
  v_mfma_f32_16x16x32_bf16 v[48:51], v[112:115], v[152:155], v[48:51]
  ds_read_b64_tr_b16 v[210:211], v242 offset:7712
  ds_read_b64_tr_b16 v[212:213], v242 offset:5184
  v_mfma_f32_16x16x32_bf16 v[52:55], v[116:119], v[152:155], v[52:55]
  ds_read_b64_tr_b16 v[214:215], v242 offset:7744
  v_mfma_f32_16x16x32_bf16 v[56:59], v[112:115], v[156:159], v[56:59]
  ds_read_b64_tr_b16 v[216:217], v242 offset:5216
  v_mfma_f32_16x16x32_bf16 v[60:63], v[116:119], v[156:159], v[60:63]
  ds_read_b64_tr_b16 v[218:219], v242 offset:7776
  v_mfma_f32_16x16x32_bf16 v[64:67], v[112:115], v[160:163], v[64:67]
  ds_read_b64_tr_b16 v[220:221], v242 offset:5248
  ds_read_b64_tr_b16 v[222:223], v242 offset:7808
  v_mfma_f32_16x16x32_bf16 v[68:71], v[116:119], v[160:163], v[68:71]
  ds_read_b64_tr_b16 v[224:225], v243 offset:0
  v_mfma_f32_16x16x32_bf16 v[72:75], v[112:115], v[164:167], v[72:75]
  ds_read_b64_tr_b16 v[226:227], v243 offset:2048
  v_mfma_f32_16x16x32_bf16 v[76:79], v[116:119], v[164:167], v[76:79]
  ds_read_b64_tr_b16 v[228:229], v244 offset:0
  v_mfma_f32_16x16x32_bf16 v[80:83], v[168:171], v[112:115], v[80:83]
  ds_read_b64_tr_b16 v[230:231], v244 offset:2048
  ds_read_b64_tr_b16 v[232:233], v245 offset:0
  v_mfma_f32_16x16x32_bf16 v[84:87], v[168:171], v[116:119], v[84:87]
  ds_read_b64_tr_b16 v[234:235], v245 offset:2048
  v_mfma_f32_16x16x32_bf16 v[88:91], v[172:175], v[112:115], v[88:91]
  ds_read_b64_tr_b16 v[236:237], v246 offset:0
  v_mfma_f32_16x16x32_bf16 v[92:95], v[172:175], v[116:119], v[92:95]
  ds_read_b64_tr_b16 v[238:239], v246 offset:2048
  v_mfma_f32_16x16x32_bf16 v[96:99], v[176:179], v[112:115], v[96:99]
  v_mfma_f32_16x16x32_bf16 v[100:103], v[176:179], v[116:119], v[100:103]
  v_mfma_f32_16x16x32_bf16 v[104:107], v[180:183], v[112:115], v[104:107]
  v_mfma_f32_16x16x32_bf16 v[108:111], v[180:183], v[116:119], v[108:111]
  s_waitcnt lgkmcnt(0)
  s_barrier
  v_mfma_f32_16x16x32_bf16 v[0:3], v[120:123], v[184:187], v[0:3]
  ds_read_b128 v[112:115], v240 offset:32768
  ds_read_b128 v[116:119], v240 offset:34816
  v_mfma_f32_16x16x32_bf16 v[4:7], v[124:127], v[184:187], v[4:7]
  ds_read_b64_tr_b16 v[128:129], v242 offset:14336
  v_mfma_f32_16x16x32_bf16 v[8:11], v[120:123], v[188:191], v[8:11]
  ds_read_b64_tr_b16 v[130:131], v242 offset:16896
  v_mfma_f32_16x16x32_bf16 v[12:15], v[124:127], v[188:191], v[12:15]
  ds_read_b64_tr_b16 v[132:133], v242 offset:14368
  v_mfma_f32_16x16x32_bf16 v[16:19], v[120:123], v[192:195], v[16:19]
  ds_read_b64_tr_b16 v[134:135], v242 offset:16928
  ds_read_b64_tr_b16 v[136:137], v242 offset:14400
  v_mfma_f32_16x16x32_bf16 v[20:23], v[124:127], v[192:195], v[20:23]
  ds_read_b64_tr_b16 v[138:139], v242 offset:16960
  v_mfma_f32_16x16x32_bf16 v[24:27], v[120:123], v[196:199], v[24:27]
  ds_read_b64_tr_b16 v[140:141], v242 offset:14432
  v_mfma_f32_16x16x32_bf16 v[28:31], v[124:127], v[196:199], v[28:31]
  ds_read_b64_tr_b16 v[142:143], v242 offset:16992
  v_mfma_f32_16x16x32_bf16 v[32:35], v[120:123], v[200:203], v[32:35]
  ds_read_b64_tr_b16 v[144:145], v242 offset:14464
  ds_read_b64_tr_b16 v[146:147], v242 offset:17024
  v_mfma_f32_16x16x32_bf16 v[36:39], v[124:127], v[200:203], v[36:39]
  ds_read_b64_tr_b16 v[148:149], v242 offset:19456
  v_mfma_f32_16x16x32_bf16 v[40:43], v[120:123], v[204:207], v[40:43]
  ds_read_b64_tr_b16 v[150:151], v242 offset:22016
  v_mfma_f32_16x16x32_bf16 v[44:47], v[124:127], v[204:207], v[44:47]
  ds_read_b64_tr_b16 v[152:153], v242 offset:19488
  v_mfma_f32_16x16x32_bf16 v[48:51], v[120:123], v[208:211], v[48:51]
  ds_read_b64_tr_b16 v[154:155], v242 offset:22048
  ds_read_b64_tr_b16 v[156:157], v242 offset:19520
  v_mfma_f32_16x16x32_bf16 v[52:55], v[124:127], v[208:211], v[52:55]
  ds_read_b64_tr_b16 v[158:159], v242 offset:22080
  v_mfma_f32_16x16x32_bf16 v[56:59], v[120:123], v[212:215], v[56:59]
  ds_read_b64_tr_b16 v[160:161], v242 offset:19552
  v_mfma_f32_16x16x32_bf16 v[60:63], v[124:127], v[212:215], v[60:63]
  ds_read_b64_tr_b16 v[162:163], v242 offset:22112
  v_mfma_f32_16x16x32_bf16 v[64:67], v[120:123], v[216:219], v[64:67]
  ds_read_b64_tr_b16 v[164:165], v242 offset:19584
  ds_read_b64_tr_b16 v[166:167], v242 offset:22144
  v_mfma_f32_16x16x32_bf16 v[68:71], v[124:127], v[216:219], v[68:71]
  ds_read_b64_tr_b16 v[168:169], v243 offset:14336
  v_mfma_f32_16x16x32_bf16 v[72:75], v[120:123], v[220:223], v[72:75]
  ds_read_b64_tr_b16 v[170:171], v243 offset:16384
  v_mfma_f32_16x16x32_bf16 v[76:79], v[124:127], v[220:223], v[76:79]
  ds_read_b64_tr_b16 v[172:173], v244 offset:14336
  v_mfma_f32_16x16x32_bf16 v[80:83], v[224:227], v[120:123], v[80:83]
  ds_read_b64_tr_b16 v[174:175], v244 offset:16384
  ds_read_b64_tr_b16 v[176:177], v245 offset:14336
  v_mfma_f32_16x16x32_bf16 v[84:87], v[224:227], v[124:127], v[84:87]
  ds_read_b64_tr_b16 v[178:179], v245 offset:16384
  v_mfma_f32_16x16x32_bf16 v[88:91], v[228:231], v[120:123], v[88:91]
  ds_read_b64_tr_b16 v[180:181], v246 offset:14336
  v_mfma_f32_16x16x32_bf16 v[92:95], v[228:231], v[124:127], v[92:95]
  ds_read_b64_tr_b16 v[182:183], v246 offset:16384
  v_mfma_f32_16x16x32_bf16 v[96:99], v[232:235], v[120:123], v[96:99]
  v_mfma_f32_16x16x32_bf16 v[100:103], v[232:235], v[124:127], v[100:103]
  v_mfma_f32_16x16x32_bf16 v[104:107], v[236:239], v[120:123], v[104:107]
  v_mfma_f32_16x16x32_bf16 v[108:111], v[236:239], v[124:127], v[108:111]
  s_waitcnt lgkmcnt(0)
  v_mfma_f32_16x16x32_bf16 v[0:3], v[112:115], v[128:131], v[0:3]
  ds_read_b128 v[120:123], v241 offset:32768
  ds_read_b128 v[124:127], v241 offset:34816
  v_mfma_f32_16x16x32_bf16 v[4:7], v[116:119], v[128:131], v[4:7]
  ds_read_b64_tr_b16 v[184:185], v242 offset:28672
  v_mfma_f32_16x16x32_bf16 v[8:11], v[112:115], v[132:135], v[8:11]
  ds_read_b64_tr_b16 v[186:187], v242 offset:31232
  ds_read_b64_tr_b16 v[188:189], v242 offset:28704
  v_mfma_f32_16x16x32_bf16 v[12:15], v[116:119], v[132:135], v[12:15]
  ds_read_b64_tr_b16 v[190:191], v242 offset:31264
  v_mfma_f32_16x16x32_bf16 v[16:19], v[112:115], v[136:139], v[16:19]
  ds_read_b64_tr_b16 v[192:193], v242 offset:28736
  ds_read_b64_tr_b16 v[194:195], v242 offset:31296
  v_mfma_f32_16x16x32_bf16 v[20:23], v[116:119], v[136:139], v[20:23]
  ds_read_b64_tr_b16 v[196:197], v242 offset:28768
  v_mfma_f32_16x16x32_bf16 v[24:27], v[112:115], v[140:143], v[24:27]
  ds_read_b64_tr_b16 v[198:199], v242 offset:31328
  ds_read_b64_tr_b16 v[200:201], v242 offset:28800
  v_mfma_f32_16x16x32_bf16 v[28:31], v[116:119], v[140:143], v[28:31]
  ds_read_b64_tr_b16 v[202:203], v242 offset:31360
  v_mfma_f32_16x16x32_bf16 v[32:35], v[112:115], v[144:147], v[32:35]
  ds_read_b64_tr_b16 v[204:205], v242 offset:33792
  ds_read_b64_tr_b16 v[206:207], v242 offset:36352
  v_mfma_f32_16x16x32_bf16 v[36:39], v[116:119], v[144:147], v[36:39]
  ds_read_b64_tr_b16 v[208:209], v242 offset:33824
  v_mfma_f32_16x16x32_bf16 v[40:43], v[112:115], v[148:151], v[40:43]
  ds_read_b64_tr_b16 v[210:211], v242 offset:36384
  ds_read_b64_tr_b16 v[212:213], v242 offset:33856
  v_mfma_f32_16x16x32_bf16 v[44:47], v[116:119], v[148:151], v[44:47]
  ds_read_b64_tr_b16 v[214:215], v242 offset:36416
  v_mfma_f32_16x16x32_bf16 v[48:51], v[112:115], v[152:155], v[48:51]
  ds_read_b64_tr_b16 v[216:217], v242 offset:33888
  v_mfma_f32_16x16x32_bf16 v[52:55], v[116:119], v[152:155], v[52:55]
  ds_read_b64_tr_b16 v[218:219], v242 offset:36448
  ds_read_b64_tr_b16 v[220:221], v242 offset:33920
  v_mfma_f32_16x16x32_bf16 v[56:59], v[112:115], v[156:159], v[56:59]
  ds_read_b64_tr_b16 v[222:223], v242 offset:36480
  v_mfma_f32_16x16x32_bf16 v[60:63], v[116:119], v[156:159], v[60:63]
  ds_read_b64_tr_b16 v[224:225], v243 offset:28672
  ds_read_b64_tr_b16 v[226:227], v243 offset:30720
  v_mfma_f32_16x16x32_bf16 v[64:67], v[112:115], v[160:163], v[64:67]
  ds_read_b64_tr_b16 v[228:229], v244 offset:28672
  v_mfma_f32_16x16x32_bf16 v[68:71], v[116:119], v[160:163], v[68:71]
  ds_read_b64_tr_b16 v[230:231], v244 offset:30720
  ds_read_b64_tr_b16 v[232:233], v245 offset:28672
  v_mfma_f32_16x16x32_bf16 v[72:75], v[112:115], v[164:167], v[72:75]
  ds_read_b64_tr_b16 v[234:235], v245 offset:30720
  v_mfma_f32_16x16x32_bf16 v[76:79], v[116:119], v[164:167], v[76:79]
  ds_read_b64_tr_b16 v[236:237], v246 offset:28672
  ds_read_b64_tr_b16 v[238:239], v246 offset:30720
  v_mfma_f32_16x16x32_bf16 v[80:83], v[168:171], v[112:115], v[80:83]
  v_subrev_u32 v242, 43008, v242
  v_mfma_f32_16x16x32_bf16 v[84:87], v[168:171], v[116:119], v[84:87]
  v_subrev_u32 v243, 43008, v243
  v_subrev_u32 v244, 43008, v244
  v_mfma_f32_16x16x32_bf16 v[88:91], v[172:175], v[112:115], v[88:91]
  v_subrev_u32 v245, 43008, v245
  v_mfma_f32_16x16x32_bf16 v[92:95], v[172:175], v[116:119], v[92:95]
  v_subrev_u32 v246, 43008, v246
  v_mfma_f32_16x16x32_bf16 v[96:99], v[176:179], v[112:115], v[96:99]
  v_mfma_f32_16x16x32_bf16 v[100:103], v[176:179], v[116:119], v[100:103]
  v_mfma_f32_16x16x32_bf16 v[104:107], v[180:183], v[112:115], v[104:107]
  v_mfma_f32_16x16x32_bf16 v[108:111], v[180:183], v[116:119], v[108:111]
  s_waitcnt lgkmcnt(0)
  s_barrier
  v_mfma_f32_16x16x32_bf16 v[0:3], v[120:123], v[184:187], v[0:3]
  ds_read_b128 v[112:115], v240 offset:0
  ds_read_b128 v[116:119], v240 offset:2048
  v_mfma_f32_16x16x32_bf16 v[4:7], v[124:127], v[184:187], v[4:7]
  ds_read_b64_tr_b16 v[128:129], v242 offset:0
  v_mfma_f32_16x16x32_bf16 v[8:11], v[120:123], v[188:191], v[8:11]
  ds_read_b64_tr_b16 v[130:131], v242 offset:2560
  v_mfma_f32_16x16x32_bf16 v[12:15], v[124:127], v[188:191], v[12:15]
  ds_read_b64_tr_b16 v[132:133], v242 offset:32
  v_mfma_f32_16x16x32_bf16 v[16:19], v[120:123], v[192:195], v[16:19]
  ds_read_b64_tr_b16 v[134:135], v242 offset:2592
  ds_read_b64_tr_b16 v[136:137], v242 offset:64
  v_mfma_f32_16x16x32_bf16 v[20:23], v[124:127], v[192:195], v[20:23]
  ds_read_b64_tr_b16 v[138:139], v242 offset:2624
  v_mfma_f32_16x16x32_bf16 v[24:27], v[120:123], v[196:199], v[24:27]
  ds_read_b64_tr_b16 v[140:141], v242 offset:96
  v_mfma_f32_16x16x32_bf16 v[28:31], v[124:127], v[196:199], v[28:31]
  ds_read_b64_tr_b16 v[142:143], v242 offset:2656
  v_mfma_f32_16x16x32_bf16 v[32:35], v[120:123], v[200:203], v[32:35]
  ds_read_b64_tr_b16 v[144:145], v242 offset:128
  ds_read_b64_tr_b16 v[146:147], v242 offset:2688
  v_mfma_f32_16x16x32_bf16 v[36:39], v[124:127], v[200:203], v[36:39]
  ds_read_b64_tr_b16 v[148:149], v242 offset:5120
  v_mfma_f32_16x16x32_bf16 v[40:43], v[120:123], v[204:207], v[40:43]
  ds_read_b64_tr_b16 v[150:151], v242 offset:7680
  v_mfma_f32_16x16x32_bf16 v[44:47], v[124:127], v[204:207], v[44:47]
  ds_read_b64_tr_b16 v[152:153], v242 offset:5152
  v_mfma_f32_16x16x32_bf16 v[48:51], v[120:123], v[208:211], v[48:51]
  ds_read_b64_tr_b16 v[154:155], v242 offset:7712
  ds_read_b64_tr_b16 v[156:157], v242 offset:5184
  v_mfma_f32_16x16x32_bf16 v[52:55], v[124:127], v[208:211], v[52:55]
  ds_read_b64_tr_b16 v[158:159], v242 offset:7744
  v_mfma_f32_16x16x32_bf16 v[56:59], v[120:123], v[212:215], v[56:59]
  ds_read_b64_tr_b16 v[160:161], v242 offset:5216
  v_mfma_f32_16x16x32_bf16 v[60:63], v[124:127], v[212:215], v[60:63]
  ds_read_b64_tr_b16 v[162:163], v242 offset:7776
  v_mfma_f32_16x16x32_bf16 v[64:67], v[120:123], v[216:219], v[64:67]
  ds_read_b64_tr_b16 v[164:165], v242 offset:5248
  ds_read_b64_tr_b16 v[166:167], v242 offset:7808
  v_mfma_f32_16x16x32_bf16 v[68:71], v[124:127], v[216:219], v[68:71]
  ds_read_b64_tr_b16 v[168:169], v243 offset:0
  v_mfma_f32_16x16x32_bf16 v[72:75], v[120:123], v[220:223], v[72:75]
  ds_read_b64_tr_b16 v[170:171], v243 offset:2048
  v_mfma_f32_16x16x32_bf16 v[76:79], v[124:127], v[220:223], v[76:79]
  ds_read_b64_tr_b16 v[172:173], v244 offset:0
  v_mfma_f32_16x16x32_bf16 v[80:83], v[224:227], v[120:123], v[80:83]
  ds_read_b64_tr_b16 v[174:175], v244 offset:2048
  ds_read_b64_tr_b16 v[176:177], v245 offset:0
  v_mfma_f32_16x16x32_bf16 v[84:87], v[224:227], v[124:127], v[84:87]
  ds_read_b64_tr_b16 v[178:179], v245 offset:2048
  v_mfma_f32_16x16x32_bf16 v[88:91], v[228:231], v[120:123], v[88:91]
  ds_read_b64_tr_b16 v[180:181], v246 offset:0
  v_mfma_f32_16x16x32_bf16 v[92:95], v[228:231], v[124:127], v[92:95]
  ds_read_b64_tr_b16 v[182:183], v246 offset:2048
  v_mfma_f32_16x16x32_bf16 v[96:99], v[232:235], v[120:123], v[96:99]
  v_mfma_f32_16x16x32_bf16 v[100:103], v[232:235], v[124:127], v[100:103]
  v_mfma_f32_16x16x32_bf16 v[104:107], v[236:239], v[120:123], v[104:107]
  v_mfma_f32_16x16x32_bf16 v[108:111], v[236:239], v[124:127], v[108:111]
  s_waitcnt lgkmcnt(0)
  v_mfma_f32_16x16x32_bf16 v[0:3], v[112:115], v[128:131], v[0:3]
  ds_read_b128 v[120:123], v241 offset:0
  ds_read_b128 v[124:127], v241 offset:2048
  v_mfma_f32_16x16x32_bf16 v[4:7], v[116:119], v[128:131], v[4:7]
  ds_read_b64_tr_b16 v[184:185], v242 offset:14336
  v_mfma_f32_16x16x32_bf16 v[8:11], v[112:115], v[132:135], v[8:11]
  ds_read_b64_tr_b16 v[186:187], v242 offset:16896
  v_mfma_f32_16x16x32_bf16 v[12:15], v[116:119], v[132:135], v[12:15]
  ds_read_b64_tr_b16 v[188:189], v242 offset:14368
  v_mfma_f32_16x16x32_bf16 v[16:19], v[112:115], v[136:139], v[16:19]
  ds_read_b64_tr_b16 v[190:191], v242 offset:16928
  ds_read_b64_tr_b16 v[192:193], v242 offset:14400
  v_mfma_f32_16x16x32_bf16 v[20:23], v[116:119], v[136:139], v[20:23]
  ds_read_b64_tr_b16 v[194:195], v242 offset:16960
  v_mfma_f32_16x16x32_bf16 v[24:27], v[112:115], v[140:143], v[24:27]
  ds_read_b64_tr_b16 v[196:197], v242 offset:14432
  v_mfma_f32_16x16x32_bf16 v[28:31], v[116:119], v[140:143], v[28:31]
  ds_read_b64_tr_b16 v[198:199], v242 offset:16992
  v_mfma_f32_16x16x32_bf16 v[32:35], v[112:115], v[144:147], v[32:35]
  ds_read_b64_tr_b16 v[200:201], v242 offset:14464
  ds_read_b64_tr_b16 v[202:203], v242 offset:17024
  v_mfma_f32_16x16x32_bf16 v[36:39], v[116:119], v[144:147], v[36:39]
  ds_read_b64_tr_b16 v[204:205], v242 offset:19456
  v_mfma_f32_16x16x32_bf16 v[40:43], v[112:115], v[148:151], v[40:43]
  ds_read_b64_tr_b16 v[206:207], v242 offset:22016
  v_mfma_f32_16x16x32_bf16 v[44:47], v[116:119], v[148:151], v[44:47]
  ds_read_b64_tr_b16 v[208:209], v242 offset:19488
  v_mfma_f32_16x16x32_bf16 v[48:51], v[112:115], v[152:155], v[48:51]
  ds_read_b64_tr_b16 v[210:211], v242 offset:22048
  ds_read_b64_tr_b16 v[212:213], v242 offset:19520
  v_mfma_f32_16x16x32_bf16 v[52:55], v[116:119], v[152:155], v[52:55]
  ds_read_b64_tr_b16 v[214:215], v242 offset:22080
  v_mfma_f32_16x16x32_bf16 v[56:59], v[112:115], v[156:159], v[56:59]
  ds_read_b64_tr_b16 v[216:217], v242 offset:19552
  v_mfma_f32_16x16x32_bf16 v[60:63], v[116:119], v[156:159], v[60:63]
  ds_read_b64_tr_b16 v[218:219], v242 offset:22112
  v_mfma_f32_16x16x32_bf16 v[64:67], v[112:115], v[160:163], v[64:67]
  ds_read_b64_tr_b16 v[220:221], v242 offset:19584
  ds_read_b64_tr_b16 v[222:223], v242 offset:22144
  v_mfma_f32_16x16x32_bf16 v[68:71], v[116:119], v[160:163], v[68:71]
  ds_read_b64_tr_b16 v[224:225], v243 offset:14336
  v_mfma_f32_16x16x32_bf16 v[72:75], v[112:115], v[164:167], v[72:75]
  ds_read_b64_tr_b16 v[226:227], v243 offset:16384
  v_mfma_f32_16x16x32_bf16 v[76:79], v[116:119], v[164:167], v[76:79]
  ds_read_b64_tr_b16 v[228:229], v244 offset:14336
  v_mfma_f32_16x16x32_bf16 v[80:83], v[168:171], v[112:115], v[80:83]
  ds_read_b64_tr_b16 v[230:231], v244 offset:16384
  ds_read_b64_tr_b16 v[232:233], v245 offset:14336
  v_mfma_f32_16x16x32_bf16 v[84:87], v[168:171], v[116:119], v[84:87]
  ds_read_b64_tr_b16 v[234:235], v245 offset:16384
  v_mfma_f32_16x16x32_bf16 v[88:91], v[172:175], v[112:115], v[88:91]
  ds_read_b64_tr_b16 v[236:237], v246 offset:14336
  v_mfma_f32_16x16x32_bf16 v[92:95], v[172:175], v[116:119], v[92:95]
  ds_read_b64_tr_b16 v[238:239], v246 offset:16384
  v_mfma_f32_16x16x32_bf16 v[96:99], v[176:179], v[112:115], v[96:99]
  v_mfma_f32_16x16x32_bf16 v[100:103], v[176:179], v[116:119], v[100:103]
  v_mfma_f32_16x16x32_bf16 v[104:107], v[180:183], v[112:115], v[104:107]
  v_mfma_f32_16x16x32_bf16 v[108:111], v[180:183], v[116:119], v[108:111]
  s_waitcnt lgkmcnt(0)
  s_barrier
  v_mfma_f32_16x16x32_bf16 v[0:3], v[120:123], v[184:187], v[0:3]
  ds_read_b128 v[112:115], v240 offset:16384
  ds_read_b128 v[116:119], v240 offset:18432
  v_mfma_f32_16x16x32_bf16 v[4:7], v[124:127], v[184:187], v[4:7]
  ds_read_b64_tr_b16 v[128:129], v242 offset:28672
  v_mfma_f32_16x16x32_bf16 v[8:11], v[120:123], v[188:191], v[8:11]
  ds_read_b64_tr_b16 v[130:131], v242 offset:31232
  ds_read_b64_tr_b16 v[132:133], v242 offset:28704
  v_mfma_f32_16x16x32_bf16 v[12:15], v[124:127], v[188:191], v[12:15]
  ds_read_b64_tr_b16 v[134:135], v242 offset:31264
  v_mfma_f32_16x16x32_bf16 v[16:19], v[120:123], v[192:195], v[16:19]
  ds_read_b64_tr_b16 v[136:137], v242 offset:28736
  ds_read_b64_tr_b16 v[138:139], v242 offset:31296
  v_mfma_f32_16x16x32_bf16 v[20:23], v[124:127], v[192:195], v[20:23]
  ds_read_b64_tr_b16 v[140:141], v242 offset:28768
  v_mfma_f32_16x16x32_bf16 v[24:27], v[120:123], v[196:199], v[24:27]
  ds_read_b64_tr_b16 v[142:143], v242 offset:31328
  ds_read_b64_tr_b16 v[144:145], v242 offset:28800
  v_mfma_f32_16x16x32_bf16 v[28:31], v[124:127], v[196:199], v[28:31]
  ds_read_b64_tr_b16 v[146:147], v242 offset:31360
  v_mfma_f32_16x16x32_bf16 v[32:35], v[120:123], v[200:203], v[32:35]
  ds_read_b64_tr_b16 v[148:149], v242 offset:33792
  ds_read_b64_tr_b16 v[150:151], v242 offset:36352
  v_mfma_f32_16x16x32_bf16 v[36:39], v[124:127], v[200:203], v[36:39]
  ds_read_b64_tr_b16 v[152:153], v242 offset:33824
  v_mfma_f32_16x16x32_bf16 v[40:43], v[120:123], v[204:207], v[40:43]
  ds_read_b64_tr_b16 v[154:155], v242 offset:36384
  ds_read_b64_tr_b16 v[156:157], v242 offset:33856
  v_mfma_f32_16x16x32_bf16 v[44:47], v[124:127], v[204:207], v[44:47]
  ds_read_b64_tr_b16 v[158:159], v242 offset:36416
  v_mfma_f32_16x16x32_bf16 v[48:51], v[120:123], v[208:211], v[48:51]
  ds_read_b64_tr_b16 v[160:161], v242 offset:33888
  v_mfma_f32_16x16x32_bf16 v[52:55], v[124:127], v[208:211], v[52:55]
  ds_read_b64_tr_b16 v[162:163], v242 offset:36448
  ds_read_b64_tr_b16 v[164:165], v242 offset:33920
  v_mfma_f32_16x16x32_bf16 v[56:59], v[120:123], v[212:215], v[56:59]
  ds_read_b64_tr_b16 v[166:167], v242 offset:36480
  v_mfma_f32_16x16x32_bf16 v[60:63], v[124:127], v[212:215], v[60:63]
  ds_read_b64_tr_b16 v[168:169], v243 offset:28672
  ds_read_b64_tr_b16 v[170:171], v243 offset:30720
  v_mfma_f32_16x16x32_bf16 v[64:67], v[120:123], v[216:219], v[64:67]
  ds_read_b64_tr_b16 v[172:173], v244 offset:28672
  v_mfma_f32_16x16x32_bf16 v[68:71], v[124:127], v[216:219], v[68:71]
  ds_read_b64_tr_b16 v[174:175], v244 offset:30720
  ds_read_b64_tr_b16 v[176:177], v245 offset:28672
  v_mfma_f32_16x16x32_bf16 v[72:75], v[120:123], v[220:223], v[72:75]
  ds_read_b64_tr_b16 v[178:179], v245 offset:30720
  v_mfma_f32_16x16x32_bf16 v[76:79], v[124:127], v[220:223], v[76:79]
  ds_read_b64_tr_b16 v[180:181], v246 offset:28672
  ds_read_b64_tr_b16 v[182:183], v246 offset:30720
  v_mfma_f32_16x16x32_bf16 v[80:83], v[224:227], v[120:123], v[80:83]
  v_add_u32 v242, 43008, v242
  v_mfma_f32_16x16x32_bf16 v[84:87], v[224:227], v[124:127], v[84:87]
  v_add_u32 v243, 43008, v243
  v_add_u32 v244, 43008, v244
  v_mfma_f32_16x16x32_bf16 v[88:91], v[228:231], v[120:123], v[88:91]
  v_add_u32 v245, 43008, v245
  v_mfma_f32_16x16x32_bf16 v[92:95], v[228:231], v[124:127], v[92:95]
  v_add_u32 v246, 43008, v246
  v_mfma_f32_16x16x32_bf16 v[96:99], v[232:235], v[120:123], v[96:99]
  v_mfma_f32_16x16x32_bf16 v[100:103], v[232:235], v[124:127], v[100:103]
  v_mfma_f32_16x16x32_bf16 v[104:107], v[236:239], v[120:123], v[104:107]
  v_mfma_f32_16x16x32_bf16 v[108:111], v[236:239], v[124:127], v[108:111]
  s_waitcnt lgkmcnt(0)
  v_mfma_f32_16x16x32_bf16 v[0:3], v[112:115], v[128:131], v[0:3]
  ds_read_b128 v[120:123], v241 offset:16384
  ds_read_b128 v[124:127], v241 offset:18432
  v_mfma_f32_16x16x32_bf16 v[4:7], v[116:119], v[128:131], v[4:7]
  ds_read_b64_tr_b16 v[184:185], v242 offset:0
  v_mfma_f32_16x16x32_bf16 v[8:11], v[112:115], v[132:135], v[8:11]
  ds_read_b64_tr_b16 v[186:187], v242 offset:2560
  v_mfma_f32_16x16x32_bf16 v[12:15], v[116:119], v[132:135], v[12:15]
  ds_read_b64_tr_b16 v[188:189], v242 offset:32
  v_mfma_f32_16x16x32_bf16 v[16:19], v[112:115], v[136:139], v[16:19]
  ds_read_b64_tr_b16 v[190:191], v242 offset:2592
  ds_read_b64_tr_b16 v[192:193], v242 offset:64
  v_mfma_f32_16x16x32_bf16 v[20:23], v[116:119], v[136:139], v[20:23]
  ds_read_b64_tr_b16 v[194:195], v242 offset:2624
  v_mfma_f32_16x16x32_bf16 v[24:27], v[112:115], v[140:143], v[24:27]
  ds_read_b64_tr_b16 v[196:197], v242 offset:96
  v_mfma_f32_16x16x32_bf16 v[28:31], v[116:119], v[140:143], v[28:31]
  ds_read_b64_tr_b16 v[198:199], v242 offset:2656
  v_mfma_f32_16x16x32_bf16 v[32:35], v[112:115], v[144:147], v[32:35]
  ds_read_b64_tr_b16 v[200:201], v242 offset:128
  ds_read_b64_tr_b16 v[202:203], v242 offset:2688
  v_mfma_f32_16x16x32_bf16 v[36:39], v[116:119], v[144:147], v[36:39]
  ds_read_b64_tr_b16 v[204:205], v242 offset:5120
  v_mfma_f32_16x16x32_bf16 v[40:43], v[112:115], v[148:151], v[40:43]
  ds_read_b64_tr_b16 v[206:207], v242 offset:7680
  v_mfma_f32_16x16x32_bf16 v[44:47], v[116:119], v[148:151], v[44:47]
  ds_read_b64_tr_b16 v[208:209], v242 offset:5152
  v_mfma_f32_16x16x32_bf16 v[48:51], v[112:115], v[152:155], v[48:51]
  ds_read_b64_tr_b16 v[210:211], v242 offset:7712
  ds_read_b64_tr_b16 v[212:213], v242 offset:5184
  v_mfma_f32_16x16x32_bf16 v[52:55], v[116:119], v[152:155], v[52:55]
  ds_read_b64_tr_b16 v[214:215], v242 offset:7744
  v_mfma_f32_16x16x32_bf16 v[56:59], v[112:115], v[156:159], v[56:59]
  ds_read_b64_tr_b16 v[216:217], v242 offset:5216
  v_mfma_f32_16x16x32_bf16 v[60:63], v[116:119], v[156:159], v[60:63]
  ds_read_b64_tr_b16 v[218:219], v242 offset:7776
  v_mfma_f32_16x16x32_bf16 v[64:67], v[112:115], v[160:163], v[64:67]
  ds_read_b64_tr_b16 v[220:221], v242 offset:5248
  ds_read_b64_tr_b16 v[222:223], v242 offset:7808
  v_mfma_f32_16x16x32_bf16 v[68:71], v[116:119], v[160:163], v[68:71]
  ds_read_b64_tr_b16 v[224:225], v243 offset:0
  v_mfma_f32_16x16x32_bf16 v[72:75], v[112:115], v[164:167], v[72:75]
  ds_read_b64_tr_b16 v[226:227], v243 offset:2048
  v_mfma_f32_16x16x32_bf16 v[76:79], v[116:119], v[164:167], v[76:79]
  ds_read_b64_tr_b16 v[228:229], v244 offset:0
  v_mfma_f32_16x16x32_bf16 v[80:83], v[168:171], v[112:115], v[80:83]
  ds_read_b64_tr_b16 v[230:231], v244 offset:2048
  ds_read_b64_tr_b16 v[232:233], v245 offset:0
  v_mfma_f32_16x16x32_bf16 v[84:87], v[168:171], v[116:119], v[84:87]
  ds_read_b64_tr_b16 v[234:235], v245 offset:2048
  v_mfma_f32_16x16x32_bf16 v[88:91], v[172:175], v[112:115], v[88:91]
  ds_read_b64_tr_b16 v[236:237], v246 offset:0
  v_mfma_f32_16x16x32_bf16 v[92:95], v[172:175], v[116:119], v[92:95]
  ds_read_b64_tr_b16 v[238:239], v246 offset:2048
  v_mfma_f32_16x16x32_bf16 v[96:99], v[176:179], v[112:115], v[96:99]
  v_mfma_f32_16x16x32_bf16 v[100:103], v[176:179], v[116:119], v[100:103]
  v_mfma_f32_16x16x32_bf16 v[104:107], v[180:183], v[112:115], v[104:107]
  v_mfma_f32_16x16x32_bf16 v[108:111], v[180:183], v[116:119], v[108:111]
  s_waitcnt lgkmcnt(0)
  s_barrier
  v_mfma_f32_16x16x32_bf16 v[0:3], v[120:123], v[184:187], v[0:3]
  ds_read_b128 v[112:115], v240 offset:32768
  ds_read_b128 v[116:119], v240 offset:34816
  v_mfma_f32_16x16x32_bf16 v[4:7], v[124:127], v[184:187], v[4:7]
  ds_read_b64_tr_b16 v[128:129], v242 offset:14336
  v_mfma_f32_16x16x32_bf16 v[8:11], v[120:123], v[188:191], v[8:11]
  ds_read_b64_tr_b16 v[130:131], v242 offset:16896
  v_mfma_f32_16x16x32_bf16 v[12:15], v[124:127], v[188:191], v[12:15]
  ds_read_b64_tr_b16 v[132:133], v242 offset:14368
  v_mfma_f32_16x16x32_bf16 v[16:19], v[120:123], v[192:195], v[16:19]
  ds_read_b64_tr_b16 v[134:135], v242 offset:16928
  ds_read_b64_tr_b16 v[136:137], v242 offset:14400
  v_mfma_f32_16x16x32_bf16 v[20:23], v[124:127], v[192:195], v[20:23]
  ds_read_b64_tr_b16 v[138:139], v242 offset:16960
  v_mfma_f32_16x16x32_bf16 v[24:27], v[120:123], v[196:199], v[24:27]
  ds_read_b64_tr_b16 v[140:141], v242 offset:14432
  v_mfma_f32_16x16x32_bf16 v[28:31], v[124:127], v[196:199], v[28:31]
  ds_read_b64_tr_b16 v[142:143], v242 offset:16992
  v_mfma_f32_16x16x32_bf16 v[32:35], v[120:123], v[200:203], v[32:35]
  ds_read_b64_tr_b16 v[144:145], v242 offset:14464
  ds_read_b64_tr_b16 v[146:147], v242 offset:17024
  v_mfma_f32_16x16x32_bf16 v[36:39], v[124:127], v[200:203], v[36:39]
  ds_read_b64_tr_b16 v[148:149], v242 offset:19456
  v_mfma_f32_16x16x32_bf16 v[40:43], v[120:123], v[204:207], v[40:43]
  ds_read_b64_tr_b16 v[150:151], v242 offset:22016
  v_mfma_f32_16x16x32_bf16 v[44:47], v[124:127], v[204:207], v[44:47]
  ds_read_b64_tr_b16 v[152:153], v242 offset:19488
  v_mfma_f32_16x16x32_bf16 v[48:51], v[120:123], v[208:211], v[48:51]
  ds_read_b64_tr_b16 v[154:155], v242 offset:22048
  ds_read_b64_tr_b16 v[156:157], v242 offset:19520
  v_mfma_f32_16x16x32_bf16 v[52:55], v[124:127], v[208:211], v[52:55]
  ds_read_b64_tr_b16 v[158:159], v242 offset:22080
  v_mfma_f32_16x16x32_bf16 v[56:59], v[120:123], v[212:215], v[56:59]
  ds_read_b64_tr_b16 v[160:161], v242 offset:19552
  v_mfma_f32_16x16x32_bf16 v[60:63], v[124:127], v[212:215], v[60:63]
  ds_read_b64_tr_b16 v[162:163], v242 offset:22112
  v_mfma_f32_16x16x32_bf16 v[64:67], v[120:123], v[216:219], v[64:67]
  ds_read_b64_tr_b16 v[164:165], v242 offset:19584
  ds_read_b64_tr_b16 v[166:167], v242 offset:22144
  v_mfma_f32_16x16x32_bf16 v[68:71], v[124:127], v[216:219], v[68:71]
  ds_read_b64_tr_b16 v[168:169], v243 offset:14336
  v_mfma_f32_16x16x32_bf16 v[72:75], v[120:123], v[220:223], v[72:75]
  ds_read_b64_tr_b16 v[170:171], v243 offset:16384
  v_mfma_f32_16x16x32_bf16 v[76:79], v[124:127], v[220:223], v[76:79]
  ds_read_b64_tr_b16 v[172:173], v244 offset:14336
  v_mfma_f32_16x16x32_bf16 v[80:83], v[224:227], v[120:123], v[80:83]
  ds_read_b64_tr_b16 v[174:175], v244 offset:16384
  ds_read_b64_tr_b16 v[176:177], v245 offset:14336
  v_mfma_f32_16x16x32_bf16 v[84:87], v[224:227], v[124:127], v[84:87]
  ds_read_b64_tr_b16 v[178:179], v245 offset:16384
  v_mfma_f32_16x16x32_bf16 v[88:91], v[228:231], v[120:123], v[88:91]
  ds_read_b64_tr_b16 v[180:181], v246 offset:14336
  v_mfma_f32_16x16x32_bf16 v[92:95], v[228:231], v[124:127], v[92:95]
  ds_read_b64_tr_b16 v[182:183], v246 offset:16384
  v_mfma_f32_16x16x32_bf16 v[96:99], v[232:235], v[120:123], v[96:99]
  v_mfma_f32_16x16x32_bf16 v[100:103], v[232:235], v[124:127], v[100:103]
  v_mfma_f32_16x16x32_bf16 v[104:107], v[236:239], v[120:123], v[104:107]
  v_mfma_f32_16x16x32_bf16 v[108:111], v[236:239], v[124:127], v[108:111]
  s_waitcnt lgkmcnt(0)
  v_mfma_f32_16x16x32_bf16 v[0:3], v[112:115], v[128:131], v[0:3]
  ds_read_b128 v[120:123], v241 offset:32768
  ds_read_b128 v[124:127], v241 offset:34816
  v_mfma_f32_16x16x32_bf16 v[4:7], v[116:119], v[128:131], v[4:7]
  ds_read_b64_tr_b16 v[184:185], v242 offset:28672
  v_mfma_f32_16x16x32_bf16 v[8:11], v[112:115], v[132:135], v[8:11]
  ds_read_b64_tr_b16 v[186:187], v242 offset:31232
  ds_read_b64_tr_b16 v[188:189], v242 offset:28704
  v_mfma_f32_16x16x32_bf16 v[12:15], v[116:119], v[132:135], v[12:15]
  ds_read_b64_tr_b16 v[190:191], v242 offset:31264
  v_mfma_f32_16x16x32_bf16 v[16:19], v[112:115], v[136:139], v[16:19]
  ds_read_b64_tr_b16 v[192:193], v242 offset:28736
  ds_read_b64_tr_b16 v[194:195], v242 offset:31296
  v_mfma_f32_16x16x32_bf16 v[20:23], v[116:119], v[136:139], v[20:23]
  ds_read_b64_tr_b16 v[196:197], v242 offset:28768
  v_mfma_f32_16x16x32_bf16 v[24:27], v[112:115], v[140:143], v[24:27]
  ds_read_b64_tr_b16 v[198:199], v242 offset:31328
  ds_read_b64_tr_b16 v[200:201], v242 offset:28800
  v_mfma_f32_16x16x32_bf16 v[28:31], v[116:119], v[140:143], v[28:31]
  ds_read_b64_tr_b16 v[202:203], v242 offset:31360
  v_mfma_f32_16x16x32_bf16 v[32:35], v[112:115], v[144:147], v[32:35]
  ds_read_b64_tr_b16 v[204:205], v242 offset:33792
  ds_read_b64_tr_b16 v[206:207], v242 offset:36352
  v_mfma_f32_16x16x32_bf16 v[36:39], v[116:119], v[144:147], v[36:39]
  ds_read_b64_tr_b16 v[208:209], v242 offset:33824
  v_mfma_f32_16x16x32_bf16 v[40:43], v[112:115], v[148:151], v[40:43]
  ds_read_b64_tr_b16 v[210:211], v242 offset:36384
  ds_read_b64_tr_b16 v[212:213], v242 offset:33856
  v_mfma_f32_16x16x32_bf16 v[44:47], v[116:119], v[148:151], v[44:47]
  ds_read_b64_tr_b16 v[214:215], v242 offset:36416
  v_mfma_f32_16x16x32_bf16 v[48:51], v[112:115], v[152:155], v[48:51]
  ds_read_b64_tr_b16 v[216:217], v242 offset:33888
  v_mfma_f32_16x16x32_bf16 v[52:55], v[116:119], v[152:155], v[52:55]
  ds_read_b64_tr_b16 v[218:219], v242 offset:36448
  ds_read_b64_tr_b16 v[220:221], v242 offset:33920
  v_mfma_f32_16x16x32_bf16 v[56:59], v[112:115], v[156:159], v[56:59]
  ds_read_b64_tr_b16 v[222:223], v242 offset:36480
  v_mfma_f32_16x16x32_bf16 v[60:63], v[116:119], v[156:159], v[60:63]
  ds_read_b64_tr_b16 v[224:225], v243 offset:28672
  ds_read_b64_tr_b16 v[226:227], v243 offset:30720
  v_mfma_f32_16x16x32_bf16 v[64:67], v[112:115], v[160:163], v[64:67]
  ds_read_b64_tr_b16 v[228:229], v244 offset:28672
  v_mfma_f32_16x16x32_bf16 v[68:71], v[116:119], v[160:163], v[68:71]
  ds_read_b64_tr_b16 v[230:231], v244 offset:30720
  ds_read_b64_tr_b16 v[232:233], v245 offset:28672
  v_mfma_f32_16x16x32_bf16 v[72:75], v[112:115], v[164:167], v[72:75]
  ds_read_b64_tr_b16 v[234:235], v245 offset:30720
  v_mfma_f32_16x16x32_bf16 v[76:79], v[116:119], v[164:167], v[76:79]
  ds_read_b64_tr_b16 v[236:237], v246 offset:28672
  ds_read_b64_tr_b16 v[238:239], v246 offset:30720
  v_mfma_f32_16x16x32_bf16 v[80:83], v[168:171], v[112:115], v[80:83]
  v_subrev_u32 v242, 43008, v242
  v_mfma_f32_16x16x32_bf16 v[84:87], v[168:171], v[116:119], v[84:87]
  v_subrev_u32 v243, 43008, v243
  v_subrev_u32 v244, 43008, v244
  v_mfma_f32_16x16x32_bf16 v[88:91], v[172:175], v[112:115], v[88:91]
  v_subrev_u32 v245, 43008, v245
  v_mfma_f32_16x16x32_bf16 v[92:95], v[172:175], v[116:119], v[92:95]
  v_subrev_u32 v246, 43008, v246
  v_mfma_f32_16x16x32_bf16 v[96:99], v[176:179], v[112:115], v[96:99]
  v_mfma_f32_16x16x32_bf16 v[100:103], v[176:179], v[116:119], v[100:103]
  v_mfma_f32_16x16x32_bf16 v[104:107], v[180:183], v[112:115], v[104:107]
  v_mfma_f32_16x16x32_bf16 v[108:111], v[180:183], v[116:119], v[108:111]
  s_waitcnt lgkmcnt(0)
  s_barrier
  v_mfma_f32_16x16x32_bf16 v[0:3], v[120:123], v[184:187], v[0:3]
  ds_read_b128 v[112:115], v240 offset:0
  ds_read_b128 v[116:119], v240 offset:2048
  v_mfma_f32_16x16x32_bf16 v[4:7], v[124:127], v[184:187], v[4:7]
  ds_read_b64_tr_b16 v[128:129], v242 offset:0
  v_mfma_f32_16x16x32_bf16 v[8:11], v[120:123], v[188:191], v[8:11]
  ds_read_b64_tr_b16 v[130:131], v242 offset:2560
  v_mfma_f32_16x16x32_bf16 v[12:15], v[124:127], v[188:191], v[12:15]
  ds_read_b64_tr_b16 v[132:133], v242 offset:32
  v_mfma_f32_16x16x32_bf16 v[16:19], v[120:123], v[192:195], v[16:19]
  ds_read_b64_tr_b16 v[134:135], v242 offset:2592
  ds_read_b64_tr_b16 v[136:137], v242 offset:64
  v_mfma_f32_16x16x32_bf16 v[20:23], v[124:127], v[192:195], v[20:23]
  ds_read_b64_tr_b16 v[138:139], v242 offset:2624
  v_mfma_f32_16x16x32_bf16 v[24:27], v[120:123], v[196:199], v[24:27]
  ds_read_b64_tr_b16 v[140:141], v242 offset:96
  v_mfma_f32_16x16x32_bf16 v[28:31], v[124:127], v[196:199], v[28:31]
  ds_read_b64_tr_b16 v[142:143], v242 offset:2656
  v_mfma_f32_16x16x32_bf16 v[32:35], v[120:123], v[200:203], v[32:35]
  ds_read_b64_tr_b16 v[144:145], v242 offset:128
  ds_read_b64_tr_b16 v[146:147], v242 offset:2688
  v_mfma_f32_16x16x32_bf16 v[36:39], v[124:127], v[200:203], v[36:39]
  ds_read_b64_tr_b16 v[148:149], v242 offset:5120
  v_mfma_f32_16x16x32_bf16 v[40:43], v[120:123], v[204:207], v[40:43]
  ds_read_b64_tr_b16 v[150:151], v242 offset:7680
  v_mfma_f32_16x16x32_bf16 v[44:47], v[124:127], v[204:207], v[44:47]
  ds_read_b64_tr_b16 v[152:153], v242 offset:5152
  v_mfma_f32_16x16x32_bf16 v[48:51], v[120:123], v[208:211], v[48:51]
  ds_read_b64_tr_b16 v[154:155], v242 offset:7712
  ds_read_b64_tr_b16 v[156:157], v242 offset:5184
  v_mfma_f32_16x16x32_bf16 v[52:55], v[124:127], v[208:211], v[52:55]
  ds_read_b64_tr_b16 v[158:159], v242 offset:7744
  v_mfma_f32_16x16x32_bf16 v[56:59], v[120:123], v[212:215], v[56:59]
  ds_read_b64_tr_b16 v[160:161], v242 offset:5216
  v_mfma_f32_16x16x32_bf16 v[60:63], v[124:127], v[212:215], v[60:63]
  ds_read_b64_tr_b16 v[162:163], v242 offset:7776
  v_mfma_f32_16x16x32_bf16 v[64:67], v[120:123], v[216:219], v[64:67]
  ds_read_b64_tr_b16 v[164:165], v242 offset:5248
  ds_read_b64_tr_b16 v[166:167], v242 offset:7808
  v_mfma_f32_16x16x32_bf16 v[68:71], v[124:127], v[216:219], v[68:71]
  ds_read_b64_tr_b16 v[168:169], v243 offset:0
  v_mfma_f32_16x16x32_bf16 v[72:75], v[120:123], v[220:223], v[72:75]
  ds_read_b64_tr_b16 v[170:171], v243 offset:2048
  v_mfma_f32_16x16x32_bf16 v[76:79], v[124:127], v[220:223], v[76:79]
  ds_read_b64_tr_b16 v[172:173], v244 offset:0
  v_mfma_f32_16x16x32_bf16 v[80:83], v[224:227], v[120:123], v[80:83]
  ds_read_b64_tr_b16 v[174:175], v244 offset:2048
  ds_read_b64_tr_b16 v[176:177], v245 offset:0
  v_mfma_f32_16x16x32_bf16 v[84:87], v[224:227], v[124:127], v[84:87]
  ds_read_b64_tr_b16 v[178:179], v245 offset:2048
  v_mfma_f32_16x16x32_bf16 v[88:91], v[228:231], v[120:123], v[88:91]
  ds_read_b64_tr_b16 v[180:181], v246 offset:0
  v_mfma_f32_16x16x32_bf16 v[92:95], v[228:231], v[124:127], v[92:95]
  ds_read_b64_tr_b16 v[182:183], v246 offset:2048
  v_mfma_f32_16x16x32_bf16 v[96:99], v[232:235], v[120:123], v[96:99]
  v_mfma_f32_16x16x32_bf16 v[100:103], v[232:235], v[124:127], v[100:103]
  v_mfma_f32_16x16x32_bf16 v[104:107], v[236:239], v[120:123], v[104:107]
  v_mfma_f32_16x16x32_bf16 v[108:111], v[236:239], v[124:127], v[108:111]
  s_waitcnt lgkmcnt(0)
  v_mfma_f32_16x16x32_bf16 v[0:3], v[112:115], v[128:131], v[0:3]
  ds_read_b128 v[120:123], v241 offset:0
  ds_read_b128 v[124:127], v241 offset:2048
  v_mfma_f32_16x16x32_bf16 v[4:7], v[116:119], v[128:131], v[4:7]
  ds_read_b64_tr_b16 v[184:185], v242 offset:14336
  v_mfma_f32_16x16x32_bf16 v[8:11], v[112:115], v[132:135], v[8:11]
  ds_read_b64_tr_b16 v[186:187], v242 offset:16896
  v_mfma_f32_16x16x32_bf16 v[12:15], v[116:119], v[132:135], v[12:15]
  ds_read_b64_tr_b16 v[188:189], v242 offset:14368
  v_mfma_f32_16x16x32_bf16 v[16:19], v[112:115], v[136:139], v[16:19]
  ds_read_b64_tr_b16 v[190:191], v242 offset:16928
  ds_read_b64_tr_b16 v[192:193], v242 offset:14400
  v_mfma_f32_16x16x32_bf16 v[20:23], v[116:119], v[136:139], v[20:23]
  ds_read_b64_tr_b16 v[194:195], v242 offset:16960
  v_mfma_f32_16x16x32_bf16 v[24:27], v[112:115], v[140:143], v[24:27]
  ds_read_b64_tr_b16 v[196:197], v242 offset:14432
  v_mfma_f32_16x16x32_bf16 v[28:31], v[116:119], v[140:143], v[28:31]
  ds_read_b64_tr_b16 v[198:199], v242 offset:16992
  v_mfma_f32_16x16x32_bf16 v[32:35], v[112:115], v[144:147], v[32:35]
  ds_read_b64_tr_b16 v[200:201], v242 offset:14464
  ds_read_b64_tr_b16 v[202:203], v242 offset:17024
  v_mfma_f32_16x16x32_bf16 v[36:39], v[116:119], v[144:147], v[36:39]
  ds_read_b64_tr_b16 v[204:205], v242 offset:19456
  v_mfma_f32_16x16x32_bf16 v[40:43], v[112:115], v[148:151], v[40:43]
  ds_read_b64_tr_b16 v[206:207], v242 offset:22016
  v_mfma_f32_16x16x32_bf16 v[44:47], v[116:119], v[148:151], v[44:47]
  ds_read_b64_tr_b16 v[208:209], v242 offset:19488
  v_mfma_f32_16x16x32_bf16 v[48:51], v[112:115], v[152:155], v[48:51]
  ds_read_b64_tr_b16 v[210:211], v242 offset:22048
  ds_read_b64_tr_b16 v[212:213], v242 offset:19520
  v_mfma_f32_16x16x32_bf16 v[52:55], v[116:119], v[152:155], v[52:55]
  ds_read_b64_tr_b16 v[214:215], v242 offset:22080
  v_mfma_f32_16x16x32_bf16 v[56:59], v[112:115], v[156:159], v[56:59]
  ds_read_b64_tr_b16 v[216:217], v242 offset:19552
  v_mfma_f32_16x16x32_bf16 v[60:63], v[116:119], v[156:159], v[60:63]
  ds_read_b64_tr_b16 v[218:219], v242 offset:22112
  v_mfma_f32_16x16x32_bf16 v[64:67], v[112:115], v[160:163], v[64:67]
  ds_read_b64_tr_b16 v[220:221], v242 offset:19584
  ds_read_b64_tr_b16 v[222:223], v242 offset:22144
  v_mfma_f32_16x16x32_bf16 v[68:71], v[116:119], v[160:163], v[68:71]
  ds_read_b64_tr_b16 v[224:225], v243 offset:14336
  v_mfma_f32_16x16x32_bf16 v[72:75], v[112:115], v[164:167], v[72:75]
  ds_read_b64_tr_b16 v[226:227], v243 offset:16384
  v_mfma_f32_16x16x32_bf16 v[76:79], v[116:119], v[164:167], v[76:79]
  ds_read_b64_tr_b16 v[228:229], v244 offset:14336
  v_mfma_f32_16x16x32_bf16 v[80:83], v[168:171], v[112:115], v[80:83]
  ds_read_b64_tr_b16 v[230:231], v244 offset:16384
  ds_read_b64_tr_b16 v[232:233], v245 offset:14336
  v_mfma_f32_16x16x32_bf16 v[84:87], v[168:171], v[116:119], v[84:87]
  ds_read_b64_tr_b16 v[234:235], v245 offset:16384
  v_mfma_f32_16x16x32_bf16 v[88:91], v[172:175], v[112:115], v[88:91]
  ds_read_b64_tr_b16 v[236:237], v246 offset:14336
  v_mfma_f32_16x16x32_bf16 v[92:95], v[172:175], v[116:119], v[92:95]
  ds_read_b64_tr_b16 v[238:239], v246 offset:16384
  v_mfma_f32_16x16x32_bf16 v[96:99], v[176:179], v[112:115], v[96:99]
  v_mfma_f32_16x16x32_bf16 v[100:103], v[176:179], v[116:119], v[100:103]
  v_mfma_f32_16x16x32_bf16 v[104:107], v[180:183], v[112:115], v[104:107]
  v_mfma_f32_16x16x32_bf16 v[108:111], v[180:183], v[116:119], v[108:111]
  s_waitcnt lgkmcnt(0)
  s_barrier
  v_mfma_f32_16x16x32_bf16 v[0:3], v[120:123], v[184:187], v[0:3]
  ds_read_b128 v[112:115], v240 offset:16384
  ds_read_b128 v[116:119], v240 offset:18432
  v_mfma_f32_16x16x32_bf16 v[4:7], v[124:127], v[184:187], v[4:7]
  ds_read_b64_tr_b16 v[128:129], v242 offset:28672
  v_mfma_f32_16x16x32_bf16 v[8:11], v[120:123], v[188:191], v[8:11]
  ds_read_b64_tr_b16 v[130:131], v242 offset:31232
  ds_read_b64_tr_b16 v[132:133], v242 offset:28704
  v_mfma_f32_16x16x32_bf16 v[12:15], v[124:127], v[188:191], v[12:15]
  ds_read_b64_tr_b16 v[134:135], v242 offset:31264
  v_mfma_f32_16x16x32_bf16 v[16:19], v[120:123], v[192:195], v[16:19]
  ds_read_b64_tr_b16 v[136:137], v242 offset:28736
  ds_read_b64_tr_b16 v[138:139], v242 offset:31296
  v_mfma_f32_16x16x32_bf16 v[20:23], v[124:127], v[192:195], v[20:23]
  ds_read_b64_tr_b16 v[140:141], v242 offset:28768
  v_mfma_f32_16x16x32_bf16 v[24:27], v[120:123], v[196:199], v[24:27]
  ds_read_b64_tr_b16 v[142:143], v242 offset:31328
  ds_read_b64_tr_b16 v[144:145], v242 offset:28800
  v_mfma_f32_16x16x32_bf16 v[28:31], v[124:127], v[196:199], v[28:31]
  ds_read_b64_tr_b16 v[146:147], v242 offset:31360
  v_mfma_f32_16x16x32_bf16 v[32:35], v[120:123], v[200:203], v[32:35]
  ds_read_b64_tr_b16 v[148:149], v242 offset:33792
  ds_read_b64_tr_b16 v[150:151], v242 offset:36352
  v_mfma_f32_16x16x32_bf16 v[36:39], v[124:127], v[200:203], v[36:39]
  ds_read_b64_tr_b16 v[152:153], v242 offset:33824
  v_mfma_f32_16x16x32_bf16 v[40:43], v[120:123], v[204:207], v[40:43]
  ds_read_b64_tr_b16 v[154:155], v242 offset:36384
  ds_read_b64_tr_b16 v[156:157], v242 offset:33856
  v_mfma_f32_16x16x32_bf16 v[44:47], v[124:127], v[204:207], v[44:47]
  ds_read_b64_tr_b16 v[158:159], v242 offset:36416
  v_mfma_f32_16x16x32_bf16 v[48:51], v[120:123], v[208:211], v[48:51]
  ds_read_b64_tr_b16 v[160:161], v242 offset:33888
  v_mfma_f32_16x16x32_bf16 v[52:55], v[124:127], v[208:211], v[52:55]
  ds_read_b64_tr_b16 v[162:163], v242 offset:36448
  ds_read_b64_tr_b16 v[164:165], v242 offset:33920
  v_mfma_f32_16x16x32_bf16 v[56:59], v[120:123], v[212:215], v[56:59]
  ds_read_b64_tr_b16 v[166:167], v242 offset:36480
  v_mfma_f32_16x16x32_bf16 v[60:63], v[124:127], v[212:215], v[60:63]
  ds_read_b64_tr_b16 v[168:169], v243 offset:28672
  ds_read_b64_tr_b16 v[170:171], v243 offset:30720
  v_mfma_f32_16x16x32_bf16 v[64:67], v[120:123], v[216:219], v[64:67]
  ds_read_b64_tr_b16 v[172:173], v244 offset:28672
  v_mfma_f32_16x16x32_bf16 v[68:71], v[124:127], v[216:219], v[68:71]
  ds_read_b64_tr_b16 v[174:175], v244 offset:30720
  ds_read_b64_tr_b16 v[176:177], v245 offset:28672
  v_mfma_f32_16x16x32_bf16 v[72:75], v[120:123], v[220:223], v[72:75]
  ds_read_b64_tr_b16 v[178:179], v245 offset:30720
  v_mfma_f32_16x16x32_bf16 v[76:79], v[124:127], v[220:223], v[76:79]
  ds_read_b64_tr_b16 v[180:181], v246 offset:28672
  ds_read_b64_tr_b16 v[182:183], v246 offset:30720
  v_mfma_f32_16x16x32_bf16 v[80:83], v[224:227], v[120:123], v[80:83]
  v_add_u32 v242, 43008, v242
  v_mfma_f32_16x16x32_bf16 v[84:87], v[224:227], v[124:127], v[84:87]
  v_add_u32 v243, 43008, v243
  v_add_u32 v244, 43008, v244
  v_mfma_f32_16x16x32_bf16 v[88:91], v[228:231], v[120:123], v[88:91]
  v_add_u32 v245, 43008, v245
  v_mfma_f32_16x16x32_bf16 v[92:95], v[228:231], v[124:127], v[92:95]
  v_add_u32 v246, 43008, v246
  v_mfma_f32_16x16x32_bf16 v[96:99], v[232:235], v[120:123], v[96:99]
  v_mfma_f32_16x16x32_bf16 v[100:103], v[232:235], v[124:127], v[100:103]
  v_mfma_f32_16x16x32_bf16 v[104:107], v[236:239], v[120:123], v[104:107]
  v_mfma_f32_16x16x32_bf16 v[108:111], v[236:239], v[124:127], v[108:111]
  s_waitcnt lgkmcnt(0)
  v_mfma_f32_16x16x32_bf16 v[0:3], v[112:115], v[128:131], v[0:3]
  ds_read_b128 v[120:123], v241 offset:16384
  ds_read_b128 v[124:127], v241 offset:18432
  v_mfma_f32_16x16x32_bf16 v[4:7], v[116:119], v[128:131], v[4:7]
  ds_read_b64_tr_b16 v[184:185], v242 offset:0
  v_mfma_f32_16x16x32_bf16 v[8:11], v[112:115], v[132:135], v[8:11]
  ds_read_b64_tr_b16 v[186:187], v242 offset:2560
  v_mfma_f32_16x16x32_bf16 v[12:15], v[116:119], v[132:135], v[12:15]
  ds_read_b64_tr_b16 v[188:189], v242 offset:32
  v_mfma_f32_16x16x32_bf16 v[16:19], v[112:115], v[136:139], v[16:19]
  ds_read_b64_tr_b16 v[190:191], v242 offset:2592
  ds_read_b64_tr_b16 v[192:193], v242 offset:64
  v_mfma_f32_16x16x32_bf16 v[20:23], v[116:119], v[136:139], v[20:23]
  ds_read_b64_tr_b16 v[194:195], v242 offset:2624
  v_mfma_f32_16x16x32_bf16 v[24:27], v[112:115], v[140:143], v[24:27]
  ds_read_b64_tr_b16 v[196:197], v242 offset:96
  v_mfma_f32_16x16x32_bf16 v[28:31], v[116:119], v[140:143], v[28:31]
  ds_read_b64_tr_b16 v[198:199], v242 offset:2656
  v_mfma_f32_16x16x32_bf16 v[32:35], v[112:115], v[144:147], v[32:35]
  ds_read_b64_tr_b16 v[200:201], v242 offset:128
  ds_read_b64_tr_b16 v[202:203], v242 offset:2688
  v_mfma_f32_16x16x32_bf16 v[36:39], v[116:119], v[144:147], v[36:39]
  ds_read_b64_tr_b16 v[204:205], v242 offset:5120
  v_mfma_f32_16x16x32_bf16 v[40:43], v[112:115], v[148:151], v[40:43]
  ds_read_b64_tr_b16 v[206:207], v242 offset:7680
  v_mfma_f32_16x16x32_bf16 v[44:47], v[116:119], v[148:151], v[44:47]
  ds_read_b64_tr_b16 v[208:209], v242 offset:5152
  v_mfma_f32_16x16x32_bf16 v[48:51], v[112:115], v[152:155], v[48:51]
  ds_read_b64_tr_b16 v[210:211], v242 offset:7712
  ds_read_b64_tr_b16 v[212:213], v242 offset:5184
  v_mfma_f32_16x16x32_bf16 v[52:55], v[116:119], v[152:155], v[52:55]
  ds_read_b64_tr_b16 v[214:215], v242 offset:7744
  v_mfma_f32_16x16x32_bf16 v[56:59], v[112:115], v[156:159], v[56:59]
  ds_read_b64_tr_b16 v[216:217], v242 offset:5216
  v_mfma_f32_16x16x32_bf16 v[60:63], v[116:119], v[156:159], v[60:63]
  ds_read_b64_tr_b16 v[218:219], v242 offset:7776
  v_mfma_f32_16x16x32_bf16 v[64:67], v[112:115], v[160:163], v[64:67]
  ds_read_b64_tr_b16 v[220:221], v242 offset:5248
  ds_read_b64_tr_b16 v[222:223], v242 offset:7808
  v_mfma_f32_16x16x32_bf16 v[68:71], v[116:119], v[160:163], v[68:71]
  ds_read_b64_tr_b16 v[224:225], v243 offset:0
  v_mfma_f32_16x16x32_bf16 v[72:75], v[112:115], v[164:167], v[72:75]
  ds_read_b64_tr_b16 v[226:227], v243 offset:2048
  v_mfma_f32_16x16x32_bf16 v[76:79], v[116:119], v[164:167], v[76:79]
  ds_read_b64_tr_b16 v[228:229], v244 offset:0
  v_mfma_f32_16x16x32_bf16 v[80:83], v[168:171], v[112:115], v[80:83]
  ds_read_b64_tr_b16 v[230:231], v244 offset:2048
  ds_read_b64_tr_b16 v[232:233], v245 offset:0
  v_mfma_f32_16x16x32_bf16 v[84:87], v[168:171], v[116:119], v[84:87]
  ds_read_b64_tr_b16 v[234:235], v245 offset:2048
  v_mfma_f32_16x16x32_bf16 v[88:91], v[172:175], v[112:115], v[88:91]
  ds_read_b64_tr_b16 v[236:237], v246 offset:0
  v_mfma_f32_16x16x32_bf16 v[92:95], v[172:175], v[116:119], v[92:95]
  ds_read_b64_tr_b16 v[238:239], v246 offset:2048
  v_mfma_f32_16x16x32_bf16 v[96:99], v[176:179], v[112:115], v[96:99]
  v_mfma_f32_16x16x32_bf16 v[100:103], v[176:179], v[116:119], v[100:103]
  v_mfma_f32_16x16x32_bf16 v[104:107], v[180:183], v[112:115], v[104:107]
  v_mfma_f32_16x16x32_bf16 v[108:111], v[180:183], v[116:119], v[108:111]
  s_waitcnt lgkmcnt(0)
  s_barrier
  v_mfma_f32_16x16x32_bf16 v[0:3], v[120:123], v[184:187], v[0:3]
  ds_read_b128 v[112:115], v240 offset:32768
  ds_read_b128 v[116:119], v240 offset:34816
  v_mfma_f32_16x16x32_bf16 v[4:7], v[124:127], v[184:187], v[4:7]
  ds_read_b64_tr_b16 v[128:129], v242 offset:14336
  v_mfma_f32_16x16x32_bf16 v[8:11], v[120:123], v[188:191], v[8:11]
  ds_read_b64_tr_b16 v[130:131], v242 offset:16896
  v_mfma_f32_16x16x32_bf16 v[12:15], v[124:127], v[188:191], v[12:15]
  ds_read_b64_tr_b16 v[132:133], v242 offset:14368
  v_mfma_f32_16x16x32_bf16 v[16:19], v[120:123], v[192:195], v[16:19]
  ds_read_b64_tr_b16 v[134:135], v242 offset:16928
  ds_read_b64_tr_b16 v[136:137], v242 offset:14400
  v_mfma_f32_16x16x32_bf16 v[20:23], v[124:127], v[192:195], v[20:23]
  ds_read_b64_tr_b16 v[138:139], v242 offset:16960
  v_mfma_f32_16x16x32_bf16 v[24:27], v[120:123], v[196:199], v[24:27]
  ds_read_b64_tr_b16 v[140:141], v242 offset:14432
  v_mfma_f32_16x16x32_bf16 v[28:31], v[124:127], v[196:199], v[28:31]
  ds_read_b64_tr_b16 v[142:143], v242 offset:16992
  v_mfma_f32_16x16x32_bf16 v[32:35], v[120:123], v[200:203], v[32:35]
  ds_read_b64_tr_b16 v[144:145], v242 offset:14464
  ds_read_b64_tr_b16 v[146:147], v242 offset:17024
  v_mfma_f32_16x16x32_bf16 v[36:39], v[124:127], v[200:203], v[36:39]
  ds_read_b64_tr_b16 v[148:149], v242 offset:19456
  v_mfma_f32_16x16x32_bf16 v[40:43], v[120:123], v[204:207], v[40:43]
  ds_read_b64_tr_b16 v[150:151], v242 offset:22016
  v_mfma_f32_16x16x32_bf16 v[44:47], v[124:127], v[204:207], v[44:47]
  ds_read_b64_tr_b16 v[152:153], v242 offset:19488
  v_mfma_f32_16x16x32_bf16 v[48:51], v[120:123], v[208:211], v[48:51]
  ds_read_b64_tr_b16 v[154:155], v242 offset:22048
  ds_read_b64_tr_b16 v[156:157], v242 offset:19520
  v_mfma_f32_16x16x32_bf16 v[52:55], v[124:127], v[208:211], v[52:55]
  ds_read_b64_tr_b16 v[158:159], v242 offset:22080
  v_mfma_f32_16x16x32_bf16 v[56:59], v[120:123], v[212:215], v[56:59]
  ds_read_b64_tr_b16 v[160:161], v242 offset:19552
  v_mfma_f32_16x16x32_bf16 v[60:63], v[124:127], v[212:215], v[60:63]
  ds_read_b64_tr_b16 v[162:163], v242 offset:22112
  v_mfma_f32_16x16x32_bf16 v[64:67], v[120:123], v[216:219], v[64:67]
  ds_read_b64_tr_b16 v[164:165], v242 offset:19584
  ds_read_b64_tr_b16 v[166:167], v242 offset:22144
  v_mfma_f32_16x16x32_bf16 v[68:71], v[124:127], v[216:219], v[68:71]
  ds_read_b64_tr_b16 v[168:169], v243 offset:14336
  v_mfma_f32_16x16x32_bf16 v[72:75], v[120:123], v[220:223], v[72:75]
  ds_read_b64_tr_b16 v[170:171], v243 offset:16384
  v_mfma_f32_16x16x32_bf16 v[76:79], v[124:127], v[220:223], v[76:79]
  ds_read_b64_tr_b16 v[172:173], v244 offset:14336
  v_mfma_f32_16x16x32_bf16 v[80:83], v[224:227], v[120:123], v[80:83]
  ds_read_b64_tr_b16 v[174:175], v244 offset:16384
  ds_read_b64_tr_b16 v[176:177], v245 offset:14336
  v_mfma_f32_16x16x32_bf16 v[84:87], v[224:227], v[124:127], v[84:87]
  ds_read_b64_tr_b16 v[178:179], v245 offset:16384
  v_mfma_f32_16x16x32_bf16 v[88:91], v[228:231], v[120:123], v[88:91]
  ds_read_b64_tr_b16 v[180:181], v246 offset:14336
  v_mfma_f32_16x16x32_bf16 v[92:95], v[228:231], v[124:127], v[92:95]
  ds_read_b64_tr_b16 v[182:183], v246 offset:16384
  v_mfma_f32_16x16x32_bf16 v[96:99], v[232:235], v[120:123], v[96:99]
  v_mfma_f32_16x16x32_bf16 v[100:103], v[232:235], v[124:127], v[100:103]
  v_mfma_f32_16x16x32_bf16 v[104:107], v[236:239], v[120:123], v[104:107]
  v_mfma_f32_16x16x32_bf16 v[108:111], v[236:239], v[124:127], v[108:111]
  s_waitcnt lgkmcnt(0)
  v_mfma_f32_16x16x32_bf16 v[0:3], v[112:115], v[128:131], v[0:3]
  ds_read_b128 v[120:123], v241 offset:32768
  ds_read_b128 v[124:127], v241 offset:34816
  v_mfma_f32_16x16x32_bf16 v[4:7], v[116:119], v[128:131], v[4:7]
  ds_read_b64_tr_b16 v[184:185], v242 offset:28672
  v_mfma_f32_16x16x32_bf16 v[8:11], v[112:115], v[132:135], v[8:11]
  ds_read_b64_tr_b16 v[186:187], v242 offset:31232
  ds_read_b64_tr_b16 v[188:189], v242 offset:28704
  v_mfma_f32_16x16x32_bf16 v[12:15], v[116:119], v[132:135], v[12:15]
  ds_read_b64_tr_b16 v[190:191], v242 offset:31264
  v_mfma_f32_16x16x32_bf16 v[16:19], v[112:115], v[136:139], v[16:19]
  ds_read_b64_tr_b16 v[192:193], v242 offset:28736
  ds_read_b64_tr_b16 v[194:195], v242 offset:31296
  v_mfma_f32_16x16x32_bf16 v[20:23], v[116:119], v[136:139], v[20:23]
  ds_read_b64_tr_b16 v[196:197], v242 offset:28768
  v_mfma_f32_16x16x32_bf16 v[24:27], v[112:115], v[140:143], v[24:27]
  ds_read_b64_tr_b16 v[198:199], v242 offset:31328
  ds_read_b64_tr_b16 v[200:201], v242 offset:28800
  v_mfma_f32_16x16x32_bf16 v[28:31], v[116:119], v[140:143], v[28:31]
  ds_read_b64_tr_b16 v[202:203], v242 offset:31360
  v_mfma_f32_16x16x32_bf16 v[32:35], v[112:115], v[144:147], v[32:35]
  ds_read_b64_tr_b16 v[204:205], v242 offset:33792
  ds_read_b64_tr_b16 v[206:207], v242 offset:36352
  v_mfma_f32_16x16x32_bf16 v[36:39], v[116:119], v[144:147], v[36:39]
  ds_read_b64_tr_b16 v[208:209], v242 offset:33824
  v_mfma_f32_16x16x32_bf16 v[40:43], v[112:115], v[148:151], v[40:43]
  ds_read_b64_tr_b16 v[210:211], v242 offset:36384
  ds_read_b64_tr_b16 v[212:213], v242 offset:33856
  v_mfma_f32_16x16x32_bf16 v[44:47], v[116:119], v[148:151], v[44:47]
  ds_read_b64_tr_b16 v[214:215], v242 offset:36416
  v_mfma_f32_16x16x32_bf16 v[48:51], v[112:115], v[152:155], v[48:51]
  ds_read_b64_tr_b16 v[216:217], v242 offset:33888
  v_mfma_f32_16x16x32_bf16 v[52:55], v[116:119], v[152:155], v[52:55]
  ds_read_b64_tr_b16 v[218:219], v242 offset:36448
  ds_read_b64_tr_b16 v[220:221], v242 offset:33920
  v_mfma_f32_16x16x32_bf16 v[56:59], v[112:115], v[156:159], v[56:59]
  ds_read_b64_tr_b16 v[222:223], v242 offset:36480
  v_mfma_f32_16x16x32_bf16 v[60:63], v[116:119], v[156:159], v[60:63]
  ds_read_b64_tr_b16 v[224:225], v243 offset:28672
  ds_read_b64_tr_b16 v[226:227], v243 offset:30720
  v_mfma_f32_16x16x32_bf16 v[64:67], v[112:115], v[160:163], v[64:67]
  ds_read_b64_tr_b16 v[228:229], v244 offset:28672
  v_mfma_f32_16x16x32_bf16 v[68:71], v[116:119], v[160:163], v[68:71]
  ds_read_b64_tr_b16 v[230:231], v244 offset:30720
  ds_read_b64_tr_b16 v[232:233], v245 offset:28672
  v_mfma_f32_16x16x32_bf16 v[72:75], v[112:115], v[164:167], v[72:75]
  ds_read_b64_tr_b16 v[234:235], v245 offset:30720
  v_mfma_f32_16x16x32_bf16 v[76:79], v[116:119], v[164:167], v[76:79]
  ds_read_b64_tr_b16 v[236:237], v246 offset:28672
  ds_read_b64_tr_b16 v[238:239], v246 offset:30720
  v_mfma_f32_16x16x32_bf16 v[80:83], v[168:171], v[112:115], v[80:83]
  v_subrev_u32 v242, 43008, v242
  v_mfma_f32_16x16x32_bf16 v[84:87], v[168:171], v[116:119], v[84:87]
  v_subrev_u32 v243, 43008, v243
  v_subrev_u32 v244, 43008, v244
  v_mfma_f32_16x16x32_bf16 v[88:91], v[172:175], v[112:115], v[88:91]
  v_subrev_u32 v245, 43008, v245
  v_mfma_f32_16x16x32_bf16 v[92:95], v[172:175], v[116:119], v[92:95]
  v_subrev_u32 v246, 43008, v246
  v_mfma_f32_16x16x32_bf16 v[96:99], v[176:179], v[112:115], v[96:99]
  v_mfma_f32_16x16x32_bf16 v[100:103], v[176:179], v[116:119], v[100:103]
  v_mfma_f32_16x16x32_bf16 v[104:107], v[180:183], v[112:115], v[104:107]
  v_mfma_f32_16x16x32_bf16 v[108:111], v[180:183], v[116:119], v[108:111]
  s_waitcnt lgkmcnt(0)
  s_barrier
  v_mfma_f32_16x16x32_bf16 v[0:3], v[120:123], v[184:187], v[0:3]
  ds_read_b128 v[112:115], v240 offset:0
  ds_read_b128 v[116:119], v240 offset:2048
  v_mfma_f32_16x16x32_bf16 v[4:7], v[124:127], v[184:187], v[4:7]
  ds_read_b64_tr_b16 v[128:129], v242 offset:0
  v_mfma_f32_16x16x32_bf16 v[8:11], v[120:123], v[188:191], v[8:11]
  ds_read_b64_tr_b16 v[130:131], v242 offset:2560
  v_mfma_f32_16x16x32_bf16 v[12:15], v[124:127], v[188:191], v[12:15]
  ds_read_b64_tr_b16 v[132:133], v242 offset:32
  v_mfma_f32_16x16x32_bf16 v[16:19], v[120:123], v[192:195], v[16:19]
  ds_read_b64_tr_b16 v[134:135], v242 offset:2592
  ds_read_b64_tr_b16 v[136:137], v242 offset:64
  v_mfma_f32_16x16x32_bf16 v[20:23], v[124:127], v[192:195], v[20:23]
  ds_read_b64_tr_b16 v[138:139], v242 offset:2624
  v_mfma_f32_16x16x32_bf16 v[24:27], v[120:123], v[196:199], v[24:27]
  ds_read_b64_tr_b16 v[140:141], v242 offset:96
  v_mfma_f32_16x16x32_bf16 v[28:31], v[124:127], v[196:199], v[28:31]
  ds_read_b64_tr_b16 v[142:143], v242 offset:2656
  v_mfma_f32_16x16x32_bf16 v[32:35], v[120:123], v[200:203], v[32:35]
  ds_read_b64_tr_b16 v[144:145], v242 offset:128
  ds_read_b64_tr_b16 v[146:147], v242 offset:2688
  v_mfma_f32_16x16x32_bf16 v[36:39], v[124:127], v[200:203], v[36:39]
  ds_read_b64_tr_b16 v[148:149], v242 offset:5120
  v_mfma_f32_16x16x32_bf16 v[40:43], v[120:123], v[204:207], v[40:43]
  ds_read_b64_tr_b16 v[150:151], v242 offset:7680
  v_mfma_f32_16x16x32_bf16 v[44:47], v[124:127], v[204:207], v[44:47]
  ds_read_b64_tr_b16 v[152:153], v242 offset:5152
  v_mfma_f32_16x16x32_bf16 v[48:51], v[120:123], v[208:211], v[48:51]
  ds_read_b64_tr_b16 v[154:155], v242 offset:7712
  ds_read_b64_tr_b16 v[156:157], v242 offset:5184
  v_mfma_f32_16x16x32_bf16 v[52:55], v[124:127], v[208:211], v[52:55]
  ds_read_b64_tr_b16 v[158:159], v242 offset:7744
  v_mfma_f32_16x16x32_bf16 v[56:59], v[120:123], v[212:215], v[56:59]
  ds_read_b64_tr_b16 v[160:161], v242 offset:5216
  v_mfma_f32_16x16x32_bf16 v[60:63], v[124:127], v[212:215], v[60:63]
  ds_read_b64_tr_b16 v[162:163], v242 offset:7776
  v_mfma_f32_16x16x32_bf16 v[64:67], v[120:123], v[216:219], v[64:67]
  ds_read_b64_tr_b16 v[164:165], v242 offset:5248
  ds_read_b64_tr_b16 v[166:167], v242 offset:7808
  v_mfma_f32_16x16x32_bf16 v[68:71], v[124:127], v[216:219], v[68:71]
  ds_read_b64_tr_b16 v[168:169], v243 offset:0
  v_mfma_f32_16x16x32_bf16 v[72:75], v[120:123], v[220:223], v[72:75]
  ds_read_b64_tr_b16 v[170:171], v243 offset:2048
  v_mfma_f32_16x16x32_bf16 v[76:79], v[124:127], v[220:223], v[76:79]
  ds_read_b64_tr_b16 v[172:173], v244 offset:0
  v_mfma_f32_16x16x32_bf16 v[80:83], v[224:227], v[120:123], v[80:83]
  ds_read_b64_tr_b16 v[174:175], v244 offset:2048
  ds_read_b64_tr_b16 v[176:177], v245 offset:0
  v_mfma_f32_16x16x32_bf16 v[84:87], v[224:227], v[124:127], v[84:87]
  ds_read_b64_tr_b16 v[178:179], v245 offset:2048
  v_mfma_f32_16x16x32_bf16 v[88:91], v[228:231], v[120:123], v[88:91]
  ds_read_b64_tr_b16 v[180:181], v246 offset:0
  v_mfma_f32_16x16x32_bf16 v[92:95], v[228:231], v[124:127], v[92:95]
  ds_read_b64_tr_b16 v[182:183], v246 offset:2048
  v_mfma_f32_16x16x32_bf16 v[96:99], v[232:235], v[120:123], v[96:99]
  v_mfma_f32_16x16x32_bf16 v[100:103], v[232:235], v[124:127], v[100:103]
  v_mfma_f32_16x16x32_bf16 v[104:107], v[236:239], v[120:123], v[104:107]
  v_mfma_f32_16x16x32_bf16 v[108:111], v[236:239], v[124:127], v[108:111]
  s_waitcnt lgkmcnt(0)
  v_mfma_f32_16x16x32_bf16 v[0:3], v[112:115], v[128:131], v[0:3]
  ds_read_b128 v[120:123], v241 offset:0
  ds_read_b128 v[124:127], v241 offset:2048
  v_mfma_f32_16x16x32_bf16 v[4:7], v[116:119], v[128:131], v[4:7]
  ds_read_b64_tr_b16 v[184:185], v242 offset:14336
  v_mfma_f32_16x16x32_bf16 v[8:11], v[112:115], v[132:135], v[8:11]
  ds_read_b64_tr_b16 v[186:187], v242 offset:16896
  v_mfma_f32_16x16x32_bf16 v[12:15], v[116:119], v[132:135], v[12:15]
  ds_read_b64_tr_b16 v[188:189], v242 offset:14368
  v_mfma_f32_16x16x32_bf16 v[16:19], v[112:115], v[136:139], v[16:19]
  ds_read_b64_tr_b16 v[190:191], v242 offset:16928
  ds_read_b64_tr_b16 v[192:193], v242 offset:14400
  v_mfma_f32_16x16x32_bf16 v[20:23], v[116:119], v[136:139], v[20:23]
  ds_read_b64_tr_b16 v[194:195], v242 offset:16960
  v_mfma_f32_16x16x32_bf16 v[24:27], v[112:115], v[140:143], v[24:27]
  ds_read_b64_tr_b16 v[196:197], v242 offset:14432
  v_mfma_f32_16x16x32_bf16 v[28:31], v[116:119], v[140:143], v[28:31]
  ds_read_b64_tr_b16 v[198:199], v242 offset:16992
  v_mfma_f32_16x16x32_bf16 v[32:35], v[112:115], v[144:147], v[32:35]
  ds_read_b64_tr_b16 v[200:201], v242 offset:14464
  ds_read_b64_tr_b16 v[202:203], v242 offset:17024
  v_mfma_f32_16x16x32_bf16 v[36:39], v[116:119], v[144:147], v[36:39]
  ds_read_b64_tr_b16 v[204:205], v242 offset:19456
  v_mfma_f32_16x16x32_bf16 v[40:43], v[112:115], v[148:151], v[40:43]
  ds_read_b64_tr_b16 v[206:207], v242 offset:22016
  v_mfma_f32_16x16x32_bf16 v[44:47], v[116:119], v[148:151], v[44:47]
  ds_read_b64_tr_b16 v[208:209], v242 offset:19488
  v_mfma_f32_16x16x32_bf16 v[48:51], v[112:115], v[152:155], v[48:51]
  ds_read_b64_tr_b16 v[210:211], v242 offset:22048
  ds_read_b64_tr_b16 v[212:213], v242 offset:19520
  v_mfma_f32_16x16x32_bf16 v[52:55], v[116:119], v[152:155], v[52:55]
  ds_read_b64_tr_b16 v[214:215], v242 offset:22080
  v_mfma_f32_16x16x32_bf16 v[56:59], v[112:115], v[156:159], v[56:59]
  ds_read_b64_tr_b16 v[216:217], v242 offset:19552
  v_mfma_f32_16x16x32_bf16 v[60:63], v[116:119], v[156:159], v[60:63]
  ds_read_b64_tr_b16 v[218:219], v242 offset:22112
  v_mfma_f32_16x16x32_bf16 v[64:67], v[112:115], v[160:163], v[64:67]
  ds_read_b64_tr_b16 v[220:221], v242 offset:19584
  ds_read_b64_tr_b16 v[222:223], v242 offset:22144
  v_mfma_f32_16x16x32_bf16 v[68:71], v[116:119], v[160:163], v[68:71]
  ds_read_b64_tr_b16 v[224:225], v243 offset:14336
  v_mfma_f32_16x16x32_bf16 v[72:75], v[112:115], v[164:167], v[72:75]
  ds_read_b64_tr_b16 v[226:227], v243 offset:16384
  v_mfma_f32_16x16x32_bf16 v[76:79], v[116:119], v[164:167], v[76:79]
  ds_read_b64_tr_b16 v[228:229], v244 offset:14336
  v_mfma_f32_16x16x32_bf16 v[80:83], v[168:171], v[112:115], v[80:83]
  ds_read_b64_tr_b16 v[230:231], v244 offset:16384
  ds_read_b64_tr_b16 v[232:233], v245 offset:14336
  v_mfma_f32_16x16x32_bf16 v[84:87], v[168:171], v[116:119], v[84:87]
  ds_read_b64_tr_b16 v[234:235], v245 offset:16384
  v_mfma_f32_16x16x32_bf16 v[88:91], v[172:175], v[112:115], v[88:91]
  ds_read_b64_tr_b16 v[236:237], v246 offset:14336
  v_mfma_f32_16x16x32_bf16 v[92:95], v[172:175], v[116:119], v[92:95]
  ds_read_b64_tr_b16 v[238:239], v246 offset:16384
  v_mfma_f32_16x16x32_bf16 v[96:99], v[176:179], v[112:115], v[96:99]
  v_mfma_f32_16x16x32_bf16 v[100:103], v[176:179], v[116:119], v[100:103]
  v_mfma_f32_16x16x32_bf16 v[104:107], v[180:183], v[112:115], v[104:107]
  v_mfma_f32_16x16x32_bf16 v[108:111], v[180:183], v[116:119], v[108:111]
  s_waitcnt lgkmcnt(0)
  v_mfma_f32_16x16x32_bf16 v[40:43], v[120:123], v[204:207], v[40:43]
  v_mfma_f32_16x16x32_bf16 v[44:47], v[124:127], v[204:207], v[44:47]
  v_mfma_f32_16x16x32_bf16 v[48:51], v[120:123], v[208:211], v[48:51]
  v_mfma_f32_16x16x32_bf16 v[52:55], v[124:127], v[208:211], v[52:55]
  v_mfma_f32_16x16x32_bf16 v[56:59], v[120:123], v[212:215], v[56:59]
  v_mfma_f32_16x16x32_bf16 v[60:63], v[124:127], v[212:215], v[60:63]
  v_mfma_f32_16x16x32_bf16 v[64:67], v[120:123], v[216:219], v[64:67]
  v_mfma_f32_16x16x32_bf16 v[68:71], v[124:127], v[216:219], v[68:71]
  v_mfma_f32_16x16x32_bf16 v[72:75], v[120:123], v[220:223], v[72:75]
  v_mfma_f32_16x16x32_bf16 v[76:79], v[124:127], v[220:223], v[76:79]
  v_mfma_f32_16x16x32_bf16 v[0:3], v[120:123], v[184:187], v[0:3]
  v_mfma_f32_16x16x32_bf16 v[4:7], v[124:127], v[184:187], v[4:7]
  v_mfma_f32_16x16x32_bf16 v[8:11], v[120:123], v[188:191], v[8:11]
  v_mfma_f32_16x16x32_bf16 v[12:15], v[124:127], v[188:191], v[12:15]
  s_barrier
  v_mfma_f32_16x16x32_bf16 v[16:19], v[120:123], v[192:195], v[16:19]
  v_mfma_f32_16x16x32_bf16 v[20:23], v[124:127], v[192:195], v[20:23]
  v_mfma_f32_16x16x32_bf16 v[24:27], v[120:123], v[196:199], v[24:27]
  v_mfma_f32_16x16x32_bf16 v[28:31], v[124:127], v[196:199], v[28:31]
  v_mfma_f32_16x16x32_bf16 v[32:35], v[120:123], v[200:203], v[32:35]
  v_mfma_f32_16x16x32_bf16 v[36:39], v[124:127], v[200:203], v[36:39]
  v_mfma_f32_16x16x32_bf16 v[80:83], v[224:227], v[120:123], v[80:83]
  v_mfma_f32_16x16x32_bf16 v[84:87], v[224:227], v[124:127], v[84:87]
  v_mfma_f32_16x16x32_bf16 v[88:91], v[228:231], v[120:123], v[88:91]
  v_mfma_f32_16x16x32_bf16 v[92:95], v[228:231], v[124:127], v[92:95]
  v_mfma_f32_16x16x32_bf16 v[96:99], v[232:235], v[120:123], v[96:99]
  v_mfma_f32_16x16x32_bf16 v[100:103], v[232:235], v[124:127], v[100:103]
  v_mfma_f32_16x16x32_bf16 v[104:107], v[236:239], v[120:123], v[104:107]
  v_mfma_f32_16x16x32_bf16 v[108:111], v[236:239], v[124:127], v[108:111]
  s_mul_i32 s60, s26, 10240
  v_add_u32 v240, s60, v247
  v_cvt_pk_bf16_f32 v40, v40, v41
  v_cvt_pk_bf16_f32 v41, v42, v43
  v_cvt_pk_bf16_f32 v42, v44, v45
  v_cvt_pk_bf16_f32 v43, v46, v47
  ds_write_b128 v240, v[40:43] offset:5120
  v_cvt_pk_bf16_f32 v48, v48, v49
  v_cvt_pk_bf16_f32 v49, v50, v51
  v_cvt_pk_bf16_f32 v50, v52, v53
  v_cvt_pk_bf16_f32 v51, v54, v55
  ds_write_b128 v240, v[48:51] offset:6144
  v_cvt_pk_bf16_f32 v56, v56, v57
  v_cvt_pk_bf16_f32 v57, v58, v59
  v_cvt_pk_bf16_f32 v58, v60, v61
  v_cvt_pk_bf16_f32 v59, v62, v63
  ds_write_b128 v240, v[56:59] offset:7168
  v_cvt_pk_bf16_f32 v64, v64, v65
  v_cvt_pk_bf16_f32 v65, v66, v67
  v_cvt_pk_bf16_f32 v66, v68, v69
  v_cvt_pk_bf16_f32 v67, v70, v71
  ds_write_b128 v240, v[64:67] offset:8192
  v_cvt_pk_bf16_f32 v72, v72, v73
  v_cvt_pk_bf16_f32 v73, v74, v75
  v_cvt_pk_bf16_f32 v74, v76, v77
  v_cvt_pk_bf16_f32 v75, v78, v79
  ds_write_b128 v240, v[72:75] offset:9216
  v_pk_mul_f32 v[112:113], v[0:1], s[96:97]
  v_pk_mul_f32 v[114:115], v[2:3], s[96:97]
  v_exp_f32 v112, v112 clamp
  v_exp_f32 v113, v113 clamp
  v_exp_f32 v114, v114 clamp
  v_exp_f32 v115, v115 clamp
  v_pk_add_f32 v[0:1], v[0:1], s[98:99]
  v_pk_add_f32 v[2:3], v[2:3], s[98:99]
  v_pk_add_f32 v[112:113], v[112:113], s[100:101]
  v_pk_add_f32 v[114:115], v[114:115], s[100:101]
  v_max_f32 v112, v112, v0
  v_max_f32 v113, v113, v1
  v_max_f32 v114, v114, v2
  v_max_f32 v115, v115, v3
  v_cvt_pk_bf16_f32 v0, v112, v113
  v_cvt_pk_bf16_f32 v1, v114, v115
  v_pk_mul_f32 v[116:117], v[4:5], s[96:97]
  v_pk_mul_f32 v[118:119], v[6:7], s[96:97]
  v_exp_f32 v116, v116 clamp
  v_exp_f32 v117, v117 clamp
  v_exp_f32 v118, v118 clamp
  v_exp_f32 v119, v119 clamp
  v_pk_add_f32 v[4:5], v[4:5], s[98:99]
  v_pk_add_f32 v[6:7], v[6:7], s[98:99]
  v_pk_add_f32 v[116:117], v[116:117], s[100:101]
  v_pk_add_f32 v[118:119], v[118:119], s[100:101]
  v_max_f32 v116, v116, v4
  v_max_f32 v117, v117, v5
  v_max_f32 v118, v118, v6
  v_max_f32 v119, v119, v7
  v_cvt_pk_bf16_f32 v2, v116, v117
  v_cvt_pk_bf16_f32 v3, v118, v119
  ds_write_b128 v240, v[0:3] offset:0
  v_pk_mul_f32 v[112:113], v[8:9], s[96:97]
  v_pk_mul_f32 v[114:115], v[10:11], s[96:97]
  v_exp_f32 v112, v112 clamp
  v_exp_f32 v113, v113 clamp
  v_exp_f32 v114, v114 clamp
  v_exp_f32 v115, v115 clamp
  v_pk_add_f32 v[8:9], v[8:9], s[98:99]
  v_pk_add_f32 v[10:11], v[10:11], s[98:99]
  v_pk_add_f32 v[112:113], v[112:113], s[100:101]
  v_pk_add_f32 v[114:115], v[114:115], s[100:101]
  v_max_f32 v112, v112, v8
  v_max_f32 v113, v113, v9
  v_max_f32 v114, v114, v10
  v_max_f32 v115, v115, v11
  v_cvt_pk_bf16_f32 v8, v112, v113
  v_cvt_pk_bf16_f32 v9, v114, v115
  v_pk_mul_f32 v[116:117], v[12:13], s[96:97]
  v_pk_mul_f32 v[118:119], v[14:15], s[96:97]
  v_exp_f32 v116, v116 clamp
  v_exp_f32 v117, v117 clamp
  v_exp_f32 v118, v118 clamp
  v_exp_f32 v119, v119 clamp
  v_pk_add_f32 v[12:13], v[12:13], s[98:99]
  v_pk_add_f32 v[14:15], v[14:15], s[98:99]
  v_pk_add_f32 v[116:117], v[116:117], s[100:101]
  v_pk_add_f32 v[118:119], v[118:119], s[100:101]
  v_max_f32 v116, v116, v12
  v_max_f32 v117, v117, v13
  v_max_f32 v118, v118, v14
  v_max_f32 v119, v119, v15
  v_cvt_pk_bf16_f32 v10, v116, v117
  v_cvt_pk_bf16_f32 v11, v118, v119
  ds_write_b128 v240, v[8:11] offset:1024
  v_pk_mul_f32 v[112:113], v[16:17], s[96:97]
  v_pk_mul_f32 v[114:115], v[18:19], s[96:97]
  v_exp_f32 v112, v112 clamp
  v_exp_f32 v113, v113 clamp
  v_exp_f32 v114, v114 clamp
  v_exp_f32 v115, v115 clamp
  v_pk_add_f32 v[16:17], v[16:17], s[98:99]
  v_pk_add_f32 v[18:19], v[18:19], s[98:99]
  v_pk_add_f32 v[112:113], v[112:113], s[100:101]
  v_pk_add_f32 v[114:115], v[114:115], s[100:101]
  v_max_f32 v112, v112, v16
  v_max_f32 v113, v113, v17
  v_max_f32 v114, v114, v18
  v_max_f32 v115, v115, v19
  v_cvt_pk_bf16_f32 v16, v112, v113
  v_cvt_pk_bf16_f32 v17, v114, v115
  v_pk_mul_f32 v[116:117], v[20:21], s[96:97]
  v_pk_mul_f32 v[118:119], v[22:23], s[96:97]
  v_exp_f32 v116, v116 clamp
  v_exp_f32 v117, v117 clamp
  v_exp_f32 v118, v118 clamp
  v_exp_f32 v119, v119 clamp
  v_pk_add_f32 v[20:21], v[20:21], s[98:99]
  v_pk_add_f32 v[22:23], v[22:23], s[98:99]
  v_pk_add_f32 v[116:117], v[116:117], s[100:101]
  v_pk_add_f32 v[118:119], v[118:119], s[100:101]
  v_max_f32 v116, v116, v20
  v_max_f32 v117, v117, v21
  v_max_f32 v118, v118, v22
  v_max_f32 v119, v119, v23
  v_cvt_pk_bf16_f32 v18, v116, v117
  v_cvt_pk_bf16_f32 v19, v118, v119
  ds_write_b128 v240, v[16:19] offset:2048
  v_pk_mul_f32 v[112:113], v[24:25], s[96:97]
  v_pk_mul_f32 v[114:115], v[26:27], s[96:97]
  v_exp_f32 v112, v112 clamp
  v_exp_f32 v113, v113 clamp
  v_exp_f32 v114, v114 clamp
  v_exp_f32 v115, v115 clamp
  v_pk_add_f32 v[24:25], v[24:25], s[98:99]
  v_pk_add_f32 v[26:27], v[26:27], s[98:99]
  v_pk_add_f32 v[112:113], v[112:113], s[100:101]
  v_pk_add_f32 v[114:115], v[114:115], s[100:101]
  v_max_f32 v112, v112, v24
  v_max_f32 v113, v113, v25
  v_max_f32 v114, v114, v26
  v_max_f32 v115, v115, v27
  v_cvt_pk_bf16_f32 v24, v112, v113
  v_cvt_pk_bf16_f32 v25, v114, v115
  v_pk_mul_f32 v[116:117], v[28:29], s[96:97]
  v_pk_mul_f32 v[118:119], v[30:31], s[96:97]
  v_exp_f32 v116, v116 clamp
  v_exp_f32 v117, v117 clamp
  v_exp_f32 v118, v118 clamp
  v_exp_f32 v119, v119 clamp
  v_pk_add_f32 v[28:29], v[28:29], s[98:99]
  v_pk_add_f32 v[30:31], v[30:31], s[98:99]
  v_pk_add_f32 v[116:117], v[116:117], s[100:101]
  v_pk_add_f32 v[118:119], v[118:119], s[100:101]
  v_max_f32 v116, v116, v28
  v_max_f32 v117, v117, v29
  v_max_f32 v118, v118, v30
  v_max_f32 v119, v119, v31
  v_cvt_pk_bf16_f32 v26, v116, v117
  v_cvt_pk_bf16_f32 v27, v118, v119
  ds_write_b128 v240, v[24:27] offset:3072
  v_pk_mul_f32 v[112:113], v[32:33], s[96:97]
  v_pk_mul_f32 v[114:115], v[34:35], s[96:97]
  v_exp_f32 v112, v112 clamp
  v_exp_f32 v113, v113 clamp
  v_exp_f32 v114, v114 clamp
  v_exp_f32 v115, v115 clamp
  v_pk_add_f32 v[32:33], v[32:33], s[98:99]
  v_pk_add_f32 v[34:35], v[34:35], s[98:99]
  v_pk_add_f32 v[112:113], v[112:113], s[100:101]
  v_pk_add_f32 v[114:115], v[114:115], s[100:101]
  v_max_f32 v112, v112, v32
  v_max_f32 v113, v113, v33
  v_max_f32 v114, v114, v34
  v_max_f32 v115, v115, v35
  v_cvt_pk_bf16_f32 v32, v112, v113
  v_cvt_pk_bf16_f32 v33, v114, v115
  v_pk_mul_f32 v[116:117], v[36:37], s[96:97]
  v_pk_mul_f32 v[118:119], v[38:39], s[96:97]
  v_exp_f32 v116, v116 clamp
  v_exp_f32 v117, v117 clamp
  v_exp_f32 v118, v118 clamp
  v_exp_f32 v119, v119 clamp
  v_pk_add_f32 v[36:37], v[36:37], s[98:99]
  v_pk_add_f32 v[38:39], v[38:39], s[98:99]
  v_pk_add_f32 v[116:117], v[116:117], s[100:101]
  v_pk_add_f32 v[118:119], v[118:119], s[100:101]
  v_max_f32 v116, v116, v36
  v_max_f32 v117, v117, v37
  v_max_f32 v118, v118, v38
  v_max_f32 v119, v119, v39
  v_cvt_pk_bf16_f32 v34, v116, v117
  v_cvt_pk_bf16_f32 v35, v118, v119
  ds_write_b128 v240, v[32:35] offset:4096
  s_lshl_b32 s60, s26, 10
  v_add_u32 v240, s60, v247
  v_mov_b32 v192, 0x3f803f80
  v_mov_b32 v193, 0x3f803f80
  v_mov_b32 v194, 0x3f803f80
  v_mov_b32 v195, 0x3f803f80
  v_mov_b32 v242, 42992
  v_mov_b32 v243, 1
  s_mov_b32 s60, 0
  s_waitcnt lgkmcnt(0)
  s_mov_b64 exec, 1
  ds_add_u32 v242, v243
  s_mov_b64 exec, -1
L_k1_39:
  ds_read_b32 v243, v242
  s_add_u32 s60, s60, 1
  s_waitcnt lgkmcnt(0)
  v_readfirstlane_b32 s61, v243
  s_cmp_ge_u32 s60, 1048576
  s_cbranch_scc1 L_k1d_40
  s_cmp_lt_u32 s61, 4
  s_cbranch_scc1 L_k1_39
L_k1d_40:
  ds_read_b128 v[128:131], v240 offset:0
  ds_read_b128 v[132:135], v240 offset:1024
  ds_read_b128 v[136:139], v240 offset:5120
  ds_read_b128 v[140:143], v240 offset:6144
  ds_read_b128 v[144:147], v240 offset:10240
  ds_read_b128 v[148:151], v240 offset:11264
  ds_read_b128 v[152:155], v240 offset:15360
  ds_read_b128 v[156:159], v240 offset:16384
  ds_read_b128 v[160:163], v240 offset:20480
  ds_read_b128 v[164:167], v240 offset:21504
  ds_read_b128 v[168:171], v240 offset:25600
  ds_read_b128 v[172:175], v240 offset:26624
  ds_read_b128 v[176:179], v240 offset:30720
  ds_read_b128 v[180:183], v240 offset:31744
  ds_read_b128 v[184:187], v240 offset:35840
  ds_read_b128 v[188:191], v240 offset:36864
  v_lshrrev_b32 v200, 4, v253
  v_and_b32 v203, 15, v253
  v_mov_b32 v202, 0x10000
  v_cmp_eq_u32 vcc, 0, v203
  v_mov_b32 v208, 320
  v_subrev_u32 v200, s26, v200
  v_cndmask_b32 v205, v202, v208, vcc
  v_add_u32 v201, 4, v200
  s_lshl_b32 s60, s26, 2
  v_subrev_u32 v203, s60, v203
  v_add_u32 v204, 16, v203
  s_lshl_b32 s64, s26, 11
  s_add_u32 s64, s64, 40960
  v_cmp_gt_u32 vcc, 5, v200
  v_cmp_gt_u32 s[62:63], 20, v203
  v_mul_u32_u24 v200, 336, v200
  v_lshlrev_b32 v203, 4, v203
  v_cndmask_b32 v200, v202, v200, vcc
  v_cndmask_b32 v203, v202, v203, s[62:63]
  v_cmp_gt_u32 vcc, 5, v201
  s_waitcnt lgkmcnt(0)
  v_mfma_f32_16x16x32_bf16 v[0:3], v[128:131], v[136:139], 0
  v_cmp_gt_u32 s[62:63], 20, v204
  v_mul_u32_u24 v201, 336, v201
  v_mfma_f32_16x16x32_bf16 v[4:7], v[128:131], v[140:143], 0
  v_lshlrev_b32 v204, 4, v204
  v_cndmask_b32 v201, v202, v201, vcc
  v_mfma_f32_16x16x32_bf16 v[8:11], v[128:131], v[192:195], 0
  v_cndmask_b32 v204, v202, v204, s[62:63]
  v_mfma_f32_16x16x32_bf16 v[12:15], v[132:135], v[136:139], 0
  v_add_u32 v208, v200, v203
  v_add_u32 v209, v200, v204
  v_mfma_f32_16x16x32_bf16 v[16:19], v[132:135], v[140:143], 0
  v_add_u32 v210, v200, v205
  v_mfma_f32_16x16x32_bf16 v[20:23], v[132:135], v[192:195], 0
  v_min_u32 v208, 1680, v208
  v_min_u32 v209, 1680, v209
  v_mfma_f32_16x16x32_bf16 v[0:3], v[144:147], v[152:155], v[0:3]
  v_min_u32 v210, 1680, v210
  v_mfma_f32_16x16x32_bf16 v[4:7], v[144:147], v[156:159], v[4:7]
  v_add_u32 v208, s64, v208
  v_add_u32 v209, s64, v209
  v_mfma_f32_16x16x32_bf16 v[8:11], v[144:147], v[192:195], v[8:11]
  v_add_u32 v210, s64, v210
  v_add_u32 v211, v201, v203
  v_mfma_f32_16x16x32_bf16 v[12:15], v[148:151], v[152:155], v[12:15]
  v_add_u32 v212, v201, v204
  v_mfma_f32_16x16x32_bf16 v[16:19], v[148:151], v[156:159], v[16:19]
  v_add_u32 v213, v201, v205
  v_min_u32 v211, 1680, v211
  v_mfma_f32_16x16x32_bf16 v[20:23], v[148:151], v[192:195], v[20:23]
  v_min_u32 v212, 1680, v212
  v_mfma_f32_16x16x32_bf16 v[0:3], v[160:163], v[168:171], v[0:3]
  v_min_u32 v213, 1680, v213
  v_add_u32 v211, s64, v211
  v_mfma_f32_16x16x32_bf16 v[4:7], v[160:163], v[172:175], v[4:7]
  v_add_u32 v212, s64, v212
  v_mfma_f32_16x16x32_bf16 v[8:11], v[160:163], v[192:195], v[8:11]
  v_add_u32 v213, s64, v213
  v_lshlrev_b32 v200, 2, v253
  v_mfma_f32_16x16x32_bf16 v[12:15], v[164:167], v[168:171], v[12:15]
  v_add_u32 v240, s64, v200
  v_mfma_f32_16x16x32_bf16 v[16:19], v[164:167], v[172:175], v[16:19]
  v_mfma_f32_16x16x32_bf16 v[20:23], v[164:167], v[192:195], v[20:23]
  v_mfma_f32_16x16x32_bf16 v[0:3], v[176:179], v[184:187], v[0:3]
  v_mfma_f32_16x16x32_bf16 v[4:7], v[176:179], v[188:191], v[4:7]
  v_mfma_f32_16x16x32_bf16 v[8:11], v[176:179], v[192:195], v[8:11]
  v_mfma_f32_16x16x32_bf16 v[12:15], v[180:183], v[184:187], v[12:15]
  v_mfma_f32_16x16x32_bf16 v[16:19], v[180:183], v[188:191], v[16:19]
  v_mfma_f32_16x16x32_bf16 v[20:23], v[180:183], v[192:195], v[20:23]
  v_pk_mul_f32 v[112:113], v[80:81], s[96:97]
  v_pk_mul_f32 v[114:115], v[82:83], s[96:97]
  v_exp_f32 v112, v112 clamp
  v_exp_f32 v113, v113 clamp
  v_exp_f32 v114, v114 clamp
  v_exp_f32 v115, v115 clamp
  v_pk_add_f32 v[80:81], v[80:81], s[98:99]
  v_pk_add_f32 v[82:83], v[82:83], s[98:99]
  ds_write_b128 v208, v[0:3]
  ds_write_b128 v209, v[4:7]
  ds_write_b128 v210, v[8:11]
  ds_write_b128 v211, v[12:15]
  ds_write_b128 v212, v[16:19]
  ds_write_b128 v213, v[20:23]
  v_pk_add_f32 v[112:113], v[112:113], s[100:101]
  v_pk_add_f32 v[114:115], v[114:115], s[100:101]
  v_max_f32 v112, v112, v80
  v_max_f32 v113, v113, v81
  v_max_f32 v114, v114, v82
  v_max_f32 v115, v115, v83
  v_cvt_pk_bf16_f32 v80, v112, v113
  v_cvt_pk_bf16_f32 v81, v114, v115
  v_pk_mul_f32 v[116:117], v[84:85], s[96:97]
  v_pk_mul_f32 v[118:119], v[86:87], s[96:97]
  v_exp_f32 v116, v116 clamp
  v_exp_f32 v117, v117 clamp
  s_waitcnt lgkmcnt(0)
  ds_read_b32 v0, v240 offset:0
  ds_read_b32 v1, v240 offset:256
  ds_read_b32 v2, v240 offset:512
  ds_read_b32 v3, v240 offset:768
  ds_read_b32 v4, v240 offset:1024
  ds_read_b32 v5, v240 offset:1280
  ds_read_b32 v6, v240 offset:1536
  v_exp_f32 v118, v118 clamp
  v_exp_f32 v119, v119 clamp
  v_pk_add_f32 v[84:85], v[84:85], s[98:99]
  v_pk_add_f32 v[86:87], v[86:87], s[98:99]
  v_pk_add_f32 v[116:117], v[116:117], s[100:101]
  v_pk_add_f32 v[118:119], v[118:119], s[100:101]
  v_max_f32 v116, v116, v84
  v_max_f32 v117, v117, v85
  v_max_f32 v118, v118, v86
  v_max_f32 v119, v119, v87
  v_cvt_pk_bf16_f32 v82, v116, v117
  v_cvt_pk_bf16_f32 v83, v118, v119
  s_waitcnt lgkmcnt(0)
  buffer_atomic_add_f32 v0, v200, s[36:39], s74 offen offset:0 sc1
  buffer_atomic_add_f32 v1, v200, s[36:39], s74 offen offset:256 sc1
  buffer_atomic_add_f32 v2, v200, s[36:39], s74 offen offset:512 sc1
  buffer_atomic_add_f32 v3, v200, s[36:39], s74 offen offset:768 sc1
  buffer_atomic_add_f32 v4, v200, s[36:39], s74 offen offset:1024 sc1
  buffer_atomic_add_f32 v5, v200, s[36:39], s74 offen offset:1280 sc1
  s_mov_b32 exec_hi, 15
  buffer_atomic_add_f32 v6, v200, s[36:39], s74 offen offset:1536 sc1
  s_mov_b32 exec_hi, -1
  s_add_u32 s60, s72, 4096
  buffer_store_dwordx4 v[80:83], v247, s[36:39], s72 offen offset:0 sc1
  v_pk_mul_f32 v[112:113], v[88:89], s[96:97]
  v_pk_mul_f32 v[114:115], v[90:91], s[96:97]
  v_exp_f32 v112, v112 clamp
  v_exp_f32 v113, v113 clamp
  v_exp_f32 v114, v114 clamp
  v_exp_f32 v115, v115 clamp
  v_pk_add_f32 v[88:89], v[88:89], s[98:99]
  v_pk_add_f32 v[90:91], v[90:91], s[98:99]
  v_pk_add_f32 v[112:113], v[112:113], s[100:101]
  v_pk_add_f32 v[114:115], v[114:115], s[100:101]
  v_max_f32 v112, v112, v88
  v_max_f32 v113, v113, v89
  v_max_f32 v114, v114, v90
  v_max_f32 v115, v115, v91
  v_cvt_pk_bf16_f32 v88, v112, v113
  v_cvt_pk_bf16_f32 v89, v114, v115
  v_pk_mul_f32 v[116:117], v[92:93], s[96:97]
  v_pk_mul_f32 v[118:119], v[94:95], s[96:97]
  v_exp_f32 v116, v116 clamp
  v_exp_f32 v117, v117 clamp
  v_exp_f32 v118, v118 clamp
  v_exp_f32 v119, v119 clamp
  v_pk_add_f32 v[92:93], v[92:93], s[98:99]
  v_pk_add_f32 v[94:95], v[94:95], s[98:99]
  v_pk_add_f32 v[116:117], v[116:117], s[100:101]
  v_pk_add_f32 v[118:119], v[118:119], s[100:101]
  v_max_f32 v116, v116, v92
  v_max_f32 v117, v117, v93
  v_max_f32 v118, v118, v94
  v_max_f32 v119, v119, v95
  v_cvt_pk_bf16_f32 v90, v116, v117
  v_cvt_pk_bf16_f32 v91, v118, v119
  buffer_store_dwordx4 v[88:91], v247, s[36:39], s72 offen offset:2048 sc1
  v_pk_mul_f32 v[112:113], v[96:97], s[96:97]
  v_pk_mul_f32 v[114:115], v[98:99], s[96:97]
  v_exp_f32 v112, v112 clamp
  v_exp_f32 v113, v113 clamp
  v_exp_f32 v114, v114 clamp
  v_exp_f32 v115, v115 clamp
  v_pk_add_f32 v[96:97], v[96:97], s[98:99]
  v_pk_add_f32 v[98:99], v[98:99], s[98:99]
  v_pk_add_f32 v[112:113], v[112:113], s[100:101]
  v_pk_add_f32 v[114:115], v[114:115], s[100:101]
  v_max_f32 v112, v112, v96
  v_max_f32 v113, v113, v97
  v_max_f32 v114, v114, v98
  v_max_f32 v115, v115, v99
  v_cvt_pk_bf16_f32 v96, v112, v113
  v_cvt_pk_bf16_f32 v97, v114, v115
  v_pk_mul_f32 v[116:117], v[100:101], s[96:97]
  v_pk_mul_f32 v[118:119], v[102:103], s[96:97]
  v_exp_f32 v116, v116 clamp
  v_exp_f32 v117, v117 clamp
  v_exp_f32 v118, v118 clamp
  v_exp_f32 v119, v119 clamp
  v_pk_add_f32 v[100:101], v[100:101], s[98:99]
  v_pk_add_f32 v[102:103], v[102:103], s[98:99]
  v_pk_add_f32 v[116:117], v[116:117], s[100:101]
  v_pk_add_f32 v[118:119], v[118:119], s[100:101]
  v_max_f32 v116, v116, v100
  v_max_f32 v117, v117, v101
  v_max_f32 v118, v118, v102
  v_max_f32 v119, v119, v103
  v_cvt_pk_bf16_f32 v98, v116, v117
  v_cvt_pk_bf16_f32 v99, v118, v119
  buffer_store_dwordx4 v[96:99], v247, s[36:39], s60 offen offset:0 sc1
  v_pk_mul_f32 v[112:113], v[104:105], s[96:97]
  v_pk_mul_f32 v[114:115], v[106:107], s[96:97]
  v_exp_f32 v112, v112 clamp
  v_exp_f32 v113, v113 clamp
  v_exp_f32 v114, v114 clamp
  v_exp_f32 v115, v115 clamp
  v_pk_add_f32 v[104:105], v[104:105], s[98:99]
  v_pk_add_f32 v[106:107], v[106:107], s[98:99]
  v_pk_add_f32 v[112:113], v[112:113], s[100:101]
  v_pk_add_f32 v[114:115], v[114:115], s[100:101]
  v_max_f32 v112, v112, v104
  v_max_f32 v113, v113, v105
  v_max_f32 v114, v114, v106
  v_max_f32 v115, v115, v107
  v_cvt_pk_bf16_f32 v104, v112, v113
  v_cvt_pk_bf16_f32 v105, v114, v115
  v_pk_mul_f32 v[116:117], v[108:109], s[96:97]
  v_pk_mul_f32 v[118:119], v[110:111], s[96:97]
  v_exp_f32 v116, v116 clamp
  v_exp_f32 v117, v117 clamp
  v_exp_f32 v118, v118 clamp
  v_exp_f32 v119, v119 clamp
  v_pk_add_f32 v[108:109], v[108:109], s[98:99]
  v_pk_add_f32 v[110:111], v[110:111], s[98:99]
  v_pk_add_f32 v[116:117], v[116:117], s[100:101]
  v_pk_add_f32 v[118:119], v[118:119], s[100:101]
  v_max_f32 v116, v116, v108
  v_max_f32 v117, v117, v109
  v_max_f32 v118, v118, v110
  v_max_f32 v119, v119, v111
  v_cvt_pk_bf16_f32 v106, v116, v117
  v_cvt_pk_bf16_f32 v107, v118, v119
  buffer_store_dwordx4 v[104:107], v247, s[36:39], s60 offen offset:2048 sc1
  v_mov_b32 v0, v253
  s_bfe_u32 s62, s2, 0x20001
  s_bfe_u32 s63, s2, 0x30003
  s_lshl3_add_u32 s27, s62, s63
  s_and_b32 s62, s2, 1
  s_lshr_b32 s63, s2, 6
  s_lshl2_add_u32 s28, s62, s63
  v_lshlrev_b32 v254, 4, v0
  v_add_u32 v255, 4096, v254
  s_mov_b32 s60, 0
  s_mul_i32 s61, s26, 6
  s_mul_i32 s62, s28, 245760
  s_add_u32 s62, s62, 3145728
  s_mul_i32 s63, s27, 196608
  s_add_u32 s63, s63, 8388608
  s_add_u32 s64, s61, s60
  s_mul_i32 s40, s64, 5120
  s_add_u32 s40, s40, s62
  s_lshl_b32 s46, s64, 12
  s_add_u32 s46, s46, s63
  s_add_u32 s60, s60, 1
  s_cmp_eq_u32 s60, 6
  s_cselect_b32 s60, 0, s60
  s_add_u32 s64, s61, s60
  s_mul_i32 s41, s64, 5120
  s_add_u32 s41, s41, s62
  s_lshl_b32 s47, s64, 12
  s_add_u32 s47, s47, s63
  s_add_u32 s60, s60, 1
  s_cmp_eq_u32 s60, 6
  s_cselect_b32 s60, 0, s60
  s_add_u32 s64, s61, s60
  s_mul_i32 s42, s64, 5120
  s_add_u32 s42, s42, s62
  s_lshl_b32 s48, s64, 12
  s_add_u32 s48, s48, s63
  s_add_u32 s60, s60, 1
  s_cmp_eq_u32 s60, 6
  s_cselect_b32 s60, 0, s60
  s_add_u32 s64, s61, s60
  s_mul_i32 s43, s64, 5120
  s_add_u32 s43, s43, s62
  s_lshl_b32 s49, s64, 12
  s_add_u32 s49, s49, s63
  s_add_u32 s60, s60, 1
  s_cmp_eq_u32 s60, 6
  s_cselect_b32 s60, 0, s60
  s_add_u32 s64, s61, s60
  s_mul_i32 s44, s64, 5120
  s_add_u32 s44, s44, s62
  s_lshl_b32 s50, s64, 12
  s_add_u32 s50, s50, s63
  s_add_u32 s60, s60, 1
  s_cmp_eq_u32 s60, 6
  s_cselect_b32 s60, 0, s60
  s_add_u32 s64, s61, s60
  s_mul_i32 s45, s64, 5120
  s_add_u32 s45, s45, s62
  s_lshl_b32 s51, s64, 12
  s_add_u32 s51, s51, s63
  s_lshl3_add_u32 s10, s27, s26
  s_lshl_b32 s10, s10, 7
  s_lshl_b32 s11, s27, 7
  s_add_u32 s11, s11, 32768
  s_mul_i32 s0, s27, 40
  s_mul_i32 s60, s26, 5
  s_add_u32 s0, s0, s60
  s_lshl_b32 s0, s0, 11
  s_add_u32 s0, s0, 5242880
  s_lshl3_add_u32 s1, s28, s26
  s_mul_i32 s1, s1, 12800
  s_add_u32 s1, s1, 2097152
  s_mul_i32 s3, s26, 7168
  s_add_u32 s3, s3, 1048576
  s_lshl_b32 s29, s26, 9
  s_add_u32 s29, s29, 36864
  s_mov_b32 s32, s73
  v_lshrrev_b32 v255, 4, v254
  s_xor_b32 s30, s26, 4
  s_mul_i32 s30, s30, 20480
  s_mov_b32 s33, -208
  v_and_b32 v44, 15, v255
  v_lshrrev_b32 v45, 4, v255
  s_add_u32 s62, s30, 13312
  v_mul_u32_u24 v47, 336, v45
  v_add_u32 v47, s62, v47
  v_add_u32 v62, s30, v254
  s_add_u32 s62, s62, 7056
  v_mov_b32 v57, s62
  v_subrev_u32 v58, 1344, v57
  v_subrev_u32 v59, 2688, v57
  v_subrev_u32 v60, 4032, v57
  v_subrev_u32 v61, 5376, v57
  v_add_u32 v50, 0, v44
  v_mul_u32_u24 v48, 3277, v50
  v_lshrrev_b32 v48, 16, v48
  v_lshl_add_u32 v50, v50, 4, v47
  v_mad_i32_i24 v49, v48, s33, v50
  v_mad_i32_i24 v48, v48, -5, v45
  v_add_u32 v52, 0, v48
  v_add_u32 v53, 4, v48
  v_cmp_gt_u32 s[64:65], 5, v52
  v_cmp_gt_u32 s[66:67], 5, v53
  s_nop 0
  v_cndmask_b32 v20, v57, v49, s[64:65]
  v_cndmask_b32 v21, v58, v49, s[66:67]
  v_add_u32 v50, 16, v44
  v_mul_u32_u24 v48, 3277, v50
  v_lshrrev_b32 v48, 16, v48
  v_lshl_add_u32 v50, v50, 4, v47
  v_mad_i32_i24 v49, v48, s33, v50
  v_mad_i32_i24 v48, v48, -5, v45
  v_add_u32 v52, 0, v48
  v_add_u32 v53, 4, v48
  v_add_u32 v54, 8, v48
  v_cmp_gt_u32 s[64:65], 5, v52
  v_cmp_gt_u32 s[66:67], 5, v53
  v_cmp_gt_u32 s[68:69], 5, v54
  s_nop 0
  v_cndmask_b32 v22, v57, v49, s[64:65]
  v_cndmask_b32 v23, v58, v49, s[66:67]
  v_cndmask_b32 v24, v59, v49, s[68:69]
  v_add_u32 v50, 32, v44
  v_mul_u32_u24 v48, 3277, v50
  v_lshrrev_b32 v48, 16, v48
  v_lshl_add_u32 v50, v50, 4, v47
  v_mad_i32_i24 v49, v48, s33, v50
  v_mad_i32_i24 v48, v48, -5, v45
  v_add_u32 v52, 4, v48
  v_add_u32 v53, 8, v48
  v_add_u32 v54, 12, v48
  v_cmp_gt_u32 s[64:65], 5, v52
  v_cmp_gt_u32 s[66:67], 5, v53
  v_cmp_gt_u32 s[68:69], 5, v54
  s_nop 0
  v_cndmask_b32 v25, v58, v49, s[64:65]
  v_cndmask_b32 v26, v59, v49, s[66:67]
  v_cndmask_b32 v27, v60, v49, s[68:69]
  v_add_u32 v50, 48, v44
  v_mul_u32_u24 v48, 3277, v50
  v_lshrrev_b32 v48, 16, v48
  v_lshl_add_u32 v50, v50, 4, v47
  v_mad_i32_i24 v49, v48, s33, v50
  v_mad_i32_i24 v48, v48, -5, v45
  v_add_u32 v52, 8, v48
  v_add_u32 v53, 12, v48
  v_add_u32 v54, 16, v48
  v_cmp_gt_u32 s[64:65], 5, v52
  v_cmp_gt_u32 s[66:67], 5, v53
  v_cmp_gt_u32 s[68:69], 5, v54
  s_nop 0
  v_cndmask_b32 v28, v59, v49, s[64:65]
  v_cndmask_b32 v29, v60, v49, s[66:67]
  v_cndmask_b32 v31, v61, v49, s[68:69]
  v_add_u32 v50, 64, v44
  v_mul_u32_u24 v48, 3277, v50
  v_lshrrev_b32 v48, 16, v48
  v_lshl_add_u32 v50, v50, 4, v47
  v_mad_i32_i24 v49, v48, s33, v50
  v_mad_i32_i24 v48, v48, -5, v45
  v_add_u32 v52, 12, v48
  v_add_u32 v53, 16, v48
  v_cmp_gt_u32 s[64:65], 5, v52
  v_cmp_gt_u32 s[66:67], 5, v53
  s_nop 0
  v_cndmask_b32 v30, v60, v49, s[64:65]
  v_cndmask_b32 v32, v61, v49, s[66:67]
  v_and_b32 v48, 3, v255
  v_mul_u32_u24 v49, 112, v48
  v_add_u32 v50, 320, v47
  v_add_u32 v49, v49, v50
  v_mad_i32_i24 v48, v48, -5, v45
  v_add_u32 v52, 0, v48
  v_add_u32 v53, 4, v48
  v_add_u32 v54, 8, v48
  v_add_u32 v55, 12, v48
  v_add_u32 v56, 16, v48
  v_cmp_gt_u32 s[64:65], 5, v52
  v_cmp_gt_u32 s[66:67], 5, v53
  v_cmp_gt_u32 s[68:69], 5, v54
  v_cmp_gt_u32 s[70:71], 5, v55
  v_cmp_gt_u32 s[72:73], 5, v56
  s_nop 0
  v_cndmask_b32 v33, v57, v49, s[64:65]
  v_cndmask_b32 v34, v58, v49, s[66:67]
  v_cndmask_b32 v35, v59, v49, s[68:69]
  v_cndmask_b32 v36, v60, v49, s[70:71]
  v_cndmask_b32 v37, v61, v49, s[72:73]
  s_waitcnt vmcnt(0)
  v_mov_b32 v70, 1
  v_mov_b32 v71, 0
  s_mov_b64 exec, 1
  buffer_atomic_add v70, v71, s[36:39], s31 offen offset:0 sc1
  s_mov_b64 exec, -1
  v_mov_b32 v70, 1
  v_mov_b32 v71, 0
  s_mov_b64 exec, 1
  buffer_atomic_add v70, v71, s[36:39], s32 offen offset:0 sc1
  s_mov_b64 exec, -1
  s_branch L_g2
L_code_end:
.section .rodata,"a"
.p2align 6
.amdhsa_kernel gated_mix__linear_attn_block__dense_activation_mish__prompt_kernel
  .amdhsa_next_free_vgpr 256
  .amdhsa_next_free_sgpr 102
  .amdhsa_accum_offset 256
  .amdhsa_group_segment_fixed_size 0
  .amdhsa_kernarg_size 88
  .amdhsa_user_sgpr_count 2
  .amdhsa_user_sgpr_kernarg_segment_ptr 1
  .amdhsa_system_sgpr_workgroup_id_x 1
.end_amdhsa_kernel
```
